```python
import torch

def _softmax(x, axis=-1):
    return torch.softmax(x, dim=axis)
def _gelu(x):
    return torch.nn.functional.gelu(x, approximate="tanh")
def _silu(x):
    return torch.nn.functional.silu(x)
def _sigmoid(x):
    return torch.sigmoid(x)
def _layernorm(x, axis=-1, eps=1e-5):
    m = x.mean(dim=axis, keepdim=True)
    v = x.var(dim=axis, keepdim=True, unbiased=False)
    return (x - m) / torch.sqrt(v + eps)
def _scatter_add(tgt, idx, src, axis=0):
    return tgt.clone().index_add_(axis, idx, src)
def _segment_sum(src, seg, n):
    out = torch.zeros((n,) + src.shape[1:], dtype=src.dtype)
    return out.index_add_(0, seg, src)
def _pad(x, pw):
    flat = tuple(v for pair in reversed(pw) for v in pair)
    return torch.nn.functional.pad(x, flat)

kernel_name = 'concat_heads__softmax_full_mha__sliding_block__prompt'

def setup_inputs():

    _w = (lambda a: (lambda t: t.to(torch.bfloat16) if t.is_floating_point() else t)(torch.as_tensor(a)))
    def _A_setup():
        B, S, D = 1, 2048, 640
        return {
            "x": _w((lambda *s: torch.randn(*s, dtype=torch.bfloat16) * 0.2)(B, S, D)),
            "wqkv": _w((lambda *s: torch.randn(*s, dtype=torch.bfloat16) * 0.4)(D, 3 * D)),
            "wo": _w((lambda *s: torch.randn(*s, dtype=torch.bfloat16) * 0.1)(D, D)),
        }
    _A_in = _A_setup()

    def _B_setup():
        B, S, D = 1, 2048, 640
        return {
            "x": _w((lambda *s: torch.randn(*s, dtype=torch.bfloat16) * 0.4)(B, S, D)),
            "wqkv": _w((lambda *s: torch.randn(*s, dtype=torch.bfloat16) * 0.4)(D, 3 * D)),
            "wo": _w((lambda *s: torch.randn(*s, dtype=torch.bfloat16) * 0.05)(D, D)),
        }
    _B_in = _B_setup()

    return {
        "A_x": _A_in["x"],
        "A_wqkv": _A_in["wqkv"],
        "A_wo": _A_in["wo"],
        "B_x": _B_in["x"],
        "B_wqkv": _B_in["wqkv"],
        "B_wo": _B_in["wo"],
    }

def reference(A_x, A_wqkv, A_wo, B_x, B_wqkv, B_wo):
    def _A_ref(x, wqkv, wo):
        B, S, D = x.shape
        H = 32; Dh = D // H
        qkv = (lambda x, *d: x.permute(*d))((x @ wqkv).reshape(B, S, 3, H, Dh), 2, 0, 3, 1, 4)
        q, k, v = qkv[0], qkv[1], qkv[2]
        scale = Dh ** -0.5
        scores = torch.einsum("bhqd,bhkd->bhqk", q, k) * scale
        p = _softmax(scores, axis=-1)
        o = torch.einsum("bhqk,bhkd->bhqd", p, v)
        return (lambda x, *d: x.permute(*d))(o, 0, 2, 1, 3).reshape(B, S, D) @ wo

    def _B_ref(x, wqkv, wo):
        B, S, D = x.shape
        H = 32; Dh = D // H; W = 256
        qkv = (lambda x, *d: x.permute(*d))((x @ wqkv).reshape(B, S, 3, H, Dh), 2, 0, 3, 1, 4)
        q, k, v = qkv[0], qkv[1], qkv[2]
        scores = torch.einsum("bhqd,bhkd->bhqk", q, k) * (Dh ** -0.5)
        idx = torch.arange(S)
        mask = (idx[:, None] - idx[None, :] >= 0) & (idx[:, None] - idx[None, :] < W)
        scores = torch.where(mask[None, None], scores, -1e9)
        p = _softmax(scores, axis=-1)
        o = torch.einsum("bhqk,bhkd->bhqd", p, v)
        return (lambda x, *d: x.permute(*d))(o, 0, 2, 1, 3).reshape(B, S, D) @ wo

    a = _A_ref(A_x, A_wqkv, A_wo)
    b = _B_ref(B_x, B_wqkv, B_wo)
    return torch.concatenate([a, b], axis=-1)
```

```asm
; @launch kernel=fk_kernel grid=(256,1,1) block=(512,1,1) lds=163840
.amdgcn_target "amdgcn-amd-amdhsa--gfx950"
.text
.globl fk_kernel
.p2align 8
.type fk_kernel,@function
fk_kernel:
    s_memrealtime s[36:37]
    s_load_dwordx16 s[16:31], s[0:1], 0
    s_load_dwordx2 s[32:33], s[0:1], 64
    s_cmp_ge_u32 s2, 256
    s_cbranch_scc1 L_end
    v_lshrrev_b32 v24, 6, v0
    s_getpc_b64 s[64:65]
    v_lshlrev_b32 v31, 7, v0
    v_readfirstlane_b32 s3, v24
    s_getreg_b32 s4, hwreg(HW_REG_XCC_ID, 0, 3)
    s_getreg_b32 s6, hwreg(HW_REG_HW_ID, 13, 2)
    s_getreg_b32 s40, hwreg(HW_REG_HW_ID, 8, 4)
    s_cmp_lg_u32 s3, 1
    s_cbranch_scc1 L_nopf
    s_and_b32 s7, s40, 3
    s_lshl_b32 s7, s7, 13
    v_add_u32 v31, s7, v31
    global_load_dword v96, v31, s[64:65]
L_nopf:
    s_lshl_b32 s60, s4, 2
    s_add_u32 s60, s60, s6
    s_and_b32 s41, s60, 7
    s_lshr_b32 s7, s4, 1
    s_lshl_b32 s7, s7, 6
    s_or_b32 s41, s41, s7
    s_lshl_b32 s60, s60, 7
    s_add_u32 s60, s60, 18350080
    s_mul_i32 s40, s40, 1
    s_mul_i32 s7, s40, 205
    s_lshr_b32 s7, s7, 10
    s_mul_i32 s7, s7, 5
    s_sub_u32 s40, s40, s7
    s_mov_b32 s42, 0
    s_mov_b32 s34, 19464192
    s_mov_b32 s35, 0x20000
    s_mov_b32 s10, 2621440
    s_mov_b32 s11, 0x20000
    s_mov_b32 s14, 2457600
    s_mov_b32 s15, 0x20000
    s_lshl_b32 s43, s3, 10
    v_and_b32 v1, 63, v0
L_restart:
    s_lshr_b32 s4, s41, 7
    s_and_b32 s6, s41, 7
    s_and_b32 s7, s6, 1
    s_mul_i32 s7, s7, 1120
    s_mul_i32 s56, s6, 160
    s_add_u32 s7, s7, s56
    s_add_u32 s7, s7, 1280
    s_mov_b32 s51, s40
    s_mul_i32 s46, s51, 491520
    s_add_u32 s52, s51, 1
    s_cmp_eq_u32 s52, 5
    s_cselect_b32 s52, 0, s52
    s_mul_i32 s47, s52, 491520
    s_add_u32 s53, s52, 1
    s_cmp_eq_u32 s53, 5
    s_cselect_b32 s53, 0, s53
    s_mul_i32 s48, s53, 491520
    s_add_u32 s54, s53, 1
    s_cmp_eq_u32 s54, 5
    s_cselect_b32 s54, 0, s54
    s_mul_i32 s49, s54, 491520
    s_add_u32 s55, s54, 1
    s_cmp_eq_u32 s55, 5
    s_cselect_b32 s55, 0, s55
    s_mul_i32 s50, s55, 491520
    v_mul_u32_u24 v25, 6554, v0
    v_lshl_add_u32 v3, v0, 4, s7
    v_lshrrev_b32 v26, 17, v25
    v_bfe_u32 v27, v25, 16, 1
    v_bfe_i32 v25, v25, 20, 1
    s_movk_i32 s66, 3520
    v_mad_u32_u24 v3, v26, s66, v3
    v_mul_u32_u24 v27, 320, v27
    v_sub_u32 v27, 160, v27
    v_and_b32 v27, v27, v25
    v_add_u32 v3, v3, v27
    v_add_u32 v24, 512, v0
    v_mul_u32_u24 v25, 6554, v24
    v_lshl_add_u32 v4, v24, 4, s7
    v_lshrrev_b32 v26, 17, v25
    v_bfe_u32 v27, v25, 16, 1
    v_bfe_i32 v25, v25, 20, 1
    v_mad_u32_u24 v4, v26, s66, v4
    v_mul_u32_u24 v27, 320, v27
    v_sub_u32 v27, 160, v27
    v_and_b32 v27, v27, v25
    v_add_u32 v4, v4, v27
    v_add_u32 v24, 1024, v0
    v_mul_u32_u24 v25, 6554, v24
    v_lshl_add_u32 v5, v24, 4, s7
    v_lshrrev_b32 v26, 17, v25
    v_bfe_u32 v27, v25, 16, 1
    v_bfe_i32 v25, v25, 20, 1
    v_mad_u32_u24 v5, v26, s66, v5
    v_mul_u32_u24 v27, 320, v27
    v_sub_u32 v27, 160, v27
    v_and_b32 v27, v27, v25
    v_add_u32 v5, v5, v27
    v_add_u32 v24, 1536, v0
    v_mul_u32_u24 v25, 6554, v24
    v_lshl_add_u32 v6, v24, 4, s7
    v_lshrrev_b32 v26, 17, v25
    v_bfe_u32 v27, v25, 16, 1
    v_bfe_i32 v25, v25, 20, 1
    v_mad_u32_u24 v6, v26, s66, v6
    v_mul_u32_u24 v27, 320, v27
    v_sub_u32 v27, 160, v27
    v_and_b32 v27, v27, v25
    v_add_u32 v6, v6, v27
    v_add_u32 v24, 2048, v0
    v_mul_u32_u24 v25, 6554, v24
    v_lshl_add_u32 v7, v24, 4, s7
    v_lshrrev_b32 v26, 17, v25
    v_bfe_u32 v27, v25, 16, 1
    v_bfe_i32 v25, v25, 20, 1
    v_mad_u32_u24 v7, v26, s66, v7
    v_mul_u32_u24 v27, 320, v27
    v_sub_u32 v27, 160, v27
    v_and_b32 v27, v27, v25
    v_add_u32 v7, v7, v27
    v_mov_b32 v22, 1
    v_mov_b32 v23, 0
    v_mov_b32 v21, 159744
    s_mov_b32 m0, s43
    s_cmp_eq_u32 s4, 0
    s_waitcnt lgkmcnt(0)
    s_cselect_b32 s8, s16, s22
    s_cselect_b32 s9, s17, s23
    s_cselect_b32 s12, s18, s24
    s_cselect_b32 s13, s19, s25
    s_or_b32 s7, s3, s42
    s_cbranch_scc1 L_notk
    s_mov_b64 exec, 1
    buffer_atomic_add v22, off, s[32:35], s60 sc0 sc1
    s_mov_b64 exec, -1
L_notk:
    buffer_load_dwordx4 v3, s[12:15], s46 offen lds
    s_add_u32 m0, s43, 8192
    s_nop 0
    buffer_load_dwordx4 v4, s[12:15], s46 offen lds
    s_add_u32 m0, s43, 16384
    s_nop 0
    buffer_load_dwordx4 v5, s[12:15], s46 offen lds
    v_lshrrev_b32 v24, 3, v1
    v_lshrrev_b32 v25, 4, v1
    s_and_b32 s7, s3, 1
    s_lshl_b32 s7, s7, 2
    v_and_b32 v26, 7, v1
    v_or_b32 v27, s7, v25
    v_xor_b32 v27, v27, v26
    v_mul_u32_u24 v2, 1280, v24
    v_lshl_add_u32 v2, v27, 4, v2
    s_lshl_b32 s7, s7, 2
    s_and_b32 s5, s3, 2
    s_lshl_b32 s5, s5, 2
    s_add_u32 s7, s7, s5
    s_lshr_b32 s44, s3, 2
    s_lshl_b32 s5, s44, 5
    s_add_u32 s7, s7, s5
    s_mul_i32 s59, s7, 5
    s_add_u32 s51, s51, s59
    s_add_u32 s52, s52, s59
    s_add_u32 s53, s53, s59
    s_add_u32 s54, s54, s59
    s_add_u32 s55, s55, s59
    s_sub_u32 s38, s36, 2000
    s_subb_u32 s39, s37, 0
    s_or_b32 s7, s3, s42
    s_cbranch_scc1 L_notk2
    s_waitcnt vmcnt(3)
    s_mov_b64 exec, 1
    ds_write_b64 v21, v[22:23]
    s_mov_b64 exec, -1
    s_waitcnt lgkmcnt(0)
L_notk2:
    s_barrier
    ds_read_b32 v24, v21
    s_waitcnt lgkmcnt(0)
    v_readfirstlane_b32 s7, v24
    s_and_b32 s7, s7, 7
    s_lshl_b32 s7, s7, 3
    s_cmp_eq_u32 s42, 0
    s_cselect_b32 s7, s7, 0
    s_or_b32 s41, s41, s7
    s_bfe_u32 s5, s41, 0x40003
    s_mul_i32 s7, s5, 640
    s_add_u32 s51, s51, s7
    s_lshl_b32 s51, s51, 8
    s_add_u32 s52, s52, s7
    s_lshl_b32 s52, s52, 8
    s_add_u32 s53, s53, s7
    s_lshl_b32 s53, s53, 8
    s_add_u32 s54, s54, s7
    s_lshl_b32 s54, s54, 8
    s_add_u32 s55, s55, s7
    s_lshl_b32 s55, s55, 8
    s_add_u32 m0, s43, 110592
    s_nop 0
    buffer_load_dwordx4 v2, s[8:11], s51 offen lds
    s_add_u32 m0, s43, 118784
    s_add_u32 s7, s51, 81920
    buffer_load_dwordx4 v2, s[8:11], s7 offen lds
    s_or_b32 s7, s3, s42
    s_cbranch_scc1 L_nocl
    v_mov_b32 v22, s36
    v_mov_b32 v23, s37
    s_lshl_b32 s7, s41, 3
    s_add_u32 s7, s7, 18354176
    s_mov_b64 exec, 1
    buffer_atomic_swap_x2 v[22:23], off, s[32:35], s7 sc0 sc1
    s_mov_b64 exec, -1
L_nocl:
    s_barrier
    s_add_u32 m0, s43, 24576
    s_nop 0
    buffer_load_dwordx4 v6, s[12:15], s46 offen lds
    s_add_u32 m0, s43, 32768
    s_nop 0
    buffer_load_dwordx4 v7, s[12:15], s46 offen lds
    s_add_u32 m0, s43, 126976
    s_add_u32 s7, s51, 128
    buffer_load_dwordx4 v2, s[8:11], s7 offen lds
    s_add_u32 m0, s43, 135168
    s_add_u32 s7, s51, 82048
    buffer_load_dwordx4 v2, s[8:11], s7 offen lds
    s_and_b32 s45, s3, 3
    s_add_u32 s58, s43, 98304
    s_sub_u32 s7, s43, 4096
    s_cmp_ge_u32 s3, 4
    s_cselect_b32 s58, s7, s58
    v_lshrrev_b32 v24, 4, v1
    v_bfe_u32 v25, v1, 2, 2
    v_and_b32 v26, 3, v1
    v_and_b32 v27, 15, v1
    v_lshl_add_u32 v28, v24, 3, v25
    v_lshlrev_b32 v28, 1, v28
    v_xor_b32 v29, s44, v24
    v_and_b32 v29, 1, v29
    v_add_u32 v28, v28, v29
    v_mul_u32_u24 v28, 160, v28
    v_lshl_add_u32 v13, v26, 3, v28
    v_lshl_add_u32 v15, v26, 5, v13
    v_add_u32 v14, 51200, v13
    v_add_u32 v16, 51200, v15
    v_lshrrev_b32 v28, 1, v27
    v_xor_b32 v28, v28, v24
    v_lshlrev_b32 v28, 4, v28
    v_lshl_add_u32 v28, v27, 7, v28
    s_lshl_b32 s7, s45, 12
    s_add_u32 s7, s7, 102400
    v_add_u32 v17, s7, v28
    v_xor_b32 v18, 64, v17
    s_cmp_ge_u32 s45, 2
    s_cselect_b32 s59, 57344, 0
    v_and_b32 v28, 8, v1
    v_add_u32 v28, v28, v27
    v_lshrrev_b32 v29, 1, v1
    v_and_b32 v29, 8, v29
    v_and_b32 v30, 32, v1
    v_add3_u32 v19, v28, v29, v30
    v_lshlrev_b32 v19, 4, v19
    v_lshlrev_b32 v93, 3, v28
    s_add_u32 s7, s3, 0
    s_lshl_b32 s7, s7, 6
    v_add_u32 v28, s7, v1
    v_mul_u32_u24 v29, 6554, v28
    v_lshl_add_u32 v8, v28, 4, s56
    v_lshrrev_b32 v29, 16, v29
    v_and_b32 v30, 12, v29
    v_bfe_u32 v31, v29, 4, 1
    v_mul_u32_u24 v31, 12, v31
    v_sub_u32 v30, v30, v31
    v_mul_i32_i24 v30, 3840, v30
    v_mul_u32_u24 v29, 3680, v29
    v_add3_u32 v8, v8, v29, v30
    s_add_u32 s7, s3, 8
    s_lshl_b32 s7, s7, 6
    v_add_u32 v28, s7, v1
    v_mul_u32_u24 v29, 6554, v28
    v_lshl_add_u32 v9, v28, 4, s56
    v_lshrrev_b32 v29, 16, v29
    v_and_b32 v30, 12, v29
    v_bfe_u32 v31, v29, 4, 1
    v_mul_u32_u24 v31, 12, v31
    v_sub_u32 v30, v30, v31
    v_mul_i32_i24 v30, 3840, v30
    v_mul_u32_u24 v29, 3680, v29
    v_add3_u32 v9, v9, v29, v30
    s_add_u32 s7, s3, 16
    s_cmp_ge_u32 s7, 20
    s_cselect_b32 s57, 20, 0
    s_sub_u32 s7, s7, s57
    s_lshl_b32 s7, s7, 6
    v_add_u32 v28, s7, v1
    v_mul_u32_u24 v29, 6554, v28
    v_lshl_add_u32 v10, v28, 4, s56
    v_lshrrev_b32 v29, 16, v29
    v_and_b32 v30, 12, v29
    v_bfe_u32 v31, v29, 4, 1
    v_mul_u32_u24 v31, 12, v31
    v_sub_u32 v30, v30, v31
    v_mul_i32_i24 v30, 3840, v30
    v_mul_u32_u24 v29, 3680, v29
    v_add3_u32 v10, v10, v29, v30
    s_add_u32 s7, s3, 4
    s_lshl_b32 s7, s7, 6
    v_add_u32 v28, s7, v1
    v_mul_u32_u24 v29, 6554, v28
    v_lshl_add_u32 v11, v28, 4, s56
    v_lshrrev_b32 v29, 16, v29
    v_and_b32 v30, 12, v29
    v_bfe_u32 v31, v29, 4, 1
    v_mul_u32_u24 v31, 12, v31
    v_sub_u32 v30, v30, v31
    v_mul_i32_i24 v30, 3840, v30
    v_mul_u32_u24 v29, 3680, v29
    v_add3_u32 v11, v11, v29, v30
    s_add_u32 s7, s3, 12
    s_lshl_b32 s7, s7, 6
    v_add_u32 v28, s7, v1
    v_mul_u32_u24 v29, 6554, v28
    v_lshl_add_u32 v12, v28, 4, s56
    v_lshrrev_b32 v29, 16, v29
    v_and_b32 v30, 12, v29
    v_bfe_u32 v31, v29, 4, 1
    v_mul_u32_u24 v31, 12, v31
    v_sub_u32 v30, v30, v31
    v_mul_i32_i24 v30, 3840, v30
    v_mul_u32_u24 v29, 3680, v29
    v_add3_u32 v12, v12, v29, v30
    s_cmp_ge_u32 s3, 4
    s_cselect_b32 s56, s47, s46
    s_cselect_b32 s57, s49, s48
    s_lshl_b32 s60, s4, 3
    s_and_b32 s7, s6, 6
    s_add_u32 s60, s60, s7
    s_add_u32 s60, s60, s44
    s_lshl_b32 s60, s60, 6
    s_add_u32 s60, s60, s5
    s_lshl_b32 s60, s60, 2
    s_add_u32 s60, s60, s45
    s_mul_i32 s60, s60, 2560
    s_mov_b32 s62, -1
    s_mov_b32 s63, 0
    s_mov_b32 s7, 163840
    v_mad_u32_u24 v20, v24, s7, v93
    v_mul_u32_u24 v91, 1280, v24
    v_add_u32 v93, v93, v91
    v_lshlrev_b32 v92, 4, v1
    v_mov_b64 v[88:89], -1
    v_mov_b64 v[90:91], -1
    s_bitcmp1_b32 s6, 0
    s_cbranch_scc1 L_kv1
    s_waitcnt vmcnt(4)
    s_barrier
    ds_read_b128 v[96:99], v17 offset:8192
    ds_read_b128 v[100:103], v17 offset:10240
    ds_read_b128 v[104:107], v18 offset:8192
    ds_read_b128 v[108:111], v18 offset:10240
    ds_read_b64_tr_b16 v[24:25], v13 offset:0
    ds_read_b64_tr_b16 v[26:27], v13 offset:1280
    ds_read_b64_tr_b16 v[28:29], v13 offset:40
    ds_read_b64_tr_b16 v[30:31], v13 offset:1320
    ds_read_b64_tr_b16 v[32:33], v13 offset:80
    ds_read_b64_tr_b16 v[34:35], v13 offset:1360
    ds_read_b64_tr_b16 v[36:37], v13 offset:120
    ds_read_b64_tr_b16 v[38:39], v13 offset:1400
    ds_read_b64_tr_b16 v[40:41], v15 offset:32
    ds_read_b64_tr_b16 v[42:43], v15 offset:1312
    s_waitcnt lgkmcnt(8)
    v_mfma_f32_16x16x32_bf16 v[48:51], v[24:27], v[96:99], 0
    v_mfma_f32_16x16x32_bf16 v[52:55], v[24:27], v[100:103], 0
    s_add_u32 m0, s43, 40960
    s_nop 0
    buffer_load_dwordx4 v3, s[12:15], s47 offen lds
    ds_read_b64_tr_b16 v[44:45], v13 offset:10240
    ds_read_b64_tr_b16 v[46:47], v13 offset:11520
    s_waitcnt lgkmcnt(8)
    v_mfma_f32_16x16x32_bf16 v[56:59], v[28:31], v[96:99], 0
    v_mfma_f32_16x16x32_bf16 v[60:63], v[28:31], v[100:103], 0
    s_add_u32 m0, s43, 49152
    s_nop 0
    buffer_load_dwordx4 v4, s[12:15], s47 offen lds
    ds_read_b64_tr_b16 v[24:25], v13 offset:10280
    ds_read_b64_tr_b16 v[26:27], v13 offset:11560
    s_waitcnt lgkmcnt(8)
    v_mfma_f32_16x16x32_bf16 v[64:67], v[32:35], v[96:99], 0
    v_mfma_f32_16x16x32_bf16 v[68:71], v[32:35], v[100:103], 0
    s_add_u32 m0, s43, 57344
    s_nop 0
    buffer_load_dwordx4 v5, s[12:15], s47 offen lds
    ds_read_b64_tr_b16 v[28:29], v13 offset:10320
    ds_read_b64_tr_b16 v[30:31], v13 offset:11600
    s_waitcnt lgkmcnt(8)
    v_mfma_f32_16x16x32_bf16 v[72:75], v[36:39], v[96:99], 0
    v_mfma_f32_16x16x32_bf16 v[76:79], v[36:39], v[100:103], 0
    s_add_u32 m0, s43, 143360
    s_nop 0
    buffer_load_dwordx4 v2, s[8:11], s52 offen lds
    ds_read_b64_tr_b16 v[32:33], v13 offset:10360
    ds_read_b64_tr_b16 v[34:35], v13 offset:11640
    s_waitcnt lgkmcnt(8)
    v_mfma_f32_16x16x32_bf16 v[80:83], v[40:43], v[96:99], 0
    v_mfma_f32_16x16x32_bf16 v[84:87], v[40:43], v[100:103], 0
    s_add_u32 m0, s43, 151552
    s_add_u32 s7, s52, 81920
    buffer_load_dwordx4 v2, s[8:11], s7 offen lds
    ds_read_b64_tr_b16 v[36:37], v15 offset:10272
    ds_read_b64_tr_b16 v[38:39], v15 offset:11552
    s_waitcnt lgkmcnt(8)
    v_mfma_f32_16x16x32_bf16 v[48:51], v[44:47], v[104:107], v[48:51]
    v_mfma_f32_16x16x32_bf16 v[52:55], v[44:47], v[108:111], v[52:55]
    s_add_u32 m0, s43, 65536
    s_nop 0
    buffer_load_dwordx4 v6, s[12:15], s47 offen lds
    s_waitcnt vmcnt(6)
    s_barrier
    ds_read_b128 v[112:115], v17 offset:24576
    ds_read_b128 v[116:119], v17 offset:26624
    ds_read_b128 v[120:123], v18 offset:24576
    ds_read_b128 v[124:127], v18 offset:26624
    ds_read_b64_tr_b16 v[40:41], v13 offset:20480
    ds_read_b64_tr_b16 v[42:43], v13 offset:21760
    s_waitcnt lgkmcnt(12)
    v_mfma_f32_16x16x32_bf16 v[56:59], v[24:27], v[104:107], v[56:59]
    v_mfma_f32_16x16x32_bf16 v[60:63], v[24:27], v[108:111], v[60:63]
    s_add_u32 m0, s43, 73728
    s_nop 0
    buffer_load_dwordx4 v7, s[12:15], s47 offen lds
    ds_read_b64_tr_b16 v[44:45], v13 offset:20520
    ds_read_b64_tr_b16 v[46:47], v13 offset:21800
    s_waitcnt lgkmcnt(12)
    v_mfma_f32_16x16x32_bf16 v[64:67], v[28:31], v[104:107], v[64:67]
    v_mfma_f32_16x16x32_bf16 v[68:71], v[28:31], v[108:111], v[68:71]
    s_add_u32 m0, s43, 102400
    s_add_u32 s7, s52, 128
    buffer_load_dwordx4 v2, s[8:11], s7 offen lds
    ds_read_b64_tr_b16 v[24:25], v13 offset:20560
    ds_read_b64_tr_b16 v[26:27], v13 offset:21840
    s_waitcnt lgkmcnt(12)
    v_mfma_f32_16x16x32_bf16 v[72:75], v[32:35], v[104:107], v[72:75]
    v_mfma_f32_16x16x32_bf16 v[76:79], v[32:35], v[108:111], v[76:79]
    s_add_u32 m0, s43, 110592
    s_add_u32 s7, s52, 82048
    buffer_load_dwordx4 v2, s[8:11], s7 offen lds
    ds_read_b64_tr_b16 v[28:29], v13 offset:20600
    ds_read_b64_tr_b16 v[30:31], v13 offset:21880
    s_waitcnt lgkmcnt(12)
    v_mfma_f32_16x16x32_bf16 v[80:83], v[36:39], v[104:107], v[80:83]
    v_mfma_f32_16x16x32_bf16 v[84:87], v[36:39], v[108:111], v[84:87]
    s_add_u32 m0, s43, 81920
    s_nop 0
    buffer_load_dwordx4 v3, s[12:15], s48 offen lds
    ds_read_b64_tr_b16 v[32:33], v15 offset:20512
    ds_read_b64_tr_b16 v[34:35], v15 offset:21792
    s_waitcnt lgkmcnt(8)
    v_mfma_f32_16x16x32_bf16 v[48:51], v[40:43], v[112:115], v[48:51]
    v_mfma_f32_16x16x32_bf16 v[52:55], v[40:43], v[116:119], v[52:55]
    s_add_u32 m0, s43, 90112
    s_nop 0
    buffer_load_dwordx4 v4, s[12:15], s48 offen lds
    ds_read_b64_tr_b16 v[36:37], v13 offset:30720
    ds_read_b64_tr_b16 v[38:39], v13 offset:32000
    s_waitcnt lgkmcnt(8)
    v_mfma_f32_16x16x32_bf16 v[56:59], v[44:47], v[112:115], v[56:59]
    v_mfma_f32_16x16x32_bf16 v[60:63], v[44:47], v[116:119], v[60:63]
    s_mov_b32 m0, s58
    s_nop 0
    buffer_load_dwordx4 v5, s[12:15], s48 offen lds
    ds_read_b64_tr_b16 v[40:41], v13 offset:30760
    ds_read_b64_tr_b16 v[42:43], v13 offset:32040
    s_waitcnt lgkmcnt(8)
    v_mfma_f32_16x16x32_bf16 v[64:67], v[24:27], v[112:115], v[64:67]
    v_mfma_f32_16x16x32_bf16 v[68:71], v[24:27], v[116:119], v[68:71]
    s_add_u32 m0, s43, 118784
    s_nop 0
    buffer_load_dwordx4 v2, s[8:11], s53 offen lds
    ds_read_b64_tr_b16 v[44:45], v13 offset:30800
    ds_read_b64_tr_b16 v[46:47], v13 offset:32080
    s_waitcnt lgkmcnt(8)
    v_mfma_f32_16x16x32_bf16 v[72:75], v[28:31], v[112:115], v[72:75]
    v_mfma_f32_16x16x32_bf16 v[76:79], v[28:31], v[116:119], v[76:79]
    ds_read_b64_tr_b16 v[24:25], v13 offset:30840
    ds_read_b64_tr_b16 v[26:27], v13 offset:32120
    s_waitcnt lgkmcnt(8)
    v_mfma_f32_16x16x32_bf16 v[80:83], v[32:35], v[112:115], v[80:83]
    v_mfma_f32_16x16x32_bf16 v[84:87], v[32:35], v[116:119], v[84:87]
    ds_read_b64_tr_b16 v[28:29], v15 offset:30752
    ds_read_b64_tr_b16 v[30:31], v15 offset:32032
    s_waitcnt lgkmcnt(8)
    v_mfma_f32_16x16x32_bf16 v[48:51], v[36:39], v[120:123], v[48:51]
    v_mfma_f32_16x16x32_bf16 v[52:55], v[36:39], v[124:127], v[52:55]
    s_waitcnt vmcnt(8)
    s_barrier
    ds_read_b128 v[128:131], v17 offset:40960
    ds_read_b128 v[132:135], v17 offset:43008
    ds_read_b128 v[136:139], v18 offset:40960
    ds_read_b128 v[140:143], v18 offset:43008
    ds_read_b64_tr_b16 v[32:33], v13 offset:40960
    ds_read_b64_tr_b16 v[34:35], v13 offset:42240
    s_waitcnt lgkmcnt(12)
    v_mfma_f32_16x16x32_bf16 v[56:59], v[40:43], v[120:123], v[56:59]
    v_mfma_f32_16x16x32_bf16 v[60:63], v[40:43], v[124:127], v[60:63]
    s_add_u32 m0, s43, 126976
    s_add_u32 s7, s53, 81920
    buffer_load_dwordx4 v2, s[8:11], s7 offen lds
    ds_read_b64_tr_b16 v[36:37], v13 offset:41000
    ds_read_b64_tr_b16 v[38:39], v13 offset:42280
    s_waitcnt lgkmcnt(12)
    v_mfma_f32_16x16x32_bf16 v[64:67], v[44:47], v[120:123], v[64:67]
    v_mfma_f32_16x16x32_bf16 v[68:71], v[44:47], v[124:127], v[68:71]
    s_add_u32 m0, s43, 4096
    s_nop 0
    buffer_load_dwordx4 v6, s[12:15], s48 offen lds
    ds_read_b64_tr_b16 v[40:41], v13 offset:41040
    ds_read_b64_tr_b16 v[42:43], v13 offset:42320
    s_waitcnt lgkmcnt(12)
    v_mfma_f32_16x16x32_bf16 v[72:75], v[24:27], v[120:123], v[72:75]
    v_mfma_f32_16x16x32_bf16 v[76:79], v[24:27], v[124:127], v[76:79]
    s_add_u32 m0, s43, 12288
    s_nop 0
    buffer_load_dwordx4 v7, s[12:15], s48 offen lds
    ds_read_b64_tr_b16 v[44:45], v13 offset:41080
    ds_read_b64_tr_b16 v[46:47], v13 offset:42360
    s_waitcnt lgkmcnt(12)
    v_mfma_f32_16x16x32_bf16 v[80:83], v[28:31], v[120:123], v[80:83]
    v_mfma_f32_16x16x32_bf16 v[84:87], v[28:31], v[124:127], v[84:87]
    s_add_u32 m0, s43, 135168
    s_add_u32 s7, s53, 128
    buffer_load_dwordx4 v2, s[8:11], s7 offen lds
    ds_read_b64_tr_b16 v[24:25], v15 offset:40992
    ds_read_b64_tr_b16 v[26:27], v15 offset:42272
    s_waitcnt lgkmcnt(8)
    v_mfma_f32_16x16x32_bf16 v[48:51], v[32:35], v[128:131], v[48:51]
    v_mfma_f32_16x16x32_bf16 v[52:55], v[32:35], v[132:135], v[52:55]
    ds_read_b64_tr_b16 v[28:29], v14 offset:0
    ds_read_b64_tr_b16 v[30:31], v14 offset:1280
    s_waitcnt lgkmcnt(8)
    v_mfma_f32_16x16x32_bf16 v[56:59], v[36:39], v[128:131], v[56:59]
    v_mfma_f32_16x16x32_bf16 v[60:63], v[36:39], v[132:135], v[60:63]
    ds_read_b64_tr_b16 v[32:33], v14 offset:40
    ds_read_b64_tr_b16 v[34:35], v14 offset:1320
    s_waitcnt lgkmcnt(8)
    v_mfma_f32_16x16x32_bf16 v[64:67], v[40:43], v[128:131], v[64:67]
    v_mfma_f32_16x16x32_bf16 v[68:71], v[40:43], v[132:135], v[68:71]
    ds_read_b64_tr_b16 v[36:37], v14 offset:80
    ds_read_b64_tr_b16 v[38:39], v14 offset:1360
    s_waitcnt lgkmcnt(8)
    v_mfma_f32_16x16x32_bf16 v[72:75], v[44:47], v[128:131], v[72:75]
    v_mfma_f32_16x16x32_bf16 v[76:79], v[44:47], v[132:135], v[76:79]
    ds_read_b64_tr_b16 v[40:41], v14 offset:120
    ds_read_b64_tr_b16 v[42:43], v14 offset:1400
    s_waitcnt lgkmcnt(8)
    v_mfma_f32_16x16x32_bf16 v[80:83], v[24:27], v[128:131], v[80:83]
    v_mfma_f32_16x16x32_bf16 v[84:87], v[24:27], v[132:135], v[84:87]
    ds_read_b64_tr_b16 v[44:45], v16 offset:32
    ds_read_b64_tr_b16 v[46:47], v16 offset:1312
    s_waitcnt lgkmcnt(8)
    v_mfma_f32_16x16x32_bf16 v[48:51], v[28:31], v[136:139], v[48:51]
    v_mfma_f32_16x16x32_bf16 v[52:55], v[28:31], v[140:143], v[52:55]
    s_waitcnt vmcnt(8)
    s_barrier
    ds_read_b128 v[144:147], v17 offset:0
    ds_read_b128 v[148:151], v17 offset:2048
    ds_read_b128 v[152:155], v18 offset:0
    ds_read_b128 v[156:159], v18 offset:2048
    ds_read_b64_tr_b16 v[24:25], v14 offset:10240
    ds_read_b64_tr_b16 v[26:27], v14 offset:11520
    s_waitcnt lgkmcnt(12)
    v_mfma_f32_16x16x32_bf16 v[56:59], v[32:35], v[136:139], v[56:59]
    v_mfma_f32_16x16x32_bf16 v[60:63], v[32:35], v[140:143], v[60:63]
    s_add_u32 m0, s43, 143360
    s_add_u32 s7, s53, 82048
    buffer_load_dwordx4 v2, s[8:11], s7 offen lds
    ds_read_b64_tr_b16 v[28:29], v14 offset:10280
    ds_read_b64_tr_b16 v[30:31], v14 offset:11560
    s_waitcnt lgkmcnt(12)
    v_mfma_f32_16x16x32_bf16 v[64:67], v[36:39], v[136:139], v[64:67]
    v_mfma_f32_16x16x32_bf16 v[68:71], v[36:39], v[140:143], v[68:71]
    s_add_u32 m0, s43, 20480
    s_nop 0
    buffer_load_dwordx4 v3, s[12:15], s49 offen lds
    ds_read_b64_tr_b16 v[32:33], v14 offset:10320
    ds_read_b64_tr_b16 v[34:35], v14 offset:11600
    s_waitcnt lgkmcnt(12)
    v_mfma_f32_16x16x32_bf16 v[72:75], v[40:43], v[136:139], v[72:75]
    v_mfma_f32_16x16x32_bf16 v[76:79], v[40:43], v[140:143], v[76:79]
    s_add_u32 m0, s43, 28672
    s_nop 0
    buffer_load_dwordx4 v4, s[12:15], s49 offen lds
    ds_read_b64_tr_b16 v[36:37], v14 offset:10360
    ds_read_b64_tr_b16 v[38:39], v14 offset:11640
    s_waitcnt lgkmcnt(12)
    v_mfma_f32_16x16x32_bf16 v[80:83], v[44:47], v[136:139], v[80:83]
    v_mfma_f32_16x16x32_bf16 v[84:87], v[44:47], v[140:143], v[84:87]
    s_add_u32 m0, s43, 36864
    s_nop 0
    buffer_load_dwordx4 v5, s[12:15], s49 offen lds
    ds_read_b64_tr_b16 v[40:41], v16 offset:10272
    ds_read_b64_tr_b16 v[42:43], v16 offset:11552
    s_waitcnt lgkmcnt(8)
    v_mfma_f32_16x16x32_bf16 v[48:51], v[24:27], v[144:147], v[48:51]
    v_mfma_f32_16x16x32_bf16 v[52:55], v[24:27], v[148:151], v[52:55]
    s_add_u32 m0, s43, 151552
    s_nop 0
    buffer_load_dwordx4 v2, s[8:11], s54 offen lds
    ds_read_b64_tr_b16 v[44:45], v14 offset:20480
    ds_read_b64_tr_b16 v[46:47], v14 offset:21760
    s_waitcnt lgkmcnt(8)
    v_mfma_f32_16x16x32_bf16 v[56:59], v[28:31], v[144:147], v[56:59]
    v_mfma_f32_16x16x32_bf16 v[60:63], v[28:31], v[148:151], v[60:63]
    ds_read_b64_tr_b16 v[24:25], v14 offset:20520
    ds_read_b64_tr_b16 v[26:27], v14 offset:21800
    s_waitcnt lgkmcnt(8)
    v_mfma_f32_16x16x32_bf16 v[64:67], v[32:35], v[144:147], v[64:67]
    v_mfma_f32_16x16x32_bf16 v[68:71], v[32:35], v[148:151], v[68:71]
    ds_read_b64_tr_b16 v[28:29], v14 offset:20560
    ds_read_b64_tr_b16 v[30:31], v14 offset:21840
    s_waitcnt lgkmcnt(8)
    v_mfma_f32_16x16x32_bf16 v[72:75], v[36:39], v[144:147], v[72:75]
    v_mfma_f32_16x16x32_bf16 v[76:79], v[36:39], v[148:151], v[76:79]
    ds_read_b64_tr_b16 v[32:33], v14 offset:20600
    ds_read_b64_tr_b16 v[34:35], v14 offset:21880
    s_waitcnt lgkmcnt(8)
    v_mfma_f32_16x16x32_bf16 v[80:83], v[40:43], v[144:147], v[80:83]
    v_mfma_f32_16x16x32_bf16 v[84:87], v[40:43], v[148:151], v[84:87]
    ds_read_b64_tr_b16 v[36:37], v16 offset:20512
    ds_read_b64_tr_b16 v[38:39], v16 offset:21792
    s_waitcnt lgkmcnt(8)
    v_mfma_f32_16x16x32_bf16 v[48:51], v[44:47], v[152:155], v[48:51]
    v_mfma_f32_16x16x32_bf16 v[52:55], v[44:47], v[156:159], v[52:55]
    s_waitcnt vmcnt(8)
    s_barrier
    ds_read_b128 v[160:163], v17 offset:16384
    ds_read_b128 v[164:167], v17 offset:18432
    ds_read_b128 v[168:171], v18 offset:16384
    ds_read_b128 v[172:175], v18 offset:18432
    ds_read_b64_tr_b16 v[40:41], v14 offset:30720
    ds_read_b64_tr_b16 v[42:43], v14 offset:32000
    s_waitcnt lgkmcnt(12)
    v_mfma_f32_16x16x32_bf16 v[56:59], v[24:27], v[152:155], v[56:59]
    v_mfma_f32_16x16x32_bf16 v[60:63], v[24:27], v[156:159], v[60:63]
    s_add_u32 m0, s43, 102400
    s_add_u32 s7, s54, 81920
    buffer_load_dwordx4 v2, s[8:11], s7 offen lds
    ds_read_b64_tr_b16 v[44:45], v14 offset:30760
    ds_read_b64_tr_b16 v[46:47], v14 offset:32040
    s_waitcnt lgkmcnt(12)
    v_mfma_f32_16x16x32_bf16 v[64:67], v[28:31], v[152:155], v[64:67]
    v_mfma_f32_16x16x32_bf16 v[68:71], v[28:31], v[156:159], v[68:71]
    s_add_u32 m0, s43, 45056
    s_nop 0
    buffer_load_dwordx4 v6, s[12:15], s49 offen lds
    ds_read_b64_tr_b16 v[24:25], v14 offset:30800
    ds_read_b64_tr_b16 v[26:27], v14 offset:32080
    s_waitcnt lgkmcnt(12)
    v_mfma_f32_16x16x32_bf16 v[72:75], v[32:35], v[152:155], v[72:75]
    v_mfma_f32_16x16x32_bf16 v[76:79], v[32:35], v[156:159], v[76:79]
    s_add_u32 m0, s43, 53248
    s_nop 0
    buffer_load_dwordx4 v7, s[12:15], s49 offen lds
    ds_read_b64_tr_b16 v[28:29], v14 offset:30840
    ds_read_b64_tr_b16 v[30:31], v14 offset:32120
    s_waitcnt lgkmcnt(12)
    v_mfma_f32_16x16x32_bf16 v[80:83], v[36:39], v[152:155], v[80:83]
    v_mfma_f32_16x16x32_bf16 v[84:87], v[36:39], v[156:159], v[84:87]
    s_add_u32 m0, s43, 110592
    s_add_u32 s7, s54, 128
    buffer_load_dwordx4 v2, s[8:11], s7 offen lds
    ds_read_b64_tr_b16 v[32:33], v16 offset:30752
    ds_read_b64_tr_b16 v[34:35], v16 offset:32032
    s_waitcnt lgkmcnt(8)
    v_mfma_f32_16x16x32_bf16 v[48:51], v[40:43], v[160:163], v[48:51]
    v_mfma_f32_16x16x32_bf16 v[52:55], v[40:43], v[164:167], v[52:55]
    ds_read_b64_tr_b16 v[36:37], v14 offset:40960
    ds_read_b64_tr_b16 v[38:39], v14 offset:42240
    s_waitcnt lgkmcnt(8)
    v_mfma_f32_16x16x32_bf16 v[56:59], v[44:47], v[160:163], v[56:59]
    v_mfma_f32_16x16x32_bf16 v[60:63], v[44:47], v[164:167], v[60:63]
    ds_read_b64_tr_b16 v[40:41], v14 offset:41000
    ds_read_b64_tr_b16 v[42:43], v14 offset:42280
    s_waitcnt lgkmcnt(8)
    v_mfma_f32_16x16x32_bf16 v[64:67], v[24:27], v[160:163], v[64:67]
    v_mfma_f32_16x16x32_bf16 v[68:71], v[24:27], v[164:167], v[68:71]
    ds_read_b64_tr_b16 v[44:45], v14 offset:41040
    ds_read_b64_tr_b16 v[46:47], v14 offset:42320
    s_waitcnt lgkmcnt(8)
    v_mfma_f32_16x16x32_bf16 v[72:75], v[28:31], v[160:163], v[72:75]
    v_mfma_f32_16x16x32_bf16 v[76:79], v[28:31], v[164:167], v[76:79]
    ds_read_b64_tr_b16 v[24:25], v14 offset:41080
    ds_read_b64_tr_b16 v[26:27], v14 offset:42360
    s_waitcnt lgkmcnt(8)
    v_mfma_f32_16x16x32_bf16 v[80:83], v[32:35], v[160:163], v[80:83]
    v_mfma_f32_16x16x32_bf16 v[84:87], v[32:35], v[164:167], v[84:87]
    ds_read_b64_tr_b16 v[28:29], v16 offset:40992
    ds_read_b64_tr_b16 v[30:31], v16 offset:42272
    s_waitcnt lgkmcnt(8)
    v_mfma_f32_16x16x32_bf16 v[48:51], v[36:39], v[168:171], v[48:51]
    v_mfma_f32_16x16x32_bf16 v[52:55], v[36:39], v[172:175], v[52:55]
    s_or_b32 s7, s3, s42
    s_cbranch_scc1 L_nocl2_0
    v_subrev_co_u32 v22, vcc, s38, v22
    v_mov_b32 v22, s39
    s_nop 0
    v_subb_co_u32 v23, vcc, v23, v22, vcc
    s_mov_b64 exec, 1
    ds_write_b32 v21, v23
    s_mov_b64 exec, -1
    s_waitcnt lgkmcnt(0)
L_nocl2_0:
    s_add_u32 s58, s43, 57344
    s_add_u32 s7, s43, 98304
    s_cmp_ge_u32 s3, 4
    s_cselect_b32 s58, s7, s58
    s_waitcnt vmcnt(8)
    s_barrier
    ds_read_b32 v22, v21
    ds_read_b128 v[176:179], v17 offset:32768
    ds_read_b128 v[180:183], v17 offset:34816
    ds_read_b128 v[184:187], v18 offset:32768
    ds_read_b128 v[188:191], v18 offset:34816
    ds_read_b64_tr_b16 v[32:33], v13 offset:0
    ds_read_b64_tr_b16 v[34:35], v13 offset:1280
    s_waitcnt lgkmcnt(13)
    v_mfma_f32_16x16x32_bf16 v[56:59], v[40:43], v[168:171], v[56:59]
    v_mfma_f32_16x16x32_bf16 v[60:63], v[40:43], v[172:175], v[60:63]
    s_add_u32 m0, s43, 118784
    s_add_u32 s7, s54, 82048
    buffer_load_dwordx4 v2, s[8:11], s7 offen lds
    ds_read_b64_tr_b16 v[36:37], v13 offset:40
    ds_read_b64_tr_b16 v[38:39], v13 offset:1320
    s_waitcnt lgkmcnt(13)
    v_mfma_f32_16x16x32_bf16 v[64:67], v[44:47], v[168:171], v[64:67]
    v_mfma_f32_16x16x32_bf16 v[68:71], v[44:47], v[172:175], v[68:71]
    s_add_u32 m0, s43, 61440
    s_nop 0
    buffer_load_dwordx4 v3, s[12:15], s50 offen lds
    ds_read_b64_tr_b16 v[40:41], v13 offset:80
    ds_read_b64_tr_b16 v[42:43], v13 offset:1360
    s_waitcnt lgkmcnt(13)
    v_mfma_f32_16x16x32_bf16 v[72:75], v[24:27], v[168:171], v[72:75]
    v_mfma_f32_16x16x32_bf16 v[76:79], v[24:27], v[172:175], v[76:79]
    s_add_u32 m0, s43, 69632
    s_nop 0
    buffer_load_dwordx4 v4, s[12:15], s50 offen lds
    ds_read_b64_tr_b16 v[44:45], v13 offset:120
    ds_read_b64_tr_b16 v[46:47], v13 offset:1400
    s_waitcnt lgkmcnt(13)
    v_mfma_f32_16x16x32_bf16 v[80:83], v[28:31], v[168:171], v[80:83]
    v_mfma_f32_16x16x32_bf16 v[84:87], v[28:31], v[172:175], v[84:87]
    s_add_u32 m0, s43, 77824
    s_nop 0
    buffer_load_dwordx4 v5, s[12:15], s50 offen lds
    ds_read_b64_tr_b16 v[24:25], v15 offset:32
    ds_read_b64_tr_b16 v[26:27], v15 offset:1312
    s_waitcnt lgkmcnt(8)
    v_mfma_f32_16x16x32_bf16 v[48:51], v[32:35], v[176:179], v[48:51]
    v_mfma_f32_16x16x32_bf16 v[52:55], v[32:35], v[180:183], v[52:55]
    s_add_u32 m0, s43, 126976
    s_nop 0
    buffer_load_dwordx4 v2, s[8:11], s55 offen lds
    ds_read_b64_tr_b16 v[28:29], v13 offset:10240
    ds_read_b64_tr_b16 v[30:31], v13 offset:11520
    s_waitcnt lgkmcnt(8)
    v_mfma_f32_16x16x32_bf16 v[56:59], v[36:39], v[176:179], v[56:59]
    v_mfma_f32_16x16x32_bf16 v[60:63], v[36:39], v[180:183], v[60:63]
    ds_read_b64_tr_b16 v[32:33], v13 offset:10280
    ds_read_b64_tr_b16 v[34:35], v13 offset:11560
    s_waitcnt lgkmcnt(8)
    v_mfma_f32_16x16x32_bf16 v[64:67], v[40:43], v[176:179], v[64:67]
    v_mfma_f32_16x16x32_bf16 v[68:71], v[40:43], v[180:183], v[68:71]
    ds_read_b64_tr_b16 v[36:37], v13 offset:10320
    ds_read_b64_tr_b16 v[38:39], v13 offset:11600
    s_waitcnt lgkmcnt(8)
    v_mfma_f32_16x16x32_bf16 v[72:75], v[44:47], v[176:179], v[72:75]
    v_mfma_f32_16x16x32_bf16 v[76:79], v[44:47], v[180:183], v[76:79]
    ds_read_b64_tr_b16 v[40:41], v13 offset:10360
    ds_read_b64_tr_b16 v[42:43], v13 offset:11640
    s_waitcnt lgkmcnt(8)
    v_mfma_f32_16x16x32_bf16 v[80:83], v[24:27], v[176:179], v[80:83]
    v_mfma_f32_16x16x32_bf16 v[84:87], v[24:27], v[180:183], v[84:87]
    ds_read_b64_tr_b16 v[44:45], v15 offset:10272
    ds_read_b64_tr_b16 v[46:47], v15 offset:11552
    s_waitcnt lgkmcnt(8)
    v_mfma_f32_16x16x32_bf16 v[48:51], v[28:31], v[184:187], v[48:51]
    v_mfma_f32_16x16x32_bf16 v[52:55], v[28:31], v[188:191], v[52:55]
    s_waitcnt vmcnt(8)
    s_barrier
    v_subrev_u32 v17, s59, v17
    v_subrev_u32 v18, s59, v18
    ds_read_b128 v[192:195], v17 offset:49152
    ds_read_b128 v[196:199], v17 offset:51200
    ds_read_b128 v[200:203], v18 offset:49152
    ds_read_b128 v[204:207], v18 offset:51200
    ds_read_b64_tr_b16 v[24:25], v13 offset:20480
    ds_read_b64_tr_b16 v[26:27], v13 offset:21760
    s_waitcnt lgkmcnt(12)
    v_mfma_f32_16x16x32_bf16 v[56:59], v[32:35], v[184:187], v[56:59]
    v_mfma_f32_16x16x32_bf16 v[60:63], v[32:35], v[188:191], v[60:63]
    s_add_u32 m0, s43, 135168
    s_add_u32 s7, s55, 81920
    buffer_load_dwordx4 v2, s[8:11], s7 offen lds
    ds_read_b64_tr_b16 v[28:29], v13 offset:20520
    ds_read_b64_tr_b16 v[30:31], v13 offset:21800
    s_waitcnt lgkmcnt(12)
    v_mfma_f32_16x16x32_bf16 v[64:67], v[36:39], v[184:187], v[64:67]
    v_mfma_f32_16x16x32_bf16 v[68:71], v[36:39], v[188:191], v[68:71]
    s_add_u32 m0, s43, 86016
    s_nop 0
    buffer_load_dwordx4 v6, s[12:15], s50 offen lds
    ds_read_b64_tr_b16 v[32:33], v13 offset:20560
    ds_read_b64_tr_b16 v[34:35], v13 offset:21840
    s_waitcnt lgkmcnt(12)
    v_mfma_f32_16x16x32_bf16 v[72:75], v[40:43], v[184:187], v[72:75]
    v_mfma_f32_16x16x32_bf16 v[76:79], v[40:43], v[188:191], v[76:79]
    s_add_u32 m0, s43, 94208
    s_nop 0
    buffer_load_dwordx4 v7, s[12:15], s50 offen lds
    ds_read_b64_tr_b16 v[36:37], v13 offset:20600
    ds_read_b64_tr_b16 v[38:39], v13 offset:21880
    s_waitcnt lgkmcnt(12)
    v_mfma_f32_16x16x32_bf16 v[80:83], v[44:47], v[184:187], v[80:83]
    v_mfma_f32_16x16x32_bf16 v[84:87], v[44:47], v[188:191], v[84:87]
    s_add_u32 m0, s43, 143360
    s_add_u32 s7, s55, 128
    buffer_load_dwordx4 v2, s[8:11], s7 offen lds
    ds_read_b64_tr_b16 v[40:41], v15 offset:20512
    ds_read_b64_tr_b16 v[42:43], v15 offset:21792
    s_waitcnt lgkmcnt(8)
    v_mfma_f32_16x16x32_bf16 v[48:51], v[24:27], v[192:195], v[48:51]
    v_mfma_f32_16x16x32_bf16 v[52:55], v[24:27], v[196:199], v[52:55]
    s_add_u32 m0, s43, 0
    s_nop 0
    buffer_load_dwordx4 v8, s[12:15], s46 offen lds
    v_readfirstlane_b32 s7, v22
    s_or_b32 s7, s7, s42
    s_cbranch_scc0 L_lost
    ds_read_b64_tr_b16 v[44:45], v13 offset:30720
    ds_read_b64_tr_b16 v[46:47], v13 offset:32000
    s_waitcnt lgkmcnt(8)
    v_mfma_f32_16x16x32_bf16 v[56:59], v[28:31], v[192:195], v[56:59]
    v_mfma_f32_16x16x32_bf16 v[60:63], v[28:31], v[196:199], v[60:63]
    s_lshl_b32 s16, s5, 1
    s_add_u32 s16, s16, s4
    s_lshl_b32 s16, s16, 1
    s_add_u32 s16, s16, s44
    s_lshl_b32 s16, s16, 3
    s_add_u32 s16, s16, s6
    s_lshl_b32 s16, s16, 2
    s_add_u32 s16, s16, s45
    ds_read_b64_tr_b16 v[24:25], v13 offset:30760
    ds_read_b64_tr_b16 v[26:27], v13 offset:32040
    s_waitcnt lgkmcnt(8)
    v_mfma_f32_16x16x32_bf16 v[64:67], v[32:35], v[192:195], v[64:67]
    v_mfma_f32_16x16x32_bf16 v[68:71], v[32:35], v[196:199], v[68:71]
    s_mul_i32 s16, s16, 1280
    s_add_u32 s16, s16, 13107200
    s_lshl_b32 s17, s41, 3
    s_add_u32 s17, s17, s3
    s_mul_i32 s17, s17, 1280
    s_add_u32 s17, s17, 10485760
    ds_read_b64_tr_b16 v[28:29], v13 offset:30800
    ds_read_b64_tr_b16 v[30:31], v13 offset:32080
    s_waitcnt lgkmcnt(8)
    v_mfma_f32_16x16x32_bf16 v[72:75], v[36:39], v[192:195], v[72:75]
    v_mfma_f32_16x16x32_bf16 v[76:79], v[36:39], v[196:199], v[76:79]
    ds_read_b64_tr_b16 v[32:33], v13 offset:30840
    ds_read_b64_tr_b16 v[34:35], v13 offset:32120
    s_waitcnt lgkmcnt(8)
    v_mfma_f32_16x16x32_bf16 v[80:83], v[40:43], v[192:195], v[80:83]
    v_mfma_f32_16x16x32_bf16 v[84:87], v[40:43], v[196:199], v[84:87]
    ds_read_b64_tr_b16 v[36:37], v15 offset:30752
    ds_read_b64_tr_b16 v[38:39], v15 offset:32032
    s_waitcnt lgkmcnt(8)
    v_mfma_f32_16x16x32_bf16 v[48:51], v[44:47], v[200:203], v[48:51]
    v_mfma_f32_16x16x32_bf16 v[52:55], v[44:47], v[204:207], v[52:55]
    s_waitcnt vmcnt(9)
    s_barrier
    v_add_u32 v17, s59, v17
    v_add_u32 v18, s59, v18
    ds_read_b128 v[208:211], v17 offset:8192
    ds_read_b128 v[212:215], v17 offset:10240
    ds_read_b128 v[216:219], v18 offset:8192
    ds_read_b128 v[220:223], v18 offset:10240
    ds_read_b64_tr_b16 v[40:41], v13 offset:40960
    ds_read_b64_tr_b16 v[42:43], v13 offset:42240
    s_waitcnt lgkmcnt(12)
    v_mfma_f32_16x16x32_bf16 v[56:59], v[24:27], v[200:203], v[56:59]
    v_mfma_f32_16x16x32_bf16 v[60:63], v[24:27], v[204:207], v[60:63]
    s_add_u32 m0, s43, 151552
    s_add_u32 s7, s55, 82048
    buffer_load_dwordx4 v2, s[8:11], s7 offen lds
    ds_read_b64_tr_b16 v[44:45], v13 offset:41000
    ds_read_b64_tr_b16 v[46:47], v13 offset:42280
    s_waitcnt lgkmcnt(12)
    v_mfma_f32_16x16x32_bf16 v[64:67], v[28:31], v[200:203], v[64:67]
    v_mfma_f32_16x16x32_bf16 v[68:71], v[28:31], v[204:207], v[68:71]
    s_add_u32 m0, s43, 8192
    s_nop 0
    buffer_load_dwordx4 v9, s[12:15], s46 offen lds
    ds_read_b64_tr_b16 v[24:25], v13 offset:41040
    ds_read_b64_tr_b16 v[26:27], v13 offset:42320
    s_waitcnt lgkmcnt(12)
    v_mfma_f32_16x16x32_bf16 v[72:75], v[32:35], v[200:203], v[72:75]
    v_mfma_f32_16x16x32_bf16 v[76:79], v[32:35], v[204:207], v[76:79]
    s_add_u32 m0, s43, 16384
    s_nop 0
    buffer_load_dwordx4 v10, s[12:15], s56 offen lds
    ds_read_b64_tr_b16 v[28:29], v13 offset:41080
    ds_read_b64_tr_b16 v[30:31], v13 offset:42360
    s_waitcnt lgkmcnt(12)
    v_mfma_f32_16x16x32_bf16 v[80:83], v[36:39], v[200:203], v[80:83]
    v_mfma_f32_16x16x32_bf16 v[84:87], v[36:39], v[204:207], v[84:87]
    ds_read_b64_tr_b16 v[32:33], v15 offset:40992
    ds_read_b64_tr_b16 v[34:35], v15 offset:42272
    s_waitcnt lgkmcnt(8)
    v_mfma_f32_16x16x32_bf16 v[48:51], v[40:43], v[208:211], v[48:51]
    v_mfma_f32_16x16x32_bf16 v[52:55], v[40:43], v[212:215], v[52:55]
    ds_read_b64_tr_b16 v[36:37], v14 offset:0
    ds_read_b64_tr_b16 v[38:39], v14 offset:1280
    s_waitcnt lgkmcnt(8)
    v_mfma_f32_16x16x32_bf16 v[56:59], v[44:47], v[208:211], v[56:59]
    v_mfma_f32_16x16x32_bf16 v[60:63], v[44:47], v[212:215], v[60:63]
    ds_read_b64_tr_b16 v[40:41], v14 offset:40
    ds_read_b64_tr_b16 v[42:43], v14 offset:1320
    s_waitcnt lgkmcnt(8)
    v_mfma_f32_16x16x32_bf16 v[64:67], v[24:27], v[208:211], v[64:67]
    v_mfma_f32_16x16x32_bf16 v[68:71], v[24:27], v[212:215], v[68:71]
    ds_read_b64_tr_b16 v[44:45], v14 offset:80
    ds_read_b64_tr_b16 v[46:47], v14 offset:1360
    s_waitcnt lgkmcnt(8)
    v_mfma_f32_16x16x32_bf16 v[72:75], v[28:31], v[208:211], v[72:75]
    v_mfma_f32_16x16x32_bf16 v[76:79], v[28:31], v[212:215], v[76:79]
    ds_read_b64_tr_b16 v[24:25], v14 offset:120
    ds_read_b64_tr_b16 v[26:27], v14 offset:1400
    s_waitcnt lgkmcnt(8)
    v_mfma_f32_16x16x32_bf16 v[80:83], v[32:35], v[208:211], v[80:83]
    v_mfma_f32_16x16x32_bf16 v[84:87], v[32:35], v[212:215], v[84:87]
    ds_read_b64_tr_b16 v[28:29], v16 offset:32
    ds_read_b64_tr_b16 v[30:31], v16 offset:1312
    s_waitcnt lgkmcnt(8)
    v_mfma_f32_16x16x32_bf16 v[48:51], v[36:39], v[216:219], v[48:51]
    v_mfma_f32_16x16x32_bf16 v[52:55], v[36:39], v[220:223], v[52:55]
    s_waitcnt vmcnt(7)
    s_barrier
    ds_read_b128 v[224:227], v17 offset:24576
    ds_read_b128 v[228:231], v17 offset:26624
    ds_read_b128 v[232:235], v18 offset:24576
    ds_read_b128 v[236:239], v18 offset:26624
    ds_read_b64_tr_b16 v[32:33], v14 offset:10240
    ds_read_b64_tr_b16 v[34:35], v14 offset:11520
    s_waitcnt lgkmcnt(12)
    v_mfma_f32_16x16x32_bf16 v[56:59], v[40:43], v[216:219], v[56:59]
    v_mfma_f32_16x16x32_bf16 v[60:63], v[40:43], v[220:223], v[60:63]
    s_add_u32 m0, s43, 24576
    s_nop 0
    buffer_load_dwordx4 v11, s[12:15], s47 offen lds
    ds_read_b64_tr_b16 v[36:37], v14 offset:10280
    ds_read_b64_tr_b16 v[38:39], v14 offset:11560
    s_waitcnt lgkmcnt(12)
    v_mfma_f32_16x16x32_bf16 v[64:67], v[44:47], v[216:219], v[64:67]
    v_mfma_f32_16x16x32_bf16 v[68:71], v[44:47], v[220:223], v[68:71]
    s_add_u32 m0, s43, 32768
    s_nop 0
    buffer_load_dwordx4 v12, s[12:15], s47 offen lds
    ds_read_b64_tr_b16 v[40:41], v14 offset:10320
    ds_read_b64_tr_b16 v[42:43], v14 offset:11600
    s_waitcnt lgkmcnt(12)
    v_mfma_f32_16x16x32_bf16 v[72:75], v[24:27], v[216:219], v[72:75]
    v_mfma_f32_16x16x32_bf16 v[76:79], v[24:27], v[220:223], v[76:79]
    s_add_u32 m0, s43, 40960
    s_nop 0
    buffer_load_dwordx4 v8, s[12:15], s48 offen lds
    ds_read_b64_tr_b16 v[44:45], v14 offset:10360
    ds_read_b64_tr_b16 v[46:47], v14 offset:11640
    s_waitcnt lgkmcnt(12)
    v_mfma_f32_16x16x32_bf16 v[80:83], v[28:31], v[216:219], v[80:83]
    v_mfma_f32_16x16x32_bf16 v[84:87], v[28:31], v[220:223], v[84:87]
    ds_read_b64_tr_b16 v[24:25], v16 offset:10272
    ds_read_b64_tr_b16 v[26:27], v16 offset:11552
    s_waitcnt lgkmcnt(8)
    v_mfma_f32_16x16x32_bf16 v[48:51], v[32:35], v[224:227], v[48:51]
    v_mfma_f32_16x16x32_bf16 v[52:55], v[32:35], v[228:231], v[52:55]
    ds_read_b64_tr_b16 v[28:29], v14 offset:20480
    ds_read_b64_tr_b16 v[30:31], v14 offset:21760
    s_waitcnt lgkmcnt(8)
    v_mfma_f32_16x16x32_bf16 v[56:59], v[36:39], v[224:227], v[56:59]
    v_mfma_f32_16x16x32_bf16 v[60:63], v[36:39], v[228:231], v[60:63]
    ds_read_b64_tr_b16 v[32:33], v14 offset:20520
    ds_read_b64_tr_b16 v[34:35], v14 offset:21800
    s_waitcnt lgkmcnt(8)
    v_mfma_f32_16x16x32_bf16 v[64:67], v[40:43], v[224:227], v[64:67]
    v_mfma_f32_16x16x32_bf16 v[68:71], v[40:43], v[228:231], v[68:71]
    ds_read_b64_tr_b16 v[36:37], v14 offset:20560
    ds_read_b64_tr_b16 v[38:39], v14 offset:21840
    s_waitcnt lgkmcnt(8)
    v_mfma_f32_16x16x32_bf16 v[72:75], v[44:47], v[224:227], v[72:75]
    v_mfma_f32_16x16x32_bf16 v[76:79], v[44:47], v[228:231], v[76:79]
    ds_read_b64_tr_b16 v[40:41], v14 offset:20600
    ds_read_b64_tr_b16 v[42:43], v14 offset:21880
    s_waitcnt lgkmcnt(8)
    v_mfma_f32_16x16x32_bf16 v[80:83], v[24:27], v[224:227], v[80:83]
    v_mfma_f32_16x16x32_bf16 v[84:87], v[24:27], v[228:231], v[84:87]
    ds_read_b64_tr_b16 v[44:45], v16 offset:20512
    ds_read_b64_tr_b16 v[46:47], v16 offset:21792
    s_waitcnt lgkmcnt(8)
    v_mfma_f32_16x16x32_bf16 v[48:51], v[28:31], v[232:235], v[48:51]
    v_mfma_f32_16x16x32_bf16 v[52:55], v[28:31], v[236:239], v[52:55]
    s_waitcnt vmcnt(5)
    s_barrier
    ds_read_b128 v[240:243], v17 offset:40960
    ds_read_b128 v[244:247], v17 offset:43008
    ds_read_b128 v[248:251], v18 offset:40960
    ds_read_b128 v[252:255], v18 offset:43008
    ds_read_b64_tr_b16 v[24:25], v14 offset:30720
    ds_read_b64_tr_b16 v[26:27], v14 offset:32000
    s_waitcnt lgkmcnt(12)
    v_mfma_f32_16x16x32_bf16 v[56:59], v[32:35], v[232:235], v[56:59]
    v_mfma_f32_16x16x32_bf16 v[60:63], v[32:35], v[236:239], v[60:63]
    s_add_u32 m0, s43, 49152
    s_nop 0
    buffer_load_dwordx4 v9, s[12:15], s48 offen lds
    ds_read_b64_tr_b16 v[28:29], v14 offset:30760
    ds_read_b64_tr_b16 v[30:31], v14 offset:32040
    s_waitcnt lgkmcnt(12)
    v_mfma_f32_16x16x32_bf16 v[64:67], v[36:39], v[232:235], v[64:67]
    v_mfma_f32_16x16x32_bf16 v[68:71], v[36:39], v[236:239], v[68:71]
    ds_read_b64_tr_b16 v[32:33], v14 offset:30800
    ds_read_b64_tr_b16 v[34:35], v14 offset:32080
    s_waitcnt lgkmcnt(12)
    v_mfma_f32_16x16x32_bf16 v[72:75], v[40:43], v[232:235], v[72:75]
    v_mfma_f32_16x16x32_bf16 v[76:79], v[40:43], v[236:239], v[76:79]
    ds_read_b64_tr_b16 v[36:37], v14 offset:30840
    ds_read_b64_tr_b16 v[38:39], v14 offset:32120
    s_waitcnt lgkmcnt(12)
    v_mfma_f32_16x16x32_bf16 v[80:83], v[44:47], v[232:235], v[80:83]
    v_mfma_f32_16x16x32_bf16 v[84:87], v[44:47], v[236:239], v[84:87]
    ds_read_b64_tr_b16 v[40:41], v16 offset:30752
    ds_read_b64_tr_b16 v[42:43], v16 offset:32032
    s_waitcnt lgkmcnt(8)
    v_mfma_f32_16x16x32_bf16 v[48:51], v[24:27], v[240:243], v[48:51]
    v_mfma_f32_16x16x32_bf16 v[52:55], v[24:27], v[244:247], v[52:55]
    ds_read_b64_tr_b16 v[44:45], v14 offset:40960
    ds_read_b64_tr_b16 v[46:47], v14 offset:42240
    s_waitcnt lgkmcnt(8)
    v_mfma_f32_16x16x32_bf16 v[56:59], v[28:31], v[240:243], v[56:59]
    v_mfma_f32_16x16x32_bf16 v[60:63], v[28:31], v[244:247], v[60:63]
    ds_read_b64_tr_b16 v[24:25], v14 offset:41000
    ds_read_b64_tr_b16 v[26:27], v14 offset:42280
    s_waitcnt lgkmcnt(8)
    v_mfma_f32_16x16x32_bf16 v[64:67], v[32:35], v[240:243], v[64:67]
    v_mfma_f32_16x16x32_bf16 v[68:71], v[32:35], v[244:247], v[68:71]
    ds_read_b64_tr_b16 v[28:29], v14 offset:41040
    ds_read_b64_tr_b16 v[30:31], v14 offset:42320
    s_waitcnt lgkmcnt(8)
    v_mfma_f32_16x16x32_bf16 v[72:75], v[36:39], v[240:243], v[72:75]
    v_mfma_f32_16x16x32_bf16 v[76:79], v[36:39], v[244:247], v[76:79]
    ds_read_b64_tr_b16 v[32:33], v14 offset:41080
    ds_read_b64_tr_b16 v[34:35], v14 offset:42360
    s_waitcnt lgkmcnt(8)
    v_mfma_f32_16x16x32_bf16 v[80:83], v[40:43], v[240:243], v[80:83]
    v_mfma_f32_16x16x32_bf16 v[84:87], v[40:43], v[244:247], v[84:87]
    ds_read_b64_tr_b16 v[36:37], v16 offset:40992
    ds_read_b64_tr_b16 v[38:39], v16 offset:42272
    s_waitcnt lgkmcnt(8)
    v_mfma_f32_16x16x32_bf16 v[48:51], v[44:47], v[248:251], v[48:51]
    v_mfma_f32_16x16x32_bf16 v[52:55], v[44:47], v[252:255], v[52:55]
    s_waitcnt lgkmcnt(6)
    v_mfma_f32_16x16x32_bf16 v[56:59], v[24:27], v[248:251], v[56:59]
    v_mfma_f32_16x16x32_bf16 v[60:63], v[24:27], v[252:255], v[60:63]
    s_waitcnt lgkmcnt(4)
    v_mfma_f32_16x16x32_bf16 v[64:67], v[28:31], v[248:251], v[64:67]
    v_mfma_f32_16x16x32_bf16 v[68:71], v[28:31], v[252:255], v[68:71]
    s_waitcnt lgkmcnt(2)
    v_mfma_f32_16x16x32_bf16 v[72:75], v[32:35], v[248:251], v[72:75]
    v_mfma_f32_16x16x32_bf16 v[76:79], v[32:35], v[252:255], v[76:79]
    s_waitcnt lgkmcnt(0)
    v_mfma_f32_16x16x32_bf16 v[80:83], v[36:39], v[248:251], v[80:83]
    v_mfma_f32_16x16x32_bf16 v[84:87], v[36:39], v[252:255], v[84:87]
    buffer_store_dwordx4 v[88:91], v92, s[32:35], s17 offen sc1
    s_mov_b64 exec, 0xffff
    buffer_store_dwordx4 v[88:91], v92, s[32:35], s17 offen offset:1024 sc1
    s_mov_b64 exec, -1
    v_cvt_pk_bf16_f32 v48, v48, v49
    v_cvt_pk_bf16_f32 v49, v50, v51
    v_cvt_pk_bf16_f32 v50, v52, v53
    v_cvt_pk_bf16_f32 v51, v54, v55
    v_mov_b32 v3, v19
    v_permlane16_swap_b32 v48, v50
    v_permlane16_swap_b32 v49, v51
    v_cvt_pk_bf16_f32 v56, v56, v57
    v_cvt_pk_bf16_f32 v57, v58, v59
    v_cvt_pk_bf16_f32 v58, v60, v61
    v_cvt_pk_bf16_f32 v59, v62, v63
    s_nop 0
    v_permlane16_swap_b32 v56, v58
    v_permlane16_swap_b32 v57, v59
    v_cvt_pk_bf16_f32 v64, v64, v65
    v_cvt_pk_bf16_f32 v65, v66, v67
    v_cvt_pk_bf16_f32 v66, v68, v69
    v_cvt_pk_bf16_f32 v67, v70, v71
    s_nop 0
    v_permlane16_swap_b32 v64, v66
    v_permlane16_swap_b32 v65, v67
    v_cvt_pk_bf16_f32 v72, v72, v73
    v_cvt_pk_bf16_f32 v73, v74, v75
    v_cvt_pk_bf16_f32 v74, v76, v77
    v_cvt_pk_bf16_f32 v75, v78, v79
    s_nop 0
    v_permlane16_swap_b32 v72, v74
    v_permlane16_swap_b32 v73, v75
    v_cvt_pk_bf16_f32 v80, v80, v81
    v_cvt_pk_bf16_f32 v81, v82, v83
    v_cvt_pk_bf16_f32 v82, v84, v85
    v_cvt_pk_bf16_f32 v83, v86, v87
    buffer_store_dwordx2 v[80:81], v20, s[32:35], s60 offen offset:2304 sc1
    buffer_store_dwordx2 v[82:83], v20, s[32:35], s60 offen offset:2368 sc1
    s_branch L_q
L_kv1:
    v_mul_u32_u24 v20, s7, v25
    v_lshl_add_u32 v20, v24, 6, v20
    v_lshl_add_u32 v20, v26, 4, v20
    s_waitcnt vmcnt(4)
    s_barrier
    ds_read_b128 v[96:99], v17 offset:8192
    ds_read_b128 v[100:103], v17 offset:10240
    ds_read_b128 v[104:107], v18 offset:8192
    ds_read_b128 v[108:111], v18 offset:10240
    ds_read_b64_tr_b16 v[24:25], v13 offset:0
    ds_read_b64_tr_b16 v[26:27], v13 offset:1280
    ds_read_b64_tr_b16 v[28:29], v13 offset:40
    ds_read_b64_tr_b16 v[30:31], v13 offset:1320
    ds_read_b64_tr_b16 v[32:33], v13 offset:80
    ds_read_b64_tr_b16 v[34:35], v13 offset:1360
    ds_read_b64_tr_b16 v[36:37], v13 offset:120
    ds_read_b64_tr_b16 v[38:39], v13 offset:1400
    ds_read_b64_tr_b16 v[40:41], v15 offset:32
    ds_read_b64_tr_b16 v[42:43], v15 offset:1312
    s_waitcnt lgkmcnt(8)
    v_mfma_f32_16x16x32_bf16 v[48:51], v[96:99], v[24:27], 0
    v_mfma_f32_16x16x32_bf16 v[52:55], v[100:103], v[24:27], 0
    s_add_u32 m0, s43, 40960
    s_nop 0
    buffer_load_dwordx4 v3, s[12:15], s47 offen lds
    ds_read_b64_tr_b16 v[44:45], v13 offset:10240
    ds_read_b64_tr_b16 v[46:47], v13 offset:11520
    s_waitcnt lgkmcnt(8)
    v_mfma_f32_16x16x32_bf16 v[56:59], v[96:99], v[28:31], 0
    v_mfma_f32_16x16x32_bf16 v[60:63], v[100:103], v[28:31], 0
    s_add_u32 m0, s43, 49152
    s_nop 0
    buffer_load_dwordx4 v4, s[12:15], s47 offen lds
    ds_read_b64_tr_b16 v[24:25], v13 offset:10280
    ds_read_b64_tr_b16 v[26:27], v13 offset:11560
    s_waitcnt lgkmcnt(8)
    v_mfma_f32_16x16x32_bf16 v[64:67], v[96:99], v[32:35], 0
    v_mfma_f32_16x16x32_bf16 v[68:71], v[100:103], v[32:35], 0
    s_add_u32 m0, s43, 57344
    s_nop 0
    buffer_load_dwordx4 v5, s[12:15], s47 offen lds
    ds_read_b64_tr_b16 v[28:29], v13 offset:10320
    ds_read_b64_tr_b16 v[30:31], v13 offset:11600
    s_waitcnt lgkmcnt(8)
    v_mfma_f32_16x16x32_bf16 v[72:75], v[96:99], v[36:39], 0
    v_mfma_f32_16x16x32_bf16 v[76:79], v[100:103], v[36:39], 0
    s_add_u32 m0, s43, 143360
    s_nop 0
    buffer_load_dwordx4 v2, s[8:11], s52 offen lds
    ds_read_b64_tr_b16 v[32:33], v13 offset:10360
    ds_read_b64_tr_b16 v[34:35], v13 offset:11640
    s_waitcnt lgkmcnt(8)
    v_mfma_f32_16x16x32_bf16 v[80:83], v[96:99], v[40:43], 0
    v_mfma_f32_16x16x32_bf16 v[84:87], v[100:103], v[40:43], 0
    s_add_u32 m0, s43, 151552
    s_add_u32 s7, s52, 81920
    buffer_load_dwordx4 v2, s[8:11], s7 offen lds
    ds_read_b64_tr_b16 v[36:37], v15 offset:10272
    ds_read_b64_tr_b16 v[38:39], v15 offset:11552
    s_waitcnt lgkmcnt(8)
    v_mfma_f32_16x16x32_bf16 v[48:51], v[104:107], v[44:47], v[48:51]
    v_mfma_f32_16x16x32_bf16 v[52:55], v[108:111], v[44:47], v[52:55]
    s_add_u32 m0, s43, 65536
    s_nop 0
    buffer_load_dwordx4 v6, s[12:15], s47 offen lds
    s_waitcnt vmcnt(6)
    s_barrier
    ds_read_b128 v[112:115], v17 offset:24576
    ds_read_b128 v[116:119], v17 offset:26624
    ds_read_b128 v[120:123], v18 offset:24576
    ds_read_b128 v[124:127], v18 offset:26624
    ds_read_b64_tr_b16 v[40:41], v13 offset:20480
    ds_read_b64_tr_b16 v[42:43], v13 offset:21760
    s_waitcnt lgkmcnt(12)
    v_mfma_f32_16x16x32_bf16 v[56:59], v[104:107], v[24:27], v[56:59]
    v_mfma_f32_16x16x32_bf16 v[60:63], v[108:111], v[24:27], v[60:63]
    s_add_u32 m0, s43, 73728
    s_nop 0
    buffer_load_dwordx4 v7, s[12:15], s47 offen lds
    ds_read_b64_tr_b16 v[44:45], v13 offset:20520
    ds_read_b64_tr_b16 v[46:47], v13 offset:21800
    s_waitcnt lgkmcnt(12)
    v_mfma_f32_16x16x32_bf16 v[64:67], v[104:107], v[28:31], v[64:67]
    v_mfma_f32_16x16x32_bf16 v[68:71], v[108:111], v[28:31], v[68:71]
    s_add_u32 m0, s43, 102400
    s_add_u32 s7, s52, 128
    buffer_load_dwordx4 v2, s[8:11], s7 offen lds
    ds_read_b64_tr_b16 v[24:25], v13 offset:20560
    ds_read_b64_tr_b16 v[26:27], v13 offset:21840
    s_waitcnt lgkmcnt(12)
    v_mfma_f32_16x16x32_bf16 v[72:75], v[104:107], v[32:35], v[72:75]
    v_mfma_f32_16x16x32_bf16 v[76:79], v[108:111], v[32:35], v[76:79]
    s_add_u32 m0, s43, 110592
    s_add_u32 s7, s52, 82048
    buffer_load_dwordx4 v2, s[8:11], s7 offen lds
    ds_read_b64_tr_b16 v[28:29], v13 offset:20600
    ds_read_b64_tr_b16 v[30:31], v13 offset:21880
    s_waitcnt lgkmcnt(12)
    v_mfma_f32_16x16x32_bf16 v[80:83], v[104:107], v[36:39], v[80:83]
    v_mfma_f32_16x16x32_bf16 v[84:87], v[108:111], v[36:39], v[84:87]
    s_add_u32 m0, s43, 81920
    s_nop 0
    buffer_load_dwordx4 v3, s[12:15], s48 offen lds
    ds_read_b64_tr_b16 v[32:33], v15 offset:20512
    ds_read_b64_tr_b16 v[34:35], v15 offset:21792
    s_waitcnt lgkmcnt(8)
    v_mfma_f32_16x16x32_bf16 v[48:51], v[112:115], v[40:43], v[48:51]
    v_mfma_f32_16x16x32_bf16 v[52:55], v[116:119], v[40:43], v[52:55]
    s_add_u32 m0, s43, 90112
    s_nop 0
    buffer_load_dwordx4 v4, s[12:15], s48 offen lds
    ds_read_b64_tr_b16 v[36:37], v13 offset:30720
    ds_read_b64_tr_b16 v[38:39], v13 offset:32000
    s_waitcnt lgkmcnt(8)
    v_mfma_f32_16x16x32_bf16 v[56:59], v[112:115], v[44:47], v[56:59]
    v_mfma_f32_16x16x32_bf16 v[60:63], v[116:119], v[44:47], v[60:63]
    s_mov_b32 m0, s58
    s_nop 0
    buffer_load_dwordx4 v5, s[12:15], s48 offen lds
    ds_read_b64_tr_b16 v[40:41], v13 offset:30760
    ds_read_b64_tr_b16 v[42:43], v13 offset:32040
    s_waitcnt lgkmcnt(8)
    v_mfma_f32_16x16x32_bf16 v[64:67], v[112:115], v[24:27], v[64:67]
    v_mfma_f32_16x16x32_bf16 v[68:71], v[116:119], v[24:27], v[68:71]
    s_add_u32 m0, s43, 118784
    s_nop 0
    buffer_load_dwordx4 v2, s[8:11], s53 offen lds
    ds_read_b64_tr_b16 v[44:45], v13 offset:30800
    ds_read_b64_tr_b16 v[46:47], v13 offset:32080
    s_waitcnt lgkmcnt(8)
    v_mfma_f32_16x16x32_bf16 v[72:75], v[112:115], v[28:31], v[72:75]
    v_mfma_f32_16x16x32_bf16 v[76:79], v[116:119], v[28:31], v[76:79]
    ds_read_b64_tr_b16 v[24:25], v13 offset:30840
    ds_read_b64_tr_b16 v[26:27], v13 offset:32120
    s_waitcnt lgkmcnt(8)
    v_mfma_f32_16x16x32_bf16 v[80:83], v[112:115], v[32:35], v[80:83]
    v_mfma_f32_16x16x32_bf16 v[84:87], v[116:119], v[32:35], v[84:87]
    ds_read_b64_tr_b16 v[28:29], v15 offset:30752
    ds_read_b64_tr_b16 v[30:31], v15 offset:32032
    s_waitcnt lgkmcnt(8)
    v_mfma_f32_16x16x32_bf16 v[48:51], v[120:123], v[36:39], v[48:51]
    v_mfma_f32_16x16x32_bf16 v[52:55], v[124:127], v[36:39], v[52:55]
    s_waitcnt vmcnt(8)
    s_barrier
    ds_read_b128 v[128:131], v17 offset:40960
    ds_read_b128 v[132:135], v17 offset:43008
    ds_read_b128 v[136:139], v18 offset:40960
    ds_read_b128 v[140:143], v18 offset:43008
    ds_read_b64_tr_b16 v[32:33], v13 offset:40960
    ds_read_b64_tr_b16 v[34:35], v13 offset:42240
    s_waitcnt lgkmcnt(12)
    v_mfma_f32_16x16x32_bf16 v[56:59], v[120:123], v[40:43], v[56:59]
    v_mfma_f32_16x16x32_bf16 v[60:63], v[124:127], v[40:43], v[60:63]
    s_add_u32 m0, s43, 126976
    s_add_u32 s7, s53, 81920
    buffer_load_dwordx4 v2, s[8:11], s7 offen lds
    ds_read_b64_tr_b16 v[36:37], v13 offset:41000
    ds_read_b64_tr_b16 v[38:39], v13 offset:42280
    s_waitcnt lgkmcnt(12)
    v_mfma_f32_16x16x32_bf16 v[64:67], v[120:123], v[44:47], v[64:67]
    v_mfma_f32_16x16x32_bf16 v[68:71], v[124:127], v[44:47], v[68:71]
    s_add_u32 m0, s43, 4096
    s_nop 0
    buffer_load_dwordx4 v6, s[12:15], s48 offen lds
    ds_read_b64_tr_b16 v[40:41], v13 offset:41040
    ds_read_b64_tr_b16 v[42:43], v13 offset:42320
    s_waitcnt lgkmcnt(12)
    v_mfma_f32_16x16x32_bf16 v[72:75], v[120:123], v[24:27], v[72:75]
    v_mfma_f32_16x16x32_bf16 v[76:79], v[124:127], v[24:27], v[76:79]
    s_add_u32 m0, s43, 12288
    s_nop 0
    buffer_load_dwordx4 v7, s[12:15], s48 offen lds
    ds_read_b64_tr_b16 v[44:45], v13 offset:41080
    ds_read_b64_tr_b16 v[46:47], v13 offset:42360
    s_waitcnt lgkmcnt(12)
    v_mfma_f32_16x16x32_bf16 v[80:83], v[120:123], v[28:31], v[80:83]
    v_mfma_f32_16x16x32_bf16 v[84:87], v[124:127], v[28:31], v[84:87]
    s_add_u32 m0, s43, 135168
    s_add_u32 s7, s53, 128
    buffer_load_dwordx4 v2, s[8:11], s7 offen lds
    ds_read_b64_tr_b16 v[24:25], v15 offset:40992
    ds_read_b64_tr_b16 v[26:27], v15 offset:42272
    s_waitcnt lgkmcnt(8)
    v_mfma_f32_16x16x32_bf16 v[48:51], v[128:131], v[32:35], v[48:51]
    v_mfma_f32_16x16x32_bf16 v[52:55], v[132:135], v[32:35], v[52:55]
    ds_read_b64_tr_b16 v[28:29], v14 offset:0
    ds_read_b64_tr_b16 v[30:31], v14 offset:1280
    s_waitcnt lgkmcnt(8)
    v_mfma_f32_16x16x32_bf16 v[56:59], v[128:131], v[36:39], v[56:59]
    v_mfma_f32_16x16x32_bf16 v[60:63], v[132:135], v[36:39], v[60:63]
    ds_read_b64_tr_b16 v[32:33], v14 offset:40
    ds_read_b64_tr_b16 v[34:35], v14 offset:1320
    s_waitcnt lgkmcnt(8)
    v_mfma_f32_16x16x32_bf16 v[64:67], v[128:131], v[40:43], v[64:67]
    v_mfma_f32_16x16x32_bf16 v[68:71], v[132:135], v[40:43], v[68:71]
    ds_read_b64_tr_b16 v[36:37], v14 offset:80
    ds_read_b64_tr_b16 v[38:39], v14 offset:1360
    s_waitcnt lgkmcnt(8)
    v_mfma_f32_16x16x32_bf16 v[72:75], v[128:131], v[44:47], v[72:75]
    v_mfma_f32_16x16x32_bf16 v[76:79], v[132:135], v[44:47], v[76:79]
    ds_read_b64_tr_b16 v[40:41], v14 offset:120
    ds_read_b64_tr_b16 v[42:43], v14 offset:1400
    s_waitcnt lgkmcnt(8)
    v_mfma_f32_16x16x32_bf16 v[80:83], v[128:131], v[24:27], v[80:83]
    v_mfma_f32_16x16x32_bf16 v[84:87], v[132:135], v[24:27], v[84:87]
    ds_read_b64_tr_b16 v[44:45], v16 offset:32
    ds_read_b64_tr_b16 v[46:47], v16 offset:1312
    s_waitcnt lgkmcnt(8)
    v_mfma_f32_16x16x32_bf16 v[48:51], v[136:139], v[28:31], v[48:51]
    v_mfma_f32_16x16x32_bf16 v[52:55], v[140:143], v[28:31], v[52:55]
    s_waitcnt vmcnt(8)
    s_barrier
    ds_read_b128 v[144:147], v17 offset:0
    ds_read_b128 v[148:151], v17 offset:2048
    ds_read_b128 v[152:155], v18 offset:0
    ds_read_b128 v[156:159], v18 offset:2048
    ds_read_b64_tr_b16 v[24:25], v14 offset:10240
    ds_read_b64_tr_b16 v[26:27], v14 offset:11520
    s_waitcnt lgkmcnt(12)
    v_mfma_f32_16x16x32_bf16 v[56:59], v[136:139], v[32:35], v[56:59]
    v_mfma_f32_16x16x32_bf16 v[60:63], v[140:143], v[32:35], v[60:63]
    s_add_u32 m0, s43, 143360
    s_add_u32 s7, s53, 82048
    buffer_load_dwordx4 v2, s[8:11], s7 offen lds
    ds_read_b64_tr_b16 v[28:29], v14 offset:10280
    ds_read_b64_tr_b16 v[30:31], v14 offset:11560
    s_waitcnt lgkmcnt(12)
    v_mfma_f32_16x16x32_bf16 v[64:67], v[136:139], v[36:39], v[64:67]
    v_mfma_f32_16x16x32_bf16 v[68:71], v[140:143], v[36:39], v[68:71]
    s_add_u32 m0, s43, 20480
    s_nop 0
    buffer_load_dwordx4 v3, s[12:15], s49 offen lds
    ds_read_b64_tr_b16 v[32:33], v14 offset:10320
    ds_read_b64_tr_b16 v[34:35], v14 offset:11600
    s_waitcnt lgkmcnt(12)
    v_mfma_f32_16x16x32_bf16 v[72:75], v[136:139], v[40:43], v[72:75]
    v_mfma_f32_16x16x32_bf16 v[76:79], v[140:143], v[40:43], v[76:79]
    s_add_u32 m0, s43, 28672
    s_nop 0
    buffer_load_dwordx4 v4, s[12:15], s49 offen lds
    ds_read_b64_tr_b16 v[36:37], v14 offset:10360
    ds_read_b64_tr_b16 v[38:39], v14 offset:11640
    s_waitcnt lgkmcnt(12)
    v_mfma_f32_16x16x32_bf16 v[80:83], v[136:139], v[44:47], v[80:83]
    v_mfma_f32_16x16x32_bf16 v[84:87], v[140:143], v[44:47], v[84:87]
    s_add_u32 m0, s43, 36864
    s_nop 0
    buffer_load_dwordx4 v5, s[12:15], s49 offen lds
    ds_read_b64_tr_b16 v[40:41], v16 offset:10272
    ds_read_b64_tr_b16 v[42:43], v16 offset:11552
    s_waitcnt lgkmcnt(8)
    v_mfma_f32_16x16x32_bf16 v[48:51], v[144:147], v[24:27], v[48:51]
    v_mfma_f32_16x16x32_bf16 v[52:55], v[148:151], v[24:27], v[52:55]
    s_add_u32 m0, s43, 151552
    s_nop 0
    buffer_load_dwordx4 v2, s[8:11], s54 offen lds
    ds_read_b64_tr_b16 v[44:45], v14 offset:20480
    ds_read_b64_tr_b16 v[46:47], v14 offset:21760
    s_waitcnt lgkmcnt(8)
    v_mfma_f32_16x16x32_bf16 v[56:59], v[144:147], v[28:31], v[56:59]
    v_mfma_f32_16x16x32_bf16 v[60:63], v[148:151], v[28:31], v[60:63]
    ds_read_b64_tr_b16 v[24:25], v14 offset:20520
    ds_read_b64_tr_b16 v[26:27], v14 offset:21800
    s_waitcnt lgkmcnt(8)
    v_mfma_f32_16x16x32_bf16 v[64:67], v[144:147], v[32:35], v[64:67]
    v_mfma_f32_16x16x32_bf16 v[68:71], v[148:151], v[32:35], v[68:71]
    ds_read_b64_tr_b16 v[28:29], v14 offset:20560
    ds_read_b64_tr_b16 v[30:31], v14 offset:21840
    s_waitcnt lgkmcnt(8)
    v_mfma_f32_16x16x32_bf16 v[72:75], v[144:147], v[36:39], v[72:75]
    v_mfma_f32_16x16x32_bf16 v[76:79], v[148:151], v[36:39], v[76:79]
    ds_read_b64_tr_b16 v[32:33], v14 offset:20600
    ds_read_b64_tr_b16 v[34:35], v14 offset:21880
    s_waitcnt lgkmcnt(8)
    v_mfma_f32_16x16x32_bf16 v[80:83], v[144:147], v[40:43], v[80:83]
    v_mfma_f32_16x16x32_bf16 v[84:87], v[148:151], v[40:43], v[84:87]
    ds_read_b64_tr_b16 v[36:37], v16 offset:20512
    ds_read_b64_tr_b16 v[38:39], v16 offset:21792
    s_waitcnt lgkmcnt(8)
    v_mfma_f32_16x16x32_bf16 v[48:51], v[152:155], v[44:47], v[48:51]
    v_mfma_f32_16x16x32_bf16 v[52:55], v[156:159], v[44:47], v[52:55]
    s_waitcnt vmcnt(8)
    s_barrier
    ds_read_b128 v[160:163], v17 offset:16384
    ds_read_b128 v[164:167], v17 offset:18432
    ds_read_b128 v[168:171], v18 offset:16384
    ds_read_b128 v[172:175], v18 offset:18432
    ds_read_b64_tr_b16 v[40:41], v14 offset:30720
    ds_read_b64_tr_b16 v[42:43], v14 offset:32000
    s_waitcnt lgkmcnt(12)
    v_mfma_f32_16x16x32_bf16 v[56:59], v[152:155], v[24:27], v[56:59]
    v_mfma_f32_16x16x32_bf16 v[60:63], v[156:159], v[24:27], v[60:63]
    s_add_u32 m0, s43, 102400
    s_add_u32 s7, s54, 81920
    buffer_load_dwordx4 v2, s[8:11], s7 offen lds
    ds_read_b64_tr_b16 v[44:45], v14 offset:30760
    ds_read_b64_tr_b16 v[46:47], v14 offset:32040
    s_waitcnt lgkmcnt(12)
    v_mfma_f32_16x16x32_bf16 v[64:67], v[152:155], v[28:31], v[64:67]
    v_mfma_f32_16x16x32_bf16 v[68:71], v[156:159], v[28:31], v[68:71]
    s_add_u32 m0, s43, 45056
    s_nop 0
    buffer_load_dwordx4 v6, s[12:15], s49 offen lds
    ds_read_b64_tr_b16 v[24:25], v14 offset:30800
    ds_read_b64_tr_b16 v[26:27], v14 offset:32080
    s_waitcnt lgkmcnt(12)
    v_mfma_f32_16x16x32_bf16 v[72:75], v[152:155], v[32:35], v[72:75]
    v_mfma_f32_16x16x32_bf16 v[76:79], v[156:159], v[32:35], v[76:79]
    s_add_u32 m0, s43, 53248
    s_nop 0
    buffer_load_dwordx4 v7, s[12:15], s49 offen lds
    ds_read_b64_tr_b16 v[28:29], v14 offset:30840
    ds_read_b64_tr_b16 v[30:31], v14 offset:32120
    s_waitcnt lgkmcnt(12)
    v_mfma_f32_16x16x32_bf16 v[80:83], v[152:155], v[36:39], v[80:83]
    v_mfma_f32_16x16x32_bf16 v[84:87], v[156:159], v[36:39], v[84:87]
    s_add_u32 m0, s43, 110592
    s_add_u32 s7, s54, 128
    buffer_load_dwordx4 v2, s[8:11], s7 offen lds
    ds_read_b64_tr_b16 v[32:33], v16 offset:30752
    ds_read_b64_tr_b16 v[34:35], v16 offset:32032
    s_waitcnt lgkmcnt(8)
    v_mfma_f32_16x16x32_bf16 v[48:51], v[160:163], v[40:43], v[48:51]
    v_mfma_f32_16x16x32_bf16 v[52:55], v[164:167], v[40:43], v[52:55]
    ds_read_b64_tr_b16 v[36:37], v14 offset:40960
    ds_read_b64_tr_b16 v[38:39], v14 offset:42240
    s_waitcnt lgkmcnt(8)
    v_mfma_f32_16x16x32_bf16 v[56:59], v[160:163], v[44:47], v[56:59]
    v_mfma_f32_16x16x32_bf16 v[60:63], v[164:167], v[44:47], v[60:63]
    ds_read_b64_tr_b16 v[40:41], v14 offset:41000
    ds_read_b64_tr_b16 v[42:43], v14 offset:42280
    s_waitcnt lgkmcnt(8)
    v_mfma_f32_16x16x32_bf16 v[64:67], v[160:163], v[24:27], v[64:67]
    v_mfma_f32_16x16x32_bf16 v[68:71], v[164:167], v[24:27], v[68:71]
    ds_read_b64_tr_b16 v[44:45], v14 offset:41040
    ds_read_b64_tr_b16 v[46:47], v14 offset:42320
    s_waitcnt lgkmcnt(8)
    v_mfma_f32_16x16x32_bf16 v[72:75], v[160:163], v[28:31], v[72:75]
    v_mfma_f32_16x16x32_bf16 v[76:79], v[164:167], v[28:31], v[76:79]
    ds_read_b64_tr_b16 v[24:25], v14 offset:41080
    ds_read_b64_tr_b16 v[26:27], v14 offset:42360
    s_waitcnt lgkmcnt(8)
    v_mfma_f32_16x16x32_bf16 v[80:83], v[160:163], v[32:35], v[80:83]
    v_mfma_f32_16x16x32_bf16 v[84:87], v[164:167], v[32:35], v[84:87]
    ds_read_b64_tr_b16 v[28:29], v16 offset:40992
    ds_read_b64_tr_b16 v[30:31], v16 offset:42272
    s_waitcnt lgkmcnt(8)
    v_mfma_f32_16x16x32_bf16 v[48:51], v[168:171], v[36:39], v[48:51]
    v_mfma_f32_16x16x32_bf16 v[52:55], v[172:175], v[36:39], v[52:55]
    s_or_b32 s7, s3, s42
    s_cbranch_scc1 L_nocl2_1
    v_subrev_co_u32 v22, vcc, s38, v22
    v_mov_b32 v22, s39
    s_nop 0
    v_subb_co_u32 v23, vcc, v23, v22, vcc
    s_mov_b64 exec, 1
    ds_write_b32 v21, v23
    s_mov_b64 exec, -1
    s_waitcnt lgkmcnt(0)
L_nocl2_1:
    s_add_u32 s58, s43, 57344
    s_add_u32 s7, s43, 98304
    s_cmp_ge_u32 s3, 4
    s_cselect_b32 s58, s7, s58
    s_waitcnt vmcnt(8)
    s_barrier
    ds_read_b32 v22, v21
    ds_read_b128 v[176:179], v17 offset:32768
    ds_read_b128 v[180:183], v17 offset:34816
    ds_read_b128 v[184:187], v18 offset:32768
    ds_read_b128 v[188:191], v18 offset:34816
    ds_read_b64_tr_b16 v[32:33], v13 offset:0
    ds_read_b64_tr_b16 v[34:35], v13 offset:1280
    s_waitcnt lgkmcnt(13)
    v_mfma_f32_16x16x32_bf16 v[56:59], v[168:171], v[40:43], v[56:59]
    v_mfma_f32_16x16x32_bf16 v[60:63], v[172:175], v[40:43], v[60:63]
    s_add_u32 m0, s43, 118784
    s_add_u32 s7, s54, 82048
    buffer_load_dwordx4 v2, s[8:11], s7 offen lds
    ds_read_b64_tr_b16 v[36:37], v13 offset:40
    ds_read_b64_tr_b16 v[38:39], v13 offset:1320
    s_waitcnt lgkmcnt(13)
    v_mfma_f32_16x16x32_bf16 v[64:67], v[168:171], v[44:47], v[64:67]
    v_mfma_f32_16x16x32_bf16 v[68:71], v[172:175], v[44:47], v[68:71]
    s_add_u32 m0, s43, 61440
    s_nop 0
    buffer_load_dwordx4 v3, s[12:15], s50 offen lds
    ds_read_b64_tr_b16 v[40:41], v13 offset:80
    ds_read_b64_tr_b16 v[42:43], v13 offset:1360
    s_waitcnt lgkmcnt(13)
    v_mfma_f32_16x16x32_bf16 v[72:75], v[168:171], v[24:27], v[72:75]
    v_mfma_f32_16x16x32_bf16 v[76:79], v[172:175], v[24:27], v[76:79]
    s_add_u32 m0, s43, 69632
    s_nop 0
    buffer_load_dwordx4 v4, s[12:15], s50 offen lds
    ds_read_b64_tr_b16 v[44:45], v13 offset:120
    ds_read_b64_tr_b16 v[46:47], v13 offset:1400
    s_waitcnt lgkmcnt(13)
    v_mfma_f32_16x16x32_bf16 v[80:83], v[168:171], v[28:31], v[80:83]
    v_mfma_f32_16x16x32_bf16 v[84:87], v[172:175], v[28:31], v[84:87]
    s_add_u32 m0, s43, 77824
    s_nop 0
    buffer_load_dwordx4 v5, s[12:15], s50 offen lds
    ds_read_b64_tr_b16 v[24:25], v15 offset:32
    ds_read_b64_tr_b16 v[26:27], v15 offset:1312
    s_waitcnt lgkmcnt(8)
    v_mfma_f32_16x16x32_bf16 v[48:51], v[176:179], v[32:35], v[48:51]
    v_mfma_f32_16x16x32_bf16 v[52:55], v[180:183], v[32:35], v[52:55]
    s_add_u32 m0, s43, 126976
    s_nop 0
    buffer_load_dwordx4 v2, s[8:11], s55 offen lds
    ds_read_b64_tr_b16 v[28:29], v13 offset:10240
    ds_read_b64_tr_b16 v[30:31], v13 offset:11520
    s_waitcnt lgkmcnt(8)
    v_mfma_f32_16x16x32_bf16 v[56:59], v[176:179], v[36:39], v[56:59]
    v_mfma_f32_16x16x32_bf16 v[60:63], v[180:183], v[36:39], v[60:63]
    ds_read_b64_tr_b16 v[32:33], v13 offset:10280
    ds_read_b64_tr_b16 v[34:35], v13 offset:11560
    s_waitcnt lgkmcnt(8)
    v_mfma_f32_16x16x32_bf16 v[64:67], v[176:179], v[40:43], v[64:67]
    v_mfma_f32_16x16x32_bf16 v[68:71], v[180:183], v[40:43], v[68:71]
    ds_read_b64_tr_b16 v[36:37], v13 offset:10320
    ds_read_b64_tr_b16 v[38:39], v13 offset:11600
    s_waitcnt lgkmcnt(8)
    v_mfma_f32_16x16x32_bf16 v[72:75], v[176:179], v[44:47], v[72:75]
    v_mfma_f32_16x16x32_bf16 v[76:79], v[180:183], v[44:47], v[76:79]
    ds_read_b64_tr_b16 v[40:41], v13 offset:10360
    ds_read_b64_tr_b16 v[42:43], v13 offset:11640
    s_waitcnt lgkmcnt(8)
    v_mfma_f32_16x16x32_bf16 v[80:83], v[176:179], v[24:27], v[80:83]
    v_mfma_f32_16x16x32_bf16 v[84:87], v[180:183], v[24:27], v[84:87]
    ds_read_b64_tr_b16 v[44:45], v15 offset:10272
    ds_read_b64_tr_b16 v[46:47], v15 offset:11552
    s_waitcnt lgkmcnt(8)
    v_mfma_f32_16x16x32_bf16 v[48:51], v[184:187], v[28:31], v[48:51]
    v_mfma_f32_16x16x32_bf16 v[52:55], v[188:191], v[28:31], v[52:55]
    s_waitcnt vmcnt(8)
    s_barrier
    v_subrev_u32 v17, s59, v17
    v_subrev_u32 v18, s59, v18
    ds_read_b128 v[192:195], v17 offset:49152
    ds_read_b128 v[196:199], v17 offset:51200
    ds_read_b128 v[200:203], v18 offset:49152
    ds_read_b128 v[204:207], v18 offset:51200
    ds_read_b64_tr_b16 v[24:25], v13 offset:20480
    ds_read_b64_tr_b16 v[26:27], v13 offset:21760
    s_waitcnt lgkmcnt(12)
    v_mfma_f32_16x16x32_bf16 v[56:59], v[184:187], v[32:35], v[56:59]
    v_mfma_f32_16x16x32_bf16 v[60:63], v[188:191], v[32:35], v[60:63]
    s_add_u32 m0, s43, 135168
    s_add_u32 s7, s55, 81920
    buffer_load_dwordx4 v2, s[8:11], s7 offen lds
    ds_read_b64_tr_b16 v[28:29], v13 offset:20520
    ds_read_b64_tr_b16 v[30:31], v13 offset:21800
    s_waitcnt lgkmcnt(12)
    v_mfma_f32_16x16x32_bf16 v[64:67], v[184:187], v[36:39], v[64:67]
    v_mfma_f32_16x16x32_bf16 v[68:71], v[188:191], v[36:39], v[68:71]
    s_add_u32 m0, s43, 86016
    s_nop 0
    buffer_load_dwordx4 v6, s[12:15], s50 offen lds
    ds_read_b64_tr_b16 v[32:33], v13 offset:20560
    ds_read_b64_tr_b16 v[34:35], v13 offset:21840
    s_waitcnt lgkmcnt(12)
    v_mfma_f32_16x16x32_bf16 v[72:75], v[184:187], v[40:43], v[72:75]
    v_mfma_f32_16x16x32_bf16 v[76:79], v[188:191], v[40:43], v[76:79]
    s_add_u32 m0, s43, 94208
    s_nop 0
    buffer_load_dwordx4 v7, s[12:15], s50 offen lds
    ds_read_b64_tr_b16 v[36:37], v13 offset:20600
    ds_read_b64_tr_b16 v[38:39], v13 offset:21880
    s_waitcnt lgkmcnt(12)
    v_mfma_f32_16x16x32_bf16 v[80:83], v[184:187], v[44:47], v[80:83]
    v_mfma_f32_16x16x32_bf16 v[84:87], v[188:191], v[44:47], v[84:87]
    s_add_u32 m0, s43, 143360
    s_add_u32 s7, s55, 128
    buffer_load_dwordx4 v2, s[8:11], s7 offen lds
    ds_read_b64_tr_b16 v[40:41], v15 offset:20512
    ds_read_b64_tr_b16 v[42:43], v15 offset:21792
    s_waitcnt lgkmcnt(8)
    v_mfma_f32_16x16x32_bf16 v[48:51], v[192:195], v[24:27], v[48:51]
    v_mfma_f32_16x16x32_bf16 v[52:55], v[196:199], v[24:27], v[52:55]
    s_add_u32 m0, s43, 0
    s_nop 0
    buffer_load_dwordx4 v8, s[12:15], s46 offen lds
    v_readfirstlane_b32 s7, v22
    s_or_b32 s7, s7, s42
    s_cbranch_scc0 L_lost
    ds_read_b64_tr_b16 v[44:45], v13 offset:30720
    ds_read_b64_tr_b16 v[46:47], v13 offset:32000
    s_waitcnt lgkmcnt(8)
    v_mfma_f32_16x16x32_bf16 v[56:59], v[192:195], v[28:31], v[56:59]
    v_mfma_f32_16x16x32_bf16 v[60:63], v[196:199], v[28:31], v[60:63]
    s_lshl_b32 s16, s5, 1
    s_add_u32 s16, s16, s4
    s_lshl_b32 s16, s16, 1
    s_add_u32 s16, s16, s44
    s_lshl_b32 s16, s16, 3
    s_add_u32 s16, s16, s6
    s_lshl_b32 s16, s16, 2
    s_add_u32 s16, s16, s45
    ds_read_b64_tr_b16 v[24:25], v13 offset:30760
    ds_read_b64_tr_b16 v[26:27], v13 offset:32040
    s_waitcnt lgkmcnt(8)
    v_mfma_f32_16x16x32_bf16 v[64:67], v[192:195], v[32:35], v[64:67]
    v_mfma_f32_16x16x32_bf16 v[68:71], v[196:199], v[32:35], v[68:71]
    s_mul_i32 s16, s16, 1280
    s_add_u32 s16, s16, 13107200
    s_lshl_b32 s17, s41, 3
    s_add_u32 s17, s17, s3
    s_mul_i32 s17, s17, 1280
    s_add_u32 s17, s17, 10485760
    ds_read_b64_tr_b16 v[28:29], v13 offset:30800
    ds_read_b64_tr_b16 v[30:31], v13 offset:32080
    s_waitcnt lgkmcnt(8)
    v_mfma_f32_16x16x32_bf16 v[72:75], v[192:195], v[36:39], v[72:75]
    v_mfma_f32_16x16x32_bf16 v[76:79], v[196:199], v[36:39], v[76:79]
    ds_read_b64_tr_b16 v[32:33], v13 offset:30840
    ds_read_b64_tr_b16 v[34:35], v13 offset:32120
    s_waitcnt lgkmcnt(8)
    v_mfma_f32_16x16x32_bf16 v[80:83], v[192:195], v[40:43], v[80:83]
    v_mfma_f32_16x16x32_bf16 v[84:87], v[196:199], v[40:43], v[84:87]
    ds_read_b64_tr_b16 v[36:37], v15 offset:30752
    ds_read_b64_tr_b16 v[38:39], v15 offset:32032
    s_waitcnt lgkmcnt(8)
    v_mfma_f32_16x16x32_bf16 v[48:51], v[200:203], v[44:47], v[48:51]
    v_mfma_f32_16x16x32_bf16 v[52:55], v[204:207], v[44:47], v[52:55]
    s_waitcnt vmcnt(9)
    s_barrier
    v_add_u32 v17, s59, v17
    v_add_u32 v18, s59, v18
    ds_read_b128 v[208:211], v17 offset:8192
    ds_read_b128 v[212:215], v17 offset:10240
    ds_read_b128 v[216:219], v18 offset:8192
    ds_read_b128 v[220:223], v18 offset:10240
    ds_read_b64_tr_b16 v[40:41], v13 offset:40960
    ds_read_b64_tr_b16 v[42:43], v13 offset:42240
    s_waitcnt lgkmcnt(12)
    v_mfma_f32_16x16x32_bf16 v[56:59], v[200:203], v[24:27], v[56:59]
    v_mfma_f32_16x16x32_bf16 v[60:63], v[204:207], v[24:27], v[60:63]
    s_add_u32 m0, s43, 151552
    s_add_u32 s7, s55, 82048
    buffer_load_dwordx4 v2, s[8:11], s7 offen lds
    ds_read_b64_tr_b16 v[44:45], v13 offset:41000
    ds_read_b64_tr_b16 v[46:47], v13 offset:42280
    s_waitcnt lgkmcnt(12)
    v_mfma_f32_16x16x32_bf16 v[64:67], v[200:203], v[28:31], v[64:67]
    v_mfma_f32_16x16x32_bf16 v[68:71], v[204:207], v[28:31], v[68:71]
    s_add_u32 m0, s43, 8192
    s_nop 0
    buffer_load_dwordx4 v9, s[12:15], s46 offen lds
    ds_read_b64_tr_b16 v[24:25], v13 offset:41040
    ds_read_b64_tr_b16 v[26:27], v13 offset:42320
    s_waitcnt lgkmcnt(12)
    v_mfma_f32_16x16x32_bf16 v[72:75], v[200:203], v[32:35], v[72:75]
    v_mfma_f32_16x16x32_bf16 v[76:79], v[204:207], v[32:35], v[76:79]
    s_add_u32 m0, s43, 16384
    s_nop 0
    buffer_load_dwordx4 v10, s[12:15], s56 offen lds
    ds_read_b64_tr_b16 v[28:29], v13 offset:41080
    ds_read_b64_tr_b16 v[30:31], v13 offset:42360
    s_waitcnt lgkmcnt(12)
    v_mfma_f32_16x16x32_bf16 v[80:83], v[200:203], v[36:39], v[80:83]
    v_mfma_f32_16x16x32_bf16 v[84:87], v[204:207], v[36:39], v[84:87]
    ds_read_b64_tr_b16 v[32:33], v15 offset:40992
    ds_read_b64_tr_b16 v[34:35], v15 offset:42272
    s_waitcnt lgkmcnt(8)
    v_mfma_f32_16x16x32_bf16 v[48:51], v[208:211], v[40:43], v[48:51]
    v_mfma_f32_16x16x32_bf16 v[52:55], v[212:215], v[40:43], v[52:55]
    ds_read_b64_tr_b16 v[36:37], v14 offset:0
    ds_read_b64_tr_b16 v[38:39], v14 offset:1280
    s_waitcnt lgkmcnt(8)
    v_mfma_f32_16x16x32_bf16 v[56:59], v[208:211], v[44:47], v[56:59]
    v_mfma_f32_16x16x32_bf16 v[60:63], v[212:215], v[44:47], v[60:63]
    ds_read_b64_tr_b16 v[40:41], v14 offset:40
    ds_read_b64_tr_b16 v[42:43], v14 offset:1320
    s_waitcnt lgkmcnt(8)
    v_mfma_f32_16x16x32_bf16 v[64:67], v[208:211], v[24:27], v[64:67]
    v_mfma_f32_16x16x32_bf16 v[68:71], v[212:215], v[24:27], v[68:71]
    ds_read_b64_tr_b16 v[44:45], v14 offset:80
    ds_read_b64_tr_b16 v[46:47], v14 offset:1360
    s_waitcnt lgkmcnt(8)
    v_mfma_f32_16x16x32_bf16 v[72:75], v[208:211], v[28:31], v[72:75]
    v_mfma_f32_16x16x32_bf16 v[76:79], v[212:215], v[28:31], v[76:79]
    ds_read_b64_tr_b16 v[24:25], v14 offset:120
    ds_read_b64_tr_b16 v[26:27], v14 offset:1400
    s_waitcnt lgkmcnt(8)
    v_mfma_f32_16x16x32_bf16 v[80:83], v[208:211], v[32:35], v[80:83]
    v_mfma_f32_16x16x32_bf16 v[84:87], v[212:215], v[32:35], v[84:87]
    ds_read_b64_tr_b16 v[28:29], v16 offset:32
    ds_read_b64_tr_b16 v[30:31], v16 offset:1312
    s_waitcnt lgkmcnt(8)
    v_mfma_f32_16x16x32_bf16 v[48:51], v[216:219], v[36:39], v[48:51]
    v_mfma_f32_16x16x32_bf16 v[52:55], v[220:223], v[36:39], v[52:55]
    s_waitcnt vmcnt(7)
    s_barrier
    ds_read_b128 v[224:227], v17 offset:24576
    ds_read_b128 v[228:231], v17 offset:26624
    ds_read_b128 v[232:235], v18 offset:24576
    ds_read_b128 v[236:239], v18 offset:26624
    ds_read_b64_tr_b16 v[32:33], v14 offset:10240
    ds_read_b64_tr_b16 v[34:35], v14 offset:11520
    s_waitcnt lgkmcnt(12)
    v_mfma_f32_16x16x32_bf16 v[56:59], v[216:219], v[40:43], v[56:59]
    v_mfma_f32_16x16x32_bf16 v[60:63], v[220:223], v[40:43], v[60:63]
    s_add_u32 m0, s43, 24576
    s_nop 0
    buffer_load_dwordx4 v11, s[12:15], s47 offen lds
    ds_read_b64_tr_b16 v[36:37], v14 offset:10280
    ds_read_b64_tr_b16 v[38:39], v14 offset:11560
    s_waitcnt lgkmcnt(12)
    v_mfma_f32_16x16x32_bf16 v[64:67], v[216:219], v[44:47], v[64:67]
    v_mfma_f32_16x16x32_bf16 v[68:71], v[220:223], v[44:47], v[68:71]
    s_add_u32 m0, s43, 32768
    s_nop 0
    buffer_load_dwordx4 v12, s[12:15], s47 offen lds
    ds_read_b64_tr_b16 v[40:41], v14 offset:10320
    ds_read_b64_tr_b16 v[42:43], v14 offset:11600
    s_waitcnt lgkmcnt(12)
    v_mfma_f32_16x16x32_bf16 v[72:75], v[216:219], v[24:27], v[72:75]
    v_mfma_f32_16x16x32_bf16 v[76:79], v[220:223], v[24:27], v[76:79]
    s_add_u32 m0, s43, 40960
    s_nop 0
    buffer_load_dwordx4 v8, s[12:15], s48 offen lds
    ds_read_b64_tr_b16 v[44:45], v14 offset:10360
    ds_read_b64_tr_b16 v[46:47], v14 offset:11640
    s_waitcnt lgkmcnt(12)
    v_mfma_f32_16x16x32_bf16 v[80:83], v[216:219], v[28:31], v[80:83]
    v_mfma_f32_16x16x32_bf16 v[84:87], v[220:223], v[28:31], v[84:87]
    ds_read_b64_tr_b16 v[24:25], v16 offset:10272
    ds_read_b64_tr_b16 v[26:27], v16 offset:11552
    s_waitcnt lgkmcnt(8)
    v_mfma_f32_16x16x32_bf16 v[48:51], v[224:227], v[32:35], v[48:51]
    v_mfma_f32_16x16x32_bf16 v[52:55], v[228:231], v[32:35], v[52:55]
    ds_read_b64_tr_b16 v[28:29], v14 offset:20480
    ds_read_b64_tr_b16 v[30:31], v14 offset:21760
    s_waitcnt lgkmcnt(8)
    v_mfma_f32_16x16x32_bf16 v[56:59], v[224:227], v[36:39], v[56:59]
    v_mfma_f32_16x16x32_bf16 v[60:63], v[228:231], v[36:39], v[60:63]
    ds_read_b64_tr_b16 v[32:33], v14 offset:20520
    ds_read_b64_tr_b16 v[34:35], v14 offset:21800
    s_waitcnt lgkmcnt(8)
    v_mfma_f32_16x16x32_bf16 v[64:67], v[224:227], v[40:43], v[64:67]
    v_mfma_f32_16x16x32_bf16 v[68:71], v[228:231], v[40:43], v[68:71]
    ds_read_b64_tr_b16 v[36:37], v14 offset:20560
    ds_read_b64_tr_b16 v[38:39], v14 offset:21840
    s_waitcnt lgkmcnt(8)
    v_mfma_f32_16x16x32_bf16 v[72:75], v[224:227], v[44:47], v[72:75]
    v_mfma_f32_16x16x32_bf16 v[76:79], v[228:231], v[44:47], v[76:79]
    ds_read_b64_tr_b16 v[40:41], v14 offset:20600
    ds_read_b64_tr_b16 v[42:43], v14 offset:21880
    s_waitcnt lgkmcnt(8)
    v_mfma_f32_16x16x32_bf16 v[80:83], v[224:227], v[24:27], v[80:83]
    v_mfma_f32_16x16x32_bf16 v[84:87], v[228:231], v[24:27], v[84:87]
    ds_read_b64_tr_b16 v[44:45], v16 offset:20512
    ds_read_b64_tr_b16 v[46:47], v16 offset:21792
    s_waitcnt lgkmcnt(8)
    v_mfma_f32_16x16x32_bf16 v[48:51], v[232:235], v[28:31], v[48:51]
    v_mfma_f32_16x16x32_bf16 v[52:55], v[236:239], v[28:31], v[52:55]
    s_waitcnt vmcnt(5)
    s_barrier
    ds_read_b128 v[240:243], v17 offset:40960
    ds_read_b128 v[244:247], v17 offset:43008
    ds_read_b128 v[248:251], v18 offset:40960
    ds_read_b128 v[252:255], v18 offset:43008
    ds_read_b64_tr_b16 v[24:25], v14 offset:30720
    ds_read_b64_tr_b16 v[26:27], v14 offset:32000
    s_waitcnt lgkmcnt(12)
    v_mfma_f32_16x16x32_bf16 v[56:59], v[232:235], v[32:35], v[56:59]
    v_mfma_f32_16x16x32_bf16 v[60:63], v[236:239], v[32:35], v[60:63]
    s_add_u32 m0, s43, 49152
    s_nop 0
    buffer_load_dwordx4 v9, s[12:15], s48 offen lds
    ds_read_b64_tr_b16 v[28:29], v14 offset:30760
    ds_read_b64_tr_b16 v[30:31], v14 offset:32040
    s_waitcnt lgkmcnt(12)
    v_mfma_f32_16x16x32_bf16 v[64:67], v[232:235], v[36:39], v[64:67]
    v_mfma_f32_16x16x32_bf16 v[68:71], v[236:239], v[36:39], v[68:71]
    ds_read_b64_tr_b16 v[32:33], v14 offset:30800
    ds_read_b64_tr_b16 v[34:35], v14 offset:32080
    s_waitcnt lgkmcnt(12)
    v_mfma_f32_16x16x32_bf16 v[72:75], v[232:235], v[40:43], v[72:75]
    v_mfma_f32_16x16x32_bf16 v[76:79], v[236:239], v[40:43], v[76:79]
    ds_read_b64_tr_b16 v[36:37], v14 offset:30840
    ds_read_b64_tr_b16 v[38:39], v14 offset:32120
    s_waitcnt lgkmcnt(12)
    v_mfma_f32_16x16x32_bf16 v[80:83], v[232:235], v[44:47], v[80:83]
    v_mfma_f32_16x16x32_bf16 v[84:87], v[236:239], v[44:47], v[84:87]
    ds_read_b64_tr_b16 v[40:41], v16 offset:30752
    ds_read_b64_tr_b16 v[42:43], v16 offset:32032
    s_waitcnt lgkmcnt(8)
    v_mfma_f32_16x16x32_bf16 v[48:51], v[240:243], v[24:27], v[48:51]
    v_mfma_f32_16x16x32_bf16 v[52:55], v[244:247], v[24:27], v[52:55]
    ds_read_b64_tr_b16 v[44:45], v14 offset:40960
    ds_read_b64_tr_b16 v[46:47], v14 offset:42240
    s_waitcnt lgkmcnt(8)
    v_mfma_f32_16x16x32_bf16 v[56:59], v[240:243], v[28:31], v[56:59]
    v_mfma_f32_16x16x32_bf16 v[60:63], v[244:247], v[28:31], v[60:63]
    ds_read_b64_tr_b16 v[24:25], v14 offset:41000
    ds_read_b64_tr_b16 v[26:27], v14 offset:42280
    s_waitcnt lgkmcnt(8)
    v_mfma_f32_16x16x32_bf16 v[64:67], v[240:243], v[32:35], v[64:67]
    v_mfma_f32_16x16x32_bf16 v[68:71], v[244:247], v[32:35], v[68:71]
    ds_read_b64_tr_b16 v[28:29], v14 offset:41040
    ds_read_b64_tr_b16 v[30:31], v14 offset:42320
    s_waitcnt lgkmcnt(8)
    v_mfma_f32_16x16x32_bf16 v[72:75], v[240:243], v[36:39], v[72:75]
    v_mfma_f32_16x16x32_bf16 v[76:79], v[244:247], v[36:39], v[76:79]
    ds_read_b64_tr_b16 v[32:33], v14 offset:41080
    ds_read_b64_tr_b16 v[34:35], v14 offset:42360
    s_waitcnt lgkmcnt(8)
    v_mfma_f32_16x16x32_bf16 v[80:83], v[240:243], v[40:43], v[80:83]
    v_mfma_f32_16x16x32_bf16 v[84:87], v[244:247], v[40:43], v[84:87]
    ds_read_b64_tr_b16 v[36:37], v16 offset:40992
    ds_read_b64_tr_b16 v[38:39], v16 offset:42272
    s_waitcnt lgkmcnt(8)
    v_mfma_f32_16x16x32_bf16 v[48:51], v[248:251], v[44:47], v[48:51]
    v_mfma_f32_16x16x32_bf16 v[52:55], v[252:255], v[44:47], v[52:55]
    s_waitcnt lgkmcnt(6)
    v_mfma_f32_16x16x32_bf16 v[56:59], v[248:251], v[24:27], v[56:59]
    v_mfma_f32_16x16x32_bf16 v[60:63], v[252:255], v[24:27], v[60:63]
    s_waitcnt lgkmcnt(4)
    v_mfma_f32_16x16x32_bf16 v[64:67], v[248:251], v[28:31], v[64:67]
    v_mfma_f32_16x16x32_bf16 v[68:71], v[252:255], v[28:31], v[68:71]
    s_waitcnt lgkmcnt(2)
    v_mfma_f32_16x16x32_bf16 v[72:75], v[248:251], v[32:35], v[72:75]
    v_mfma_f32_16x16x32_bf16 v[76:79], v[252:255], v[32:35], v[76:79]
    s_waitcnt lgkmcnt(0)
    v_mfma_f32_16x16x32_bf16 v[80:83], v[248:251], v[36:39], v[80:83]
    v_mfma_f32_16x16x32_bf16 v[84:87], v[252:255], v[36:39], v[84:87]
    buffer_store_dwordx4 v[88:91], v92, s[32:35], s17 offen sc1
    s_mov_b64 exec, 0xffff
    buffer_store_dwordx4 v[88:91], v92, s[32:35], s17 offen offset:1024 sc1
    s_mov_b64 exec, -1
    v_cvt_pk_bf16_f32 v48, v48, v49
    v_cvt_pk_bf16_f32 v49, v50, v51
    v_cvt_pk_bf16_f32 v50, v52, v53
    v_cvt_pk_bf16_f32 v51, v54, v55
    v_add_u32 v3, 1024, v92
    v_cvt_pk_bf16_f32 v56, v56, v57
    v_cvt_pk_bf16_f32 v57, v58, v59
    v_cvt_pk_bf16_f32 v58, v60, v61
    v_cvt_pk_bf16_f32 v59, v62, v63
    v_cvt_pk_bf16_f32 v64, v64, v65
    v_cvt_pk_bf16_f32 v65, v66, v67
    v_cvt_pk_bf16_f32 v66, v68, v69
    v_cvt_pk_bf16_f32 v67, v70, v71
    v_cvt_pk_bf16_f32 v72, v72, v73
    v_cvt_pk_bf16_f32 v73, v74, v75
    v_cvt_pk_bf16_f32 v74, v76, v77
    v_cvt_pk_bf16_f32 v75, v78, v79
    v_cvt_pk_bf16_f32 v80, v80, v81
    v_cvt_pk_bf16_f32 v81, v82, v83
    v_cvt_pk_bf16_f32 v82, v84, v85
    v_cvt_pk_bf16_f32 v83, v86, v87
    buffer_store_dwordx4 v[80:83], v20, s[32:35], s60 offen offset:2048 sc1
L_q:
    v_lshrrev_b32 v17, 2, v1
    v_and_b32 v21, 3, v1
    v_mul_u32_u24 v17, 160, v17
    v_lshl_add_u32 v17, v21, 3, v17
    v_lshl_add_u32 v20, v21, 5, v17
    v_add_u32 v18, 102400, v17
    v_add_u32 v21, 102400, v20
    s_lshl_b32 s7, s4, 3
    s_add_u32 s7, s7, s6
    s_lshl_b32 s54, s7, 4
    s_add_u32 s54, s54, s5
    s_lshl_b32 s55, s54, 7
    s_lshl_b32 s54, s54, 3
    s_lshl_b32 s52, s5, 4
    s_add_u32 s52, s52, s7
    s_lshl_b32 s52, s52, 3
    s_add_u32 s55, s55, 18366464
    s_add_u32 s54, s54, 18358272
    s_add_u32 s52, s52, 18362368
    v_mov_b32 v22, s36
    v_mov_b32 v23, s37
    s_cmp_ge_u32 s3, 4
    s_cbranch_scc1 L_q1
    buffer_store_dwordx4 v[48:51], v3, s[32:35], s60 offen sc1
    s_add_u32 s7, s60, 163840
    buffer_store_dwordx4 v[56:59], v3, s[32:35], s7 offen sc1
    s_add_u32 s7, s60, 327680
    buffer_store_dwordx4 v[64:67], v3, s[32:35], s7 offen sc1
    s_add_u32 s7, s60, 491520
    buffer_store_dwordx4 v[72:75], v3, s[32:35], s7 offen sc1
    s_waitcnt vmcnt(7)
    s_barrier
    ds_read_b64_tr_b16 v[24:25], v17 offset:0
    ds_read_b64_tr_b16 v[26:27], v17 offset:2560
    ds_read_b64_tr_b16 v[28:29], v17 offset:40
    ds_read_b64_tr_b16 v[30:31], v17 offset:2600
    ds_read_b64_tr_b16 v[32:33], v20 offset:32
    ds_read_b64_tr_b16 v[34:35], v20 offset:2592
    ds_read_b64_tr_b16 v[36:37], v17 offset:5120
    ds_read_b64_tr_b16 v[38:39], v17 offset:7680
    ds_read_b64_tr_b16 v[40:41], v17 offset:5160
    ds_read_b64_tr_b16 v[42:43], v17 offset:7720
    s_waitcnt lgkmcnt(8)
    v_mfma_f32_16x16x32_bf16 v[52:55], v[24:27], v[96:99], 0
    v_mfma_f32_16x16x32_bf16 v[60:63], v[24:27], v[100:103], 0
    s_mov_b32 m0, s58
    s_nop 0
    buffer_load_dwordx4 v10, s[12:15], s57 offen lds
    ds_read_b64_tr_b16 v[44:45], v20 offset:5152
    ds_read_b64_tr_b16 v[46:47], v20 offset:7712
    s_waitcnt lgkmcnt(8)
    v_mfma_f32_16x16x32_bf16 v[68:71], v[28:31], v[96:99], 0
    v_mfma_f32_16x16x32_bf16 v[76:79], v[28:31], v[100:103], 0
    s_add_u32 m0, s43, 106496
    s_nop 0
    buffer_load_dwordx4 v11, s[12:15], s49 offen lds
    ds_read_b64_tr_b16 v[24:25], v17 offset:10240
    ds_read_b64_tr_b16 v[26:27], v17 offset:12800
    s_waitcnt lgkmcnt(8)
    v_mfma_f32_16x16x32_bf16 v[84:87], v[32:35], v[96:99], 0
    v_mfma_f32_16x16x32_bf16 v[88:91], v[32:35], v[100:103], 0
    s_add_u32 m0, s43, 114688
    s_nop 0
    buffer_load_dwordx4 v12, s[12:15], s49 offen lds
    ds_read_b64_tr_b16 v[28:29], v17 offset:10280
    ds_read_b64_tr_b16 v[30:31], v17 offset:12840
    s_waitcnt lgkmcnt(8)
    v_mfma_f32_16x16x32_bf16 v[52:55], v[36:39], v[104:107], v[52:55]
    v_mfma_f32_16x16x32_bf16 v[60:63], v[36:39], v[108:111], v[60:63]
    s_add_u32 m0, s43, 122880
    s_nop 0
    buffer_load_dwordx4 v8, s[12:15], s50 offen lds
    ds_read_b64_tr_b16 v[32:33], v20 offset:10272
    ds_read_b64_tr_b16 v[34:35], v20 offset:12832
    s_waitcnt lgkmcnt(8)
    v_mfma_f32_16x16x32_bf16 v[68:71], v[40:43], v[104:107], v[68:71]
    v_mfma_f32_16x16x32_bf16 v[76:79], v[40:43], v[108:111], v[76:79]
    s_add_u32 m0, s43, 131072
    s_nop 0
    buffer_load_dwordx4 v9, s[12:15], s50 offen lds
    ds_read_b64_tr_b16 v[36:37], v17 offset:15360
    ds_read_b64_tr_b16 v[38:39], v17 offset:17920
    s_waitcnt lgkmcnt(8)
    v_mfma_f32_16x16x32_bf16 v[84:87], v[44:47], v[104:107], v[84:87]
    v_mfma_f32_16x16x32_bf16 v[88:91], v[44:47], v[108:111], v[88:91]
    s_cmp_ge_u32 s3, 4
    s_cbranch_scc1 L_nq12_0
    s_add_u32 m0, s43, 139264
    s_nop 0
    buffer_load_dwordx4 v10, s[12:15], s50 offen lds
L_nq12_0:
    ds_read_b64_tr_b16 v[40:41], v17 offset:15400
    ds_read_b64_tr_b16 v[42:43], v17 offset:17960
    s_waitcnt lgkmcnt(8)
    v_mfma_f32_16x16x32_bf16 v[52:55], v[24:27], v[112:115], v[52:55]
    v_mfma_f32_16x16x32_bf16 v[60:63], v[24:27], v[116:119], v[60:63]
    v_and_b32 v10, 15, v1
    v_bfe_u32 v11, v1, 1, 3
    v_min_u32 v11, 2, v11
    v_sub_u32 v11, s5, v11
    v_max_i32 v11, 0, v11
    v_and_b32 v12, 1, v1
    v_lshl_add_u32 v11, v12, 4, v11
    v_add_u32 v11, 0x80, v11
    v_cndmask_b32_e64 v11, v11, v1, s[62:63]
    s_and_b32 s7, s6, 6
    s_lshl_b32 s7, s7, 4
    s_add_u32 s7, s7, 2294784
    v_add_lshl_u32 v6, v11, s7, 3
    s_mov_b32 s40, -275365888
    v_lshl_add_u32 v0, v6, 4, s40
    s_lshl_b32 s40, s5, 4
    s_add_u32 s40, s40, 2295296
    v_add_lshl_u32 v10, v10, s40, 3
    s_mov_b32 s68, 0
    s_mov_b32 s69, 0xffff0000
    v_cndmask_b32_e64 v6, v6, v10, s[68:69]
    v_lshlrev_b32 v2, 4, v1
    v_lshlrev_b32 v3, 3, v1
    s_lshl_b32 s53, s5, 1
    s_add_u32 s53, s53, s4
    s_lshl_b32 s53, s53, 1
    ds_read_b64_tr_b16 v[44:45], v20 offset:15392
    ds_read_b64_tr_b16 v[46:47], v20 offset:17952
    s_waitcnt lgkmcnt(8)
    v_mfma_f32_16x16x32_bf16 v[68:71], v[28:31], v[112:115], v[68:71]
    v_mfma_f32_16x16x32_bf16 v[76:79], v[28:31], v[116:119], v[76:79]
    s_lshl_b32 s46, s6, 2
    s_add_u32 s46, s46, s45
    s_mul_i32 s46, s46, 163840
    v_and_b32 v10, 31, v1
    v_lshrrev_b32 v11, 5, v1
    ds_read_b64_tr_b16 v[24:25], v17 offset:20480
    ds_read_b64_tr_b16 v[26:27], v17 offset:23040
    s_waitcnt lgkmcnt(8)
    v_mfma_f32_16x16x32_bf16 v[84:87], v[32:35], v[112:115], v[84:87]
    v_mfma_f32_16x16x32_bf16 v[88:91], v[32:35], v[116:119], v[88:91]
    v_lshlrev_b32 v12, 4, v10
    v_lshl_add_u32 v4, v11, 8, v12
    v_lshl_add_u32 v12, v11, 6, v12
    v_add_u32 v5, 512, v4
    ds_read_b64_tr_b16 v[28:29], v17 offset:20520
    ds_read_b64_tr_b16 v[30:31], v17 offset:23080
    s_waitcnt lgkmcnt(8)
    v_mfma_f32_16x16x32_bf16 v[52:55], v[36:39], v[120:123], v[52:55]
    v_mfma_f32_16x16x32_bf16 v[60:63], v[36:39], v[124:127], v[60:63]
    v_add_u32 v15, 768, v12
    v_add_u32 v12, 896, v12
    v_cmp_gt_u32 vcc, 16, v10
    s_nop 1
    v_cndmask_b32 v4, v15, v4, vcc
    v_cndmask_b32 v5, v12, v5, vcc
    ds_read_b64_tr_b16 v[32:33], v20 offset:20512
    ds_read_b64_tr_b16 v[34:35], v20 offset:23072
    s_waitcnt lgkmcnt(8)
    v_mfma_f32_16x16x32_bf16 v[68:71], v[40:43], v[120:123], v[68:71]
    v_mfma_f32_16x16x32_bf16 v[76:79], v[40:43], v[124:127], v[76:79]
    v_mov_b32 v7, s39
    s_mov_b32 s64, 0xfffff
    s_mov_b32 s65, 0xfffff
    s_mov_b64 s[66:67], 0
    v_mov_b32 v15, 0xf149f2ca
    ds_read_b64_tr_b16 v[36:37], v17 offset:25600
    ds_read_b64_tr_b16 v[38:39], v17 offset:28160
    s_waitcnt lgkmcnt(8)
    v_mfma_f32_16x16x32_bf16 v[84:87], v[44:47], v[120:123], v[84:87]
    v_mfma_f32_16x16x32_bf16 v[88:91], v[44:47], v[124:127], v[88:91]
    s_mul_i32 s24, s44, 9
    s_add_u32 s24, s24, s53
    s_sub_u32 s24, s24, 8
    s_lshl_b32 s25, s44, 1
    s_sub_u32 s25, 1, s25
    s_add_u32 s70, s46, 5242880
    ds_read_b64_tr_b16 v[40:41], v17 offset:25640
    ds_read_b64_tr_b16 v[42:43], v17 offset:28200
    s_waitcnt lgkmcnt(8)
    v_mfma_f32_16x16x32_bf16 v[52:55], v[24:27], v[128:131], v[52:55]
    v_mfma_f32_16x16x32_bf16 v[60:63], v[24:27], v[132:135], v[60:63]
    s_cmp_lt_i32 s24, 0
    s_cselect_b32 s56, 0, s24
    s_cselect_b32 s17, 0x3f800000, 0
    s_or_b32 s17, s17, 0x3f80
    s_mul_i32 s56, s56, 2560
    s_add_u32 s56, s56, s70
    s_add_u32 s24, s24, s25
    ds_read_b64_tr_b16 v[44:45], v20 offset:25632
    ds_read_b64_tr_b16 v[46:47], v20 offset:28192
    s_waitcnt lgkmcnt(8)
    v_mfma_f32_16x16x32_bf16 v[68:71], v[28:31], v[128:131], v[68:71]
    v_mfma_f32_16x16x32_bf16 v[76:79], v[28:31], v[132:135], v[76:79]
    ds_read_b64_tr_b16 v[24:25], v17 offset:30720
    ds_read_b64_tr_b16 v[26:27], v17 offset:33280
    s_waitcnt lgkmcnt(8)
    v_mfma_f32_16x16x32_bf16 v[84:87], v[32:35], v[128:131], v[84:87]
    v_mfma_f32_16x16x32_bf16 v[88:91], v[32:35], v[132:135], v[88:91]
    s_cmp_lt_i32 s24, 0
    s_cselect_b32 s57, 0, s24
    s_cselect_b32 s18, 0x3f800000, 0
    s_or_b32 s18, s18, 0x3f80
    s_mul_i32 s57, s57, 2560
    s_add_u32 s57, s57, s70
    s_add_u32 s24, s24, s25
    ds_read_b64_tr_b16 v[28:29], v17 offset:30760
    ds_read_b64_tr_b16 v[30:31], v17 offset:33320
    s_waitcnt lgkmcnt(8)
    v_mfma_f32_16x16x32_bf16 v[52:55], v[36:39], v[136:139], v[52:55]
    v_mfma_f32_16x16x32_bf16 v[60:63], v[36:39], v[140:143], v[60:63]
    s_cmp_lt_i32 s24, 0
    s_cselect_b32 s58, 0, s24
    s_cselect_b32 s19, 0x3f800000, 0
    s_or_b32 s19, s19, 0x3f80
    s_mul_i32 s58, s58, 2560
    s_add_u32 s58, s58, s70
    s_add_u32 s24, s24, s25
    ds_read_b64_tr_b16 v[32:33], v20 offset:30752
    ds_read_b64_tr_b16 v[34:35], v20 offset:33312
    s_waitcnt lgkmcnt(8)
    v_mfma_f32_16x16x32_bf16 v[68:71], v[40:43], v[136:139], v[68:71]
    v_mfma_f32_16x16x32_bf16 v[76:79], v[40:43], v[140:143], v[76:79]
    s_cmp_lt_i32 s24, 0
    s_cselect_b32 s59, 0, s24
    s_cselect_b32 s30, 0x3f800000, 0
    s_or_b32 s30, s30, 0x3f80
    s_mul_i32 s59, s59, 2560
    s_add_u32 s59, s59, s70
    s_add_u32 s24, s24, s25
    ds_read_b64_tr_b16 v[36:37], v17 offset:35840
    ds_read_b64_tr_b16 v[38:39], v17 offset:38400
    s_waitcnt lgkmcnt(8)
    v_mfma_f32_16x16x32_bf16 v[84:87], v[44:47], v[136:139], v[84:87]
    v_mfma_f32_16x16x32_bf16 v[88:91], v[44:47], v[140:143], v[88:91]
    ds_read_b64_tr_b16 v[40:41], v17 offset:35880
    ds_read_b64_tr_b16 v[42:43], v17 offset:38440
    s_waitcnt lgkmcnt(8)
    v_mfma_f32_16x16x32_bf16 v[52:55], v[24:27], v[144:147], v[52:55]
    v_mfma_f32_16x16x32_bf16 v[60:63], v[24:27], v[148:151], v[60:63]
    s_cmp_lt_i32 s24, 0
    s_cselect_b32 s60, 0, s24
    s_cselect_b32 s31, 0x3f800000, 0
    s_or_b32 s31, s31, 0x3f80
    s_mul_i32 s60, s60, 2560
    s_add_u32 s60, s60, s70
    ds_read_b64_tr_b16 v[44:45], v20 offset:35872
    ds_read_b64_tr_b16 v[46:47], v20 offset:38432
    s_waitcnt lgkmcnt(8)
    v_mfma_f32_16x16x32_bf16 v[68:71], v[28:31], v[144:147], v[68:71]
    v_mfma_f32_16x16x32_bf16 v[76:79], v[28:31], v[148:151], v[76:79]
    s_cmp_eq_u32 s4, 0
    s_cselect_b32 s24, s31, s18
    s_cselect_b32 s25, s30, s17
    s_cselect_b32 s8, s20, s26
    s_cselect_b32 s9, s21, s27
    s_mov_b32 s10, 819200
    s_mov_b32 s12, s28
    s_mov_b32 s13, s29
    s_mov_b32 s14, 5242880
    ds_read_b64_tr_b16 v[24:25], v17 offset:40960
    ds_read_b64_tr_b16 v[26:27], v17 offset:43520
    s_waitcnt lgkmcnt(8)
    v_mfma_f32_16x16x32_bf16 v[84:87], v[32:35], v[144:147], v[84:87]
    v_mfma_f32_16x16x32_bf16 v[88:91], v[32:35], v[148:151], v[88:91]
    ds_read_b64_tr_b16 v[28:29], v17 offset:41000
    ds_read_b64_tr_b16 v[30:31], v17 offset:43560
    s_waitcnt lgkmcnt(8)
    v_mfma_f32_16x16x32_bf16 v[52:55], v[36:39], v[152:155], v[52:55]
    v_mfma_f32_16x16x32_bf16 v[60:63], v[36:39], v[156:159], v[60:63]
    s_max_u32 s61, s53, 1
    s_sub_u32 s61, s61, 1
    s_mul_i32 s61, s61, 2560
    s_add_u32 s61, s61, s70
    ds_read_b64_tr_b16 v[32:33], v20 offset:40992
    ds_read_b64_tr_b16 v[34:35], v20 offset:43552
    s_waitcnt lgkmcnt(8)
    v_mfma_f32_16x16x32_bf16 v[68:71], v[40:43], v[152:155], v[68:71]
    v_mfma_f32_16x16x32_bf16 v[76:79], v[40:43], v[156:159], v[76:79]
    s_lshl_b32 s50, s44, 2
    s_add_u32 s50, s50, s5
    s_and_b32 s50, s50, 7
    s_mul_i32 s26, s50, 0x11111111
    s_add_u32 s26, s26, 0x76543210
    s_and_b32 s26, s26, 0x77777777
    s_waitcnt vmcnt(5)
    s_barrier
    s_cmp_lg_u32 s3, 0
    s_cbranch_scc1 L_nof1
    s_mov_b64 exec, 1
    buffer_store_dwordx2 v[22:23], off, s[32:35], s55 sc1
    buffer_store_dwordx2 v[22:23], off, s[32:35], s54 sc1
    s_mov_b64 exec, -1
L_nof1:
    ds_read_b64_tr_b16 v[36:37], v17 offset:46080
    ds_read_b64_tr_b16 v[38:39], v17 offset:48640
    s_waitcnt lgkmcnt(8)
    v_mfma_f32_16x16x32_bf16 v[84:87], v[44:47], v[152:155], v[84:87]
    v_mfma_f32_16x16x32_bf16 v[88:91], v[44:47], v[156:159], v[88:91]
    s_bitcmp1_b32 s5, 3
    s_cselect_b32 s27, 0, 16
    s_lshl_b32 s27, 0x8888, s27
    s_or_b32 s26, s26, s27
    s_and_b32 s50, s26, 15
    ds_read_b64_tr_b16 v[40:41], v17 offset:46120
    ds_read_b64_tr_b16 v[42:43], v17 offset:48680
    s_waitcnt lgkmcnt(8)
    v_mfma_f32_16x16x32_bf16 v[52:55], v[24:27], v[160:163], v[52:55]
    v_mfma_f32_16x16x32_bf16 v[60:63], v[24:27], v[164:167], v[60:63]
    s_xor_b32 s47, s41, 128
    s_lshl_b32 s47, s47, 3
    s_add_u32 s47, s47, s45
    s_mul_i32 s47, s47, 1280
    s_add_u32 s47, s47, 10485760
    ds_read_b64_tr_b16 v[44:45], v20 offset:46112
    ds_read_b64_tr_b16 v[46:47], v20 offset:48672
    s_waitcnt lgkmcnt(8)
    v_mfma_f32_16x16x32_bf16 v[68:71], v[28:31], v[160:163], v[68:71]
    v_mfma_f32_16x16x32_bf16 v[76:79], v[28:31], v[164:167], v[76:79]
    s_xor_b32 s7, s54, 1024
    v_writelane_b32 v6, s7, 47
    s_and_b32 s23, s45, 1
    s_lshl_b32 s23, s23, 1
    s_add_u32 s23, s23, s44
    s_lshl_b32 s22, s41, 2
    s_add_u32 s22, s22, s23
    s_mul_i32 s22, s22, 2560
    s_mul_i32 s23, s23, 2560
    s_add_u32 s22, s22, 10485760
    s_add_u32 s23, s23, 143360
    ds_read_b64_tr_b16 v[24:25], v17 offset:51200
    ds_read_b64_tr_b16 v[26:27], v17 offset:53760
    s_waitcnt lgkmcnt(8)
    v_mfma_f32_16x16x32_bf16 v[84:87], v[32:35], v[160:163], v[84:87]
    v_mfma_f32_16x16x32_bf16 v[88:91], v[32:35], v[164:167], v[88:91]
    ds_read_b64_tr_b16 v[28:29], v17 offset:51240
    ds_read_b64_tr_b16 v[30:31], v17 offset:53800
    s_waitcnt lgkmcnt(8)
    v_mfma_f32_16x16x32_bf16 v[52:55], v[36:39], v[168:171], v[52:55]
    v_mfma_f32_16x16x32_bf16 v[60:63], v[36:39], v[172:175], v[60:63]
    s_mul_i32 s7, s45, 1280
    s_mul_i32 s40, s44, 5120
    s_add_u32 s7, s7, 143360
    s_add_u32 s70, s7, s40
    s_sub_u32 s7, s7, s40
    v_add_u32 v92, s7, v2
    v_add_u32 v94, s70, v2
    v_add_u32 v95, s7, v3
    v_add_u32 v16, s70, v3
    ds_read_b64_tr_b16 v[32:33], v20 offset:51232
    ds_read_b64_tr_b16 v[34:35], v20 offset:53792
    s_waitcnt lgkmcnt(8)
    v_mfma_f32_16x16x32_bf16 v[68:71], v[40:43], v[168:171], v[68:71]
    v_mfma_f32_16x16x32_bf16 v[76:79], v[40:43], v[172:175], v[76:79]
    s_waitcnt vmcnt(2)
    s_barrier
    ds_read_b64_tr_b16 v[36:37], v17 offset:56320
    ds_read_b64_tr_b16 v[38:39], v17 offset:58880
    s_waitcnt lgkmcnt(8)
    v_mfma_f32_16x16x32_bf16 v[84:87], v[44:47], v[168:171], v[84:87]
    v_mfma_f32_16x16x32_bf16 v[88:91], v[44:47], v[172:175], v[88:91]
    v_mul_u32_u24 v13, 6554, v1
    v_lshrrev_b32 v13, 16, v13
    v_mul_u32_u24 v13, 1120, v13
    v_add_u32 v13, v13, v2
    ds_read_b64_tr_b16 v[40:41], v17 offset:56360
    ds_read_b64_tr_b16 v[42:43], v17 offset:58920
    s_waitcnt lgkmcnt(8)
    v_mfma_f32_16x16x32_bf16 v[52:55], v[24:27], v[176:179], v[52:55]
    v_mfma_f32_16x16x32_bf16 v[60:63], v[24:27], v[180:183], v[60:63]
    s_mul_i32 s51, s3, 40
    s_add_u32 s51, s51, s6
    s_mul_i32 s51, s51, 160
    s_mul_i32 m0, s3, 800
    s_mul_i32 s7, s3, 3072
    s_add_u32 s7, s7, 102656
    v_add_u32 v14, s7, v2
    ds_read_b64_tr_b16 v[44:45], v20 offset:56352
    ds_read_b64_tr_b16 v[46:47], v20 offset:58912
    s_waitcnt lgkmcnt(8)
    v_mfma_f32_16x16x32_bf16 v[68:71], v[28:31], v[176:179], v[68:71]
    v_mfma_f32_16x16x32_bf16 v[76:79], v[28:31], v[180:183], v[76:79]
    s_lshl_b32 s42, s4, 6
    s_add_u32 s42, s42, s53
    s_lshr_b32 s7, s45, 1
    s_add_u32 s42, s42, s7
    s_lshl_b32 s42, s42, 1
    s_add_u32 s42, s42, s44
    s_mul_i32 s42, s42, 20480
    s_add_u32 s42, s42, 13107200
    ds_read_b64_tr_b16 v[24:25], v18 offset:0
    ds_read_b64_tr_b16 v[26:27], v18 offset:2560
    s_waitcnt lgkmcnt(8)
    v_mfma_f32_16x16x32_bf16 v[84:87], v[32:35], v[176:179], v[84:87]
    v_mfma_f32_16x16x32_bf16 v[88:91], v[32:35], v[180:183], v[88:91]
    ds_read_b64_tr_b16 v[28:29], v18 offset:40
    ds_read_b64_tr_b16 v[30:31], v18 offset:2600
    s_waitcnt lgkmcnt(8)
    v_mfma_f32_16x16x32_bf16 v[52:55], v[36:39], v[184:187], v[52:55]
    v_mfma_f32_16x16x32_bf16 v[60:63], v[36:39], v[188:191], v[60:63]
    s_lshl_b32 s43, s53, 1
    s_add_u32 s43, s43, s45
    s_lshl_b32 s43, s43, 8
    s_lshl_b32 s7, s4, 3
    s_add_u32 s43, s43, s7
    s_add_u32 s43, s43, s6
    s_mul_i32 s43, s43, 160
    ds_read_b64_tr_b16 v[32:33], v21 offset:32
    ds_read_b64_tr_b16 v[34:35], v21 offset:2592
    s_waitcnt lgkmcnt(8)
    v_mfma_f32_16x16x32_bf16 v[68:71], v[40:43], v[184:187], v[68:71]
    v_mfma_f32_16x16x32_bf16 v[76:79], v[40:43], v[188:191], v[76:79]
    v_cmp_eq_u32 vcc, 20, v10
    v_mov_b32 v12, 0x3f803f80
    s_nop 0
    v_cndmask_b32 v134, 0, v12, vcc
    v_mov_b32 v135, v134
    ds_read_b64_tr_b16 v[36:37], v18 offset:5120
    ds_read_b64_tr_b16 v[38:39], v18 offset:7680
    s_waitcnt lgkmcnt(8)
    v_mfma_f32_16x16x32_bf16 v[84:87], v[44:47], v[184:187], v[84:87]
    v_mfma_f32_16x16x32_bf16 v[88:91], v[44:47], v[188:191], v[88:91]
    v_mov_b64 v[108:109], 0
    v_mov_b64 v[114:115], 0
    v_mov_b64 v[120:121], 0
    v_mov_b64 v[126:127], 0
    v_mov_b64 v[132:133], 0
    ds_read_b64_tr_b16 v[40:41], v18 offset:5160
    ds_read_b64_tr_b16 v[42:43], v18 offset:7720
    s_waitcnt lgkmcnt(8)
    v_mfma_f32_16x16x32_bf16 v[52:55], v[24:27], v[192:195], v[52:55]
    v_mfma_f32_16x16x32_bf16 v[60:63], v[24:27], v[196:199], v[60:63]
    v_mov_b64 v[142:143], v[134:135]
    v_mov_b64 v[144:145], v[134:135]
    v_mov_b64 v[146:147], v[134:135]
    v_mov_b64 v[148:149], v[134:135]
    v_mov_b32 v140, s24
    v_mov_b32 v141, 0
    ds_read_b64_tr_b16 v[44:45], v21 offset:5152
    ds_read_b64_tr_b16 v[46:47], v21 offset:7712
    s_waitcnt lgkmcnt(8)
    v_mfma_f32_16x16x32_bf16 v[68:71], v[28:31], v[192:195], v[68:71]
    v_mfma_f32_16x16x32_bf16 v[76:79], v[28:31], v[196:199], v[76:79]
    v_mov_b64 v[156:157], v[134:135]
    v_mov_b64 v[158:159], v[134:135]
    v_mov_b64 v[160:161], v[134:135]
    v_mov_b64 v[162:163], v[134:135]
    v_mov_b32 v154, s19
    v_mov_b32 v155, 0
    ds_read_b64_tr_b16 v[24:25], v18 offset:10240
    ds_read_b64_tr_b16 v[26:27], v18 offset:12800
    s_waitcnt lgkmcnt(8)
    v_mfma_f32_16x16x32_bf16 v[84:87], v[32:35], v[192:195], v[84:87]
    v_mfma_f32_16x16x32_bf16 v[88:91], v[32:35], v[196:199], v[88:91]
    v_mov_b64 v[170:171], v[134:135]
    v_mov_b64 v[172:173], v[134:135]
    v_mov_b64 v[174:175], v[134:135]
    v_mov_b64 v[176:177], v[134:135]
    v_mov_b32 v168, s30
    v_mov_b32 v169, 0
    ds_read_b64_tr_b16 v[28:29], v18 offset:10280
    ds_read_b64_tr_b16 v[30:31], v18 offset:12840
    s_waitcnt lgkmcnt(8)
    v_mfma_f32_16x16x32_bf16 v[52:55], v[36:39], v[200:203], v[52:55]
    v_mfma_f32_16x16x32_bf16 v[60:63], v[36:39], v[204:207], v[60:63]
    v_mov_b64 v[184:185], v[134:135]
    v_mov_b64 v[186:187], v[134:135]
    v_mov_b64 v[188:189], v[134:135]
    v_mov_b64 v[190:191], v[134:135]
    v_mov_b32 v182, s31
    v_mov_b32 v183, 0
    ds_read_b64_tr_b16 v[32:33], v21 offset:10272
    ds_read_b64_tr_b16 v[34:35], v21 offset:12832
    s_waitcnt lgkmcnt(8)
    v_mfma_f32_16x16x32_bf16 v[68:71], v[40:43], v[200:203], v[68:71]
    v_mfma_f32_16x16x32_bf16 v[76:79], v[40:43], v[204:207], v[76:79]
    ds_read_b64_tr_b16 v[36:37], v18 offset:15360
    ds_read_b64_tr_b16 v[38:39], v18 offset:17920
    s_waitcnt lgkmcnt(8)
    v_mfma_f32_16x16x32_bf16 v[84:87], v[44:47], v[200:203], v[84:87]
    v_mfma_f32_16x16x32_bf16 v[88:91], v[44:47], v[204:207], v[88:91]
    v_mov_b64 v[198:199], v[134:135]
    v_mov_b64 v[200:201], v[134:135]
    v_mov_b64 v[202:203], v[134:135]
    v_mov_b64 v[204:205], v[134:135]
    v_mov_b32 v196, s17
    v_mov_b32 v197, 0
    ds_read_b64_tr_b16 v[40:41], v18 offset:15400
    ds_read_b64_tr_b16 v[42:43], v18 offset:17960
    s_waitcnt lgkmcnt(8)
    v_mfma_f32_16x16x32_bf16 v[52:55], v[24:27], v[208:211], v[52:55]
    v_mfma_f32_16x16x32_bf16 v[60:63], v[24:27], v[212:215], v[60:63]
    ds_read_b64_tr_b16 v[44:45], v21 offset:15392
    ds_read_b64_tr_b16 v[46:47], v21 offset:17952
    s_waitcnt lgkmcnt(8)
    v_mfma_f32_16x16x32_bf16 v[68:71], v[28:31], v[208:211], v[68:71]
    v_mfma_f32_16x16x32_bf16 v[76:79], v[28:31], v[212:215], v[76:79]
    s_waitcnt vmcnt(0)
    s_barrier
    ds_read_b64_tr_b16 v[24:25], v18 offset:20480
    ds_read_b64_tr_b16 v[26:27], v18 offset:23040
    s_waitcnt lgkmcnt(8)
    v_mfma_f32_16x16x32_bf16 v[84:87], v[32:35], v[208:211], v[84:87]
    v_mfma_f32_16x16x32_bf16 v[88:91], v[32:35], v[212:215], v[88:91]
    ds_read_b64_tr_b16 v[28:29], v18 offset:20520
    ds_read_b64_tr_b16 v[30:31], v18 offset:23080
    s_waitcnt lgkmcnt(8)
    v_mfma_f32_16x16x32_bf16 v[52:55], v[36:39], v[216:219], v[52:55]
    v_mfma_f32_16x16x32_bf16 v[60:63], v[36:39], v[220:223], v[60:63]
    ds_read_b64_tr_b16 v[32:33], v21 offset:20512
    ds_read_b64_tr_b16 v[34:35], v21 offset:23072
    s_waitcnt lgkmcnt(8)
    v_mfma_f32_16x16x32_bf16 v[68:71], v[40:43], v[216:219], v[68:71]
    v_mfma_f32_16x16x32_bf16 v[76:79], v[40:43], v[220:223], v[76:79]
    ds_read_b64_tr_b16 v[36:37], v18 offset:25600
    ds_read_b64_tr_b16 v[38:39], v18 offset:28160
    s_waitcnt lgkmcnt(8)
    v_mfma_f32_16x16x32_bf16 v[84:87], v[44:47], v[216:219], v[84:87]
    v_mfma_f32_16x16x32_bf16 v[88:91], v[44:47], v[220:223], v[88:91]
    v_mov_b64 v[212:213], v[134:135]
    v_mov_b64 v[214:215], v[134:135]
    v_mov_b64 v[216:217], v[134:135]
    v_mov_b64 v[218:219], v[134:135]
    v_mov_b32 v210, s18
    v_mov_b32 v211, 0
    s_lshl_b32 s68, 0x10001, s50
    s_lshl_b32 s7, 0x10001, s5
    s_or_b32 s68, s68, s7
    s_cmp_eq_u32 s4, 0
    s_cselect_b32 s68, s68, 0
    s_cselect_b32 s69, 0, 0x3f
    s_mov_b64 exec, s[68:69]
    buffer_load_dwordx2 v[8:9], v0, s[32:35], 0 offen sc1
    s_mov_b64 exec, -1
    ds_read_b64_tr_b16 v[40:41], v18 offset:25640
    ds_read_b64_tr_b16 v[42:43], v18 offset:28200
    s_waitcnt lgkmcnt(8)
    v_mfma_f32_16x16x32_bf16 v[52:55], v[24:27], v[224:227], v[52:55]
    v_mfma_f32_16x16x32_bf16 v[60:63], v[24:27], v[228:231], v[60:63]
    ds_read_b64_tr_b16 v[44:45], v21 offset:25632
    ds_read_b64_tr_b16 v[46:47], v21 offset:28192
    s_waitcnt lgkmcnt(8)
    v_mfma_f32_16x16x32_bf16 v[68:71], v[28:31], v[224:227], v[68:71]
    v_mfma_f32_16x16x32_bf16 v[76:79], v[28:31], v[228:231], v[76:79]
    ds_read_b64_tr_b16 v[24:25], v18 offset:30720
    ds_read_b64_tr_b16 v[26:27], v18 offset:33280
    s_waitcnt lgkmcnt(8)
    v_mfma_f32_16x16x32_bf16 v[84:87], v[32:35], v[224:227], v[84:87]
    v_mfma_f32_16x16x32_bf16 v[88:91], v[32:35], v[228:231], v[88:91]
    ds_read_b64_tr_b16 v[28:29], v18 offset:30760
    ds_read_b64_tr_b16 v[30:31], v18 offset:33320
    s_waitcnt lgkmcnt(8)
    v_mfma_f32_16x16x32_bf16 v[52:55], v[36:39], v[232:235], v[52:55]
    v_mfma_f32_16x16x32_bf16 v[60:63], v[36:39], v[236:239], v[60:63]
    ds_read_b64_tr_b16 v[32:33], v21 offset:30752
    ds_read_b64_tr_b16 v[34:35], v21 offset:33312
    s_waitcnt lgkmcnt(8)
    v_mfma_f32_16x16x32_bf16 v[68:71], v[40:43], v[232:235], v[68:71]
    v_mfma_f32_16x16x32_bf16 v[76:79], v[40:43], v[236:239], v[76:79]
    ds_read_b64_tr_b16 v[36:37], v18 offset:35840
    ds_read_b64_tr_b16 v[38:39], v18 offset:38400
    s_waitcnt lgkmcnt(8)
    v_mfma_f32_16x16x32_bf16 v[84:87], v[44:47], v[232:235], v[84:87]
    v_mfma_f32_16x16x32_bf16 v[88:91], v[44:47], v[236:239], v[88:91]
    v_mov_b64 v[226:227], v[134:135]
    v_mov_b64 v[228:229], v[134:135]
    v_mov_b64 v[230:231], v[134:135]
    v_mov_b64 v[232:233], v[134:135]
    v_mov_b32 v224, s19
    v_mov_b32 v225, 0
    ds_read_b64_tr_b16 v[40:41], v18 offset:35880
    ds_read_b64_tr_b16 v[42:43], v18 offset:38440
    s_waitcnt lgkmcnt(8)
    v_mfma_f32_16x16x32_bf16 v[52:55], v[24:27], v[240:243], v[52:55]
    v_mfma_f32_16x16x32_bf16 v[60:63], v[24:27], v[244:247], v[60:63]
    ds_read_b64_tr_b16 v[44:45], v21 offset:35872
    ds_read_b64_tr_b16 v[46:47], v21 offset:38432
    s_waitcnt lgkmcnt(8)
    v_mfma_f32_16x16x32_bf16 v[68:71], v[28:31], v[240:243], v[68:71]
    v_mfma_f32_16x16x32_bf16 v[76:79], v[28:31], v[244:247], v[76:79]
    s_waitcnt lgkmcnt(6)
    v_mfma_f32_16x16x32_bf16 v[84:87], v[32:35], v[240:243], v[84:87]
    v_mfma_f32_16x16x32_bf16 v[88:91], v[32:35], v[244:247], v[88:91]
    v_mov_b64 v[240:241], v[134:135]
    v_mov_b64 v[242:243], v[134:135]
    v_mov_b64 v[244:245], v[134:135]
    v_mov_b64 v[246:247], v[134:135]
    v_mov_b32 v238, s25
    v_mov_b32 v239, 0
    s_waitcnt lgkmcnt(4)
    v_mfma_f32_16x16x32_bf16 v[52:55], v[36:39], v[248:251], v[52:55]
    v_mfma_f32_16x16x32_bf16 v[60:63], v[36:39], v[252:255], v[60:63]
    s_waitcnt lgkmcnt(2)
    v_mfma_f32_16x16x32_bf16 v[68:71], v[40:43], v[248:251], v[68:71]
    v_mfma_f32_16x16x32_bf16 v[76:79], v[40:43], v[252:255], v[76:79]
    s_waitcnt lgkmcnt(0)
    v_mfma_f32_16x16x32_bf16 v[84:87], v[44:47], v[248:251], v[84:87]
    v_mfma_f32_16x16x32_bf16 v[88:91], v[44:47], v[252:255], v[88:91]
    s_branch L_att
L_q1:
    s_waitcnt vmcnt(3)
    s_barrier
    ds_read_b64_tr_b16 v[24:25], v17 offset:80
    ds_read_b64_tr_b16 v[26:27], v17 offset:2640
    ds_read_b64_tr_b16 v[28:29], v17 offset:120
    ds_read_b64_tr_b16 v[30:31], v17 offset:2680
    ds_read_b64_tr_b16 v[32:33], v17 offset:5200
    ds_read_b64_tr_b16 v[34:35], v17 offset:7760
    ds_read_b64_tr_b16 v[36:37], v17 offset:5240
    ds_read_b64_tr_b16 v[38:39], v17 offset:7800
    ds_read_b64_tr_b16 v[40:41], v17 offset:10320
    ds_read_b64_tr_b16 v[42:43], v17 offset:12880
    s_waitcnt lgkmcnt(8)
    v_mfma_f32_16x16x32_bf16 v[52:55], v[24:27], v[96:99], 0
    v_mfma_f32_16x16x32_bf16 v[60:63], v[24:27], v[100:103], 0
    buffer_store_dwordx4 v[48:51], v3, s[32:35], s60 offen sc1
    ds_read_b64_tr_b16 v[44:45], v17 offset:10360
    ds_read_b64_tr_b16 v[46:47], v17 offset:12920
    s_waitcnt lgkmcnt(8)
    v_mfma_f32_16x16x32_bf16 v[68:71], v[28:31], v[96:99], 0
    v_mfma_f32_16x16x32_bf16 v[76:79], v[28:31], v[100:103], 0
    s_add_u32 s7, s60, 163840
    buffer_store_dwordx4 v[56:59], v3, s[32:35], s7 offen sc1
    ds_read_b64_tr_b16 v[24:25], v17 offset:15440
    ds_read_b64_tr_b16 v[26:27], v17 offset:18000
    s_waitcnt lgkmcnt(8)
    v_mfma_f32_16x16x32_bf16 v[52:55], v[32:35], v[104:107], v[52:55]
    v_mfma_f32_16x16x32_bf16 v[60:63], v[32:35], v[108:111], v[60:63]
    s_add_u32 s7, s60, 327680
    buffer_store_dwordx4 v[64:67], v3, s[32:35], s7 offen sc1
    ds_read_b64_tr_b16 v[28:29], v17 offset:15480
    ds_read_b64_tr_b16 v[30:31], v17 offset:18040
    s_waitcnt lgkmcnt(8)
    v_mfma_f32_16x16x32_bf16 v[68:71], v[36:39], v[104:107], v[68:71]
    v_mfma_f32_16x16x32_bf16 v[76:79], v[36:39], v[108:111], v[76:79]
    s_add_u32 s7, s60, 491520
    buffer_store_dwordx4 v[72:75], v3, s[32:35], s7 offen sc1
    ds_read_b64_tr_b16 v[32:33], v17 offset:20560
    ds_read_b64_tr_b16 v[34:35], v17 offset:23120
    s_waitcnt lgkmcnt(8)
    v_mfma_f32_16x16x32_bf16 v[52:55], v[40:43], v[112:115], v[52:55]
    v_mfma_f32_16x16x32_bf16 v[60:63], v[40:43], v[116:119], v[60:63]
    s_mov_b32 m0, s58
    s_nop 0
    buffer_load_dwordx4 v10, s[12:15], s57 offen lds
    ds_read_b64_tr_b16 v[36:37], v17 offset:20600
    ds_read_b64_tr_b16 v[38:39], v17 offset:23160
    s_waitcnt lgkmcnt(8)
    v_mfma_f32_16x16x32_bf16 v[68:71], v[44:47], v[112:115], v[68:71]
    v_mfma_f32_16x16x32_bf16 v[76:79], v[44:47], v[116:119], v[76:79]
    s_add_u32 m0, s43, 106496
    s_nop 0
    buffer_load_dwordx4 v11, s[12:15], s49 offen lds
    ds_read_b64_tr_b16 v[40:41], v17 offset:25680
    ds_read_b64_tr_b16 v[42:43], v17 offset:28240
    s_waitcnt lgkmcnt(8)
    v_mfma_f32_16x16x32_bf16 v[52:55], v[24:27], v[120:123], v[52:55]
    v_mfma_f32_16x16x32_bf16 v[60:63], v[24:27], v[124:127], v[60:63]
    s_add_u32 m0, s43, 114688
    s_nop 0
    buffer_load_dwordx4 v12, s[12:15], s49 offen lds
    ds_read_b64_tr_b16 v[44:45], v17 offset:25720
    ds_read_b64_tr_b16 v[46:47], v17 offset:28280
    s_waitcnt lgkmcnt(8)
    v_mfma_f32_16x16x32_bf16 v[68:71], v[28:31], v[120:123], v[68:71]
    v_mfma_f32_16x16x32_bf16 v[76:79], v[28:31], v[124:127], v[76:79]
    s_add_u32 m0, s43, 122880
    s_nop 0
    buffer_load_dwordx4 v8, s[12:15], s50 offen lds
    ds_read_b64_tr_b16 v[24:25], v17 offset:30800
    ds_read_b64_tr_b16 v[26:27], v17 offset:33360
    s_waitcnt lgkmcnt(8)
    v_mfma_f32_16x16x32_bf16 v[52:55], v[32:35], v[128:131], v[52:55]
    v_mfma_f32_16x16x32_bf16 v[60:63], v[32:35], v[132:135], v[60:63]
    s_add_u32 m0, s43, 131072
    s_nop 0
    buffer_load_dwordx4 v9, s[12:15], s50 offen lds
    ds_read_b64_tr_b16 v[28:29], v17 offset:30840
    ds_read_b64_tr_b16 v[30:31], v17 offset:33400
    s_waitcnt lgkmcnt(8)
    v_mfma_f32_16x16x32_bf16 v[68:71], v[36:39], v[128:131], v[68:71]
    v_mfma_f32_16x16x32_bf16 v[76:79], v[36:39], v[132:135], v[76:79]
    v_and_b32 v10, 15, v1
    v_bfe_u32 v11, v1, 1, 3
    v_min_u32 v11, 2, v11
    v_sub_u32 v11, s5, v11
    v_max_i32 v11, 0, v11
    v_and_b32 v12, 1, v1
    v_lshl_add_u32 v11, v12, 4, v11
    v_add_u32 v11, 0x80, v11
    v_cndmask_b32_e64 v11, v11, v1, s[62:63]
    s_and_b32 s7, s6, 6
    s_lshl_b32 s7, s7, 4
    s_add_u32 s7, s7, 2294784
    v_add_lshl_u32 v6, v11, s7, 3
    s_mov_b32 s40, -275365888
    v_lshl_add_u32 v0, v6, 4, s40
    s_lshl_b32 s40, s5, 4
    s_add_u32 s40, s40, 2295296
    v_add_lshl_u32 v10, v10, s40, 3
    s_mov_b32 s68, 0
    s_mov_b32 s69, 0xffff0000
    v_cndmask_b32_e64 v6, v6, v10, s[68:69]
    v_lshlrev_b32 v2, 4, v1
    v_lshlrev_b32 v3, 3, v1
    s_lshl_b32 s53, s5, 1
    s_add_u32 s53, s53, s4
    s_lshl_b32 s53, s53, 1
    s_lshl_b32 s46, s6, 2
    s_add_u32 s46, s46, s45
    s_mul_i32 s46, s46, 163840
    v_and_b32 v10, 31, v1
    v_lshrrev_b32 v11, 5, v1
    v_lshlrev_b32 v12, 4, v10
    v_lshl_add_u32 v4, v11, 8, v12
    v_lshl_add_u32 v12, v11, 6, v12
    v_add_u32 v5, 512, v4
    v_add_u32 v15, 768, v12
    v_add_u32 v12, 896, v12
    v_cmp_gt_u32 vcc, 16, v10
    s_nop 1
    v_cndmask_b32 v4, v15, v4, vcc
    v_cndmask_b32 v5, v12, v5, vcc
    v_mov_b32 v7, s39
    s_mov_b32 s64, 0xfffff
    s_mov_b32 s65, 0xfffff
    s_mov_b64 s[66:67], 0
    v_mov_b32 v15, 0xf149f2ca
    s_mul_i32 s24, s44, 9
    s_add_u32 s24, s24, s53
    s_sub_u32 s24, s24, 8
    s_lshl_b32 s25, s44, 1
    s_sub_u32 s25, 1, s25
    s_add_u32 s70, s46, 5242880
    s_cmp_lt_i32 s24, 0
    s_cselect_b32 s56, 0, s24
    s_cselect_b32 s17, 0x3f800000, 0
    s_or_b32 s17, s17, 0x3f80
    s_mul_i32 s56, s56, 2560
    s_add_u32 s56, s56, s70
    s_add_u32 s24, s24, s25
    ds_read_b64_tr_b16 v[32:33], v17 offset:35920
    ds_read_b64_tr_b16 v[34:35], v17 offset:38480
    s_waitcnt lgkmcnt(8)
    v_mfma_f32_16x16x32_bf16 v[52:55], v[40:43], v[136:139], v[52:55]
    v_mfma_f32_16x16x32_bf16 v[60:63], v[40:43], v[140:143], v[60:63]
    s_cmp_lt_i32 s24, 0
    s_cselect_b32 s57, 0, s24
    s_cselect_b32 s18, 0x3f800000, 0
    s_or_b32 s18, s18, 0x3f80
    s_mul_i32 s57, s57, 2560
    s_add_u32 s57, s57, s70
    s_add_u32 s24, s24, s25
    ds_read_b64_tr_b16 v[36:37], v17 offset:35960
    ds_read_b64_tr_b16 v[38:39], v17 offset:38520
    s_waitcnt lgkmcnt(8)
    v_mfma_f32_16x16x32_bf16 v[68:71], v[44:47], v[136:139], v[68:71]
    v_mfma_f32_16x16x32_bf16 v[76:79], v[44:47], v[140:143], v[76:79]
    s_cmp_lt_i32 s24, 0
    s_cselect_b32 s58, 0, s24
    s_cselect_b32 s19, 0x3f800000, 0
    s_or_b32 s19, s19, 0x3f80
    s_mul_i32 s58, s58, 2560
    s_add_u32 s58, s58, s70
    s_add_u32 s24, s24, s25
    ds_read_b64_tr_b16 v[40:41], v17 offset:41040
    ds_read_b64_tr_b16 v[42:43], v17 offset:43600
    s_waitcnt lgkmcnt(8)
    v_mfma_f32_16x16x32_bf16 v[52:55], v[24:27], v[144:147], v[52:55]
    v_mfma_f32_16x16x32_bf16 v[60:63], v[24:27], v[148:151], v[60:63]
    s_cmp_lt_i32 s24, 0
    s_cselect_b32 s59, 0, s24
    s_cselect_b32 s30, 0x3f800000, 0
    s_or_b32 s30, s30, 0x3f80
    s_mul_i32 s59, s59, 2560
    s_add_u32 s59, s59, s70
    s_add_u32 s24, s24, s25
    s_cmp_lt_i32 s24, 0
    s_cselect_b32 s60, 0, s24
    s_cselect_b32 s31, 0x3f800000, 0
    s_or_b32 s31, s31, 0x3f80
    s_mul_i32 s60, s60, 2560
    s_add_u32 s60, s60, s70
    ds_read_b64_tr_b16 v[44:45], v17 offset:41080
    ds_read_b64_tr_b16 v[46:47], v17 offset:43640
    s_waitcnt lgkmcnt(8)
    v_mfma_f32_16x16x32_bf16 v[68:71], v[28:31], v[144:147], v[68:71]
    v_mfma_f32_16x16x32_bf16 v[76:79], v[28:31], v[148:151], v[76:79]
    s_cmp_eq_u32 s4, 0
    s_cselect_b32 s24, s31, s18
    s_cselect_b32 s25, s30, s17
    s_cselect_b32 s8, s20, s26
    s_cselect_b32 s9, s21, s27
    s_mov_b32 s10, 819200
    s_mov_b32 s12, s28
    s_mov_b32 s13, s29
    s_mov_b32 s14, 5242880
    s_waitcnt vmcnt(5)
    s_barrier
    ds_read_b64_tr_b16 v[24:25], v17 offset:46160
    ds_read_b64_tr_b16 v[26:27], v17 offset:48720
    s_waitcnt lgkmcnt(8)
    v_mfma_f32_16x16x32_bf16 v[52:55], v[32:35], v[152:155], v[52:55]
    v_mfma_f32_16x16x32_bf16 v[60:63], v[32:35], v[156:159], v[60:63]
    s_max_u32 s61, s53, 1
    s_sub_u32 s61, s61, 1
    s_mul_i32 s61, s61, 2560
    s_add_u32 s61, s61, s70
    ds_read_b64_tr_b16 v[28:29], v17 offset:46200
    ds_read_b64_tr_b16 v[30:31], v17 offset:48760
    s_waitcnt lgkmcnt(8)
    v_mfma_f32_16x16x32_bf16 v[68:71], v[36:39], v[152:155], v[68:71]
    v_mfma_f32_16x16x32_bf16 v[76:79], v[36:39], v[156:159], v[76:79]
    s_lshl_b32 s50, s44, 2
    s_add_u32 s50, s50, s5
    s_and_b32 s50, s50, 7
    s_mul_i32 s26, s50, 0x11111111
    s_add_u32 s26, s26, 0x76543210
    s_and_b32 s26, s26, 0x77777777
    ds_read_b64_tr_b16 v[32:33], v17 offset:51280
    ds_read_b64_tr_b16 v[34:35], v17 offset:53840
    s_waitcnt lgkmcnt(8)
    v_mfma_f32_16x16x32_bf16 v[52:55], v[40:43], v[160:163], v[52:55]
    v_mfma_f32_16x16x32_bf16 v[60:63], v[40:43], v[164:167], v[60:63]
    s_bitcmp1_b32 s5, 3
    s_cselect_b32 s27, 0, 16
    s_lshl_b32 s27, 0x8888, s27
    s_or_b32 s26, s26, s27
    s_and_b32 s50, s26, 15
    s_xor_b32 s47, s41, 128
    s_lshl_b32 s47, s47, 3
    s_add_u32 s47, s47, s45
    s_mul_i32 s47, s47, 1280
    s_add_u32 s47, s47, 10485760
    ds_read_b64_tr_b16 v[36:37], v17 offset:51320
    ds_read_b64_tr_b16 v[38:39], v17 offset:53880
    s_waitcnt lgkmcnt(8)
    v_mfma_f32_16x16x32_bf16 v[68:71], v[44:47], v[160:163], v[68:71]
    v_mfma_f32_16x16x32_bf16 v[76:79], v[44:47], v[164:167], v[76:79]
    s_xor_b32 s7, s54, 1024
    v_writelane_b32 v6, s7, 47
    s_and_b32 s23, s45, 1
    s_lshl_b32 s23, s23, 1
    s_add_u32 s23, s23, s44
    s_lshl_b32 s22, s41, 2
    s_add_u32 s22, s22, s23
    s_mul_i32 s22, s22, 2560
    s_mul_i32 s23, s23, 2560
    s_add_u32 s22, s22, 10485760
    s_add_u32 s23, s23, 143360
    s_waitcnt vmcnt(2)
    s_barrier
    ds_read_b64_tr_b16 v[40:41], v17 offset:56400
    ds_read_b64_tr_b16 v[42:43], v17 offset:58960
    s_waitcnt lgkmcnt(8)
    v_mfma_f32_16x16x32_bf16 v[52:55], v[24:27], v[168:171], v[52:55]
    v_mfma_f32_16x16x32_bf16 v[60:63], v[24:27], v[172:175], v[60:63]
    ds_read_b64_tr_b16 v[44:45], v17 offset:56440
    ds_read_b64_tr_b16 v[46:47], v17 offset:59000
    s_waitcnt lgkmcnt(8)
    v_mfma_f32_16x16x32_bf16 v[68:71], v[28:31], v[168:171], v[68:71]
    v_mfma_f32_16x16x32_bf16 v[76:79], v[28:31], v[172:175], v[76:79]
    s_mul_i32 s7, s45, 1280
    s_mul_i32 s40, s44, 5120
    s_add_u32 s7, s7, 143360
    s_add_u32 s70, s7, s40
    s_sub_u32 s7, s7, s40
    v_add_u32 v92, s7, v2
    v_add_u32 v94, s70, v2
    v_add_u32 v95, s7, v3
    v_add_u32 v16, s70, v3
    ds_read_b64_tr_b16 v[24:25], v18 offset:80
    ds_read_b64_tr_b16 v[26:27], v18 offset:2640
    s_waitcnt lgkmcnt(8)
    v_mfma_f32_16x16x32_bf16 v[52:55], v[32:35], v[176:179], v[52:55]
    v_mfma_f32_16x16x32_bf16 v[60:63], v[32:35], v[180:183], v[60:63]
    v_mul_u32_u24 v13, 6554, v1
    v_lshrrev_b32 v13, 16, v13
    v_mul_u32_u24 v13, 1120, v13
    v_add_u32 v13, v13, v2
    s_mul_i32 s51, s3, 40
    s_add_u32 s51, s51, s6
    s_mul_i32 s51, s51, 160
    s_mul_i32 m0, s3, 800
    s_mul_i32 s7, s3, 3072
    s_add_u32 s7, s7, 102656
    v_add_u32 v14, s7, v2
    ds_read_b64_tr_b16 v[28:29], v18 offset:120
    ds_read_b64_tr_b16 v[30:31], v18 offset:2680
    s_waitcnt lgkmcnt(8)
    v_mfma_f32_16x16x32_bf16 v[68:71], v[36:39], v[176:179], v[68:71]
    v_mfma_f32_16x16x32_bf16 v[76:79], v[36:39], v[180:183], v[76:79]
    s_lshl_b32 s42, s4, 6
    s_add_u32 s42, s42, s53
    s_lshr_b32 s7, s45, 1
    s_add_u32 s42, s42, s7
    s_lshl_b32 s42, s42, 1
    s_add_u32 s42, s42, s44
    s_mul_i32 s42, s42, 20480
    s_add_u32 s42, s42, 13107200
    ds_read_b64_tr_b16 v[32:33], v18 offset:5200
    ds_read_b64_tr_b16 v[34:35], v18 offset:7760
    s_waitcnt lgkmcnt(8)
    v_mfma_f32_16x16x32_bf16 v[52:55], v[40:43], v[184:187], v[52:55]
    v_mfma_f32_16x16x32_bf16 v[60:63], v[40:43], v[188:191], v[60:63]
    s_lshl_b32 s43, s53, 1
    s_add_u32 s43, s43, s45
    s_lshl_b32 s43, s43, 8
    s_lshl_b32 s7, s4, 3
    s_add_u32 s43, s43, s7
    s_add_u32 s43, s43, s6
    s_mul_i32 s43, s43, 160
    ds_read_b64_tr_b16 v[36:37], v18 offset:5240
    ds_read_b64_tr_b16 v[38:39], v18 offset:7800
    s_waitcnt lgkmcnt(8)
    v_mfma_f32_16x16x32_bf16 v[68:71], v[44:47], v[184:187], v[68:71]
    v_mfma_f32_16x16x32_bf16 v[76:79], v[44:47], v[188:191], v[76:79]
    v_cmp_eq_u32 vcc, 20, v10
    v_mov_b32 v12, 0x3f803f80
    s_nop 0
    v_cndmask_b32 v134, 0, v12, vcc
    v_mov_b32 v135, v134
    ds_read_b64_tr_b16 v[40:41], v18 offset:10320
    ds_read_b64_tr_b16 v[42:43], v18 offset:12880
    s_waitcnt lgkmcnt(8)
    v_mfma_f32_16x16x32_bf16 v[52:55], v[24:27], v[192:195], v[52:55]
    v_mfma_f32_16x16x32_bf16 v[60:63], v[24:27], v[196:199], v[60:63]
    v_mov_b64 v[108:109], 0
    v_mov_b64 v[114:115], 0
    v_mov_b64 v[120:121], 0
    v_mov_b64 v[126:127], 0
    v_mov_b64 v[132:133], 0
    v_mov_b64 v[142:143], v[134:135]
    v_mov_b64 v[144:145], v[134:135]
    v_mov_b64 v[146:147], v[134:135]
    v_mov_b64 v[148:149], v[134:135]
    v_mov_b32 v140, s24
    v_mov_b32 v141, 0
    ds_read_b64_tr_b16 v[44:45], v18 offset:10360
    ds_read_b64_tr_b16 v[46:47], v18 offset:12920
    s_waitcnt lgkmcnt(8)
    v_mfma_f32_16x16x32_bf16 v[68:71], v[28:31], v[192:195], v[68:71]
    v_mfma_f32_16x16x32_bf16 v[76:79], v[28:31], v[196:199], v[76:79]
    v_mov_b64 v[156:157], v[134:135]
    v_mov_b64 v[158:159], v[134:135]
    v_mov_b64 v[160:161], v[134:135]
    v_mov_b64 v[162:163], v[134:135]
    v_mov_b32 v154, s19
    v_mov_b32 v155, 0
    ds_read_b64_tr_b16 v[24:25], v18 offset:15440
    ds_read_b64_tr_b16 v[26:27], v18 offset:18000
    s_waitcnt lgkmcnt(8)
    v_mfma_f32_16x16x32_bf16 v[52:55], v[32:35], v[200:203], v[52:55]
    v_mfma_f32_16x16x32_bf16 v[60:63], v[32:35], v[204:207], v[60:63]
    v_mov_b64 v[170:171], v[134:135]
    v_mov_b64 v[172:173], v[134:135]
    v_mov_b64 v[174:175], v[134:135]
    v_mov_b64 v[176:177], v[134:135]
    v_mov_b32 v168, s30
    v_mov_b32 v169, 0
    ds_read_b64_tr_b16 v[28:29], v18 offset:15480
    ds_read_b64_tr_b16 v[30:31], v18 offset:18040
    s_waitcnt lgkmcnt(8)
    v_mfma_f32_16x16x32_bf16 v[68:71], v[36:39], v[200:203], v[68:71]
    v_mfma_f32_16x16x32_bf16 v[76:79], v[36:39], v[204:207], v[76:79]
    v_mov_b64 v[184:185], v[134:135]
    v_mov_b64 v[186:187], v[134:135]
    v_mov_b64 v[188:189], v[134:135]
    v_mov_b64 v[190:191], v[134:135]
    v_mov_b32 v182, s31
    v_mov_b32 v183, 0
    v_mov_b64 v[198:199], v[134:135]
    v_mov_b64 v[200:201], v[134:135]
    v_mov_b64 v[202:203], v[134:135]
    v_mov_b64 v[204:205], v[134:135]
    v_mov_b32 v196, s17
    v_mov_b32 v197, 0
    s_waitcnt vmcnt(0)
    s_barrier
    ds_read_b64_tr_b16 v[32:33], v18 offset:20560
    ds_read_b64_tr_b16 v[34:35], v18 offset:23120
    s_waitcnt lgkmcnt(8)
    v_mfma_f32_16x16x32_bf16 v[52:55], v[40:43], v[208:211], v[52:55]
    v_mfma_f32_16x16x32_bf16 v[60:63], v[40:43], v[212:215], v[60:63]
    ds_read_b64_tr_b16 v[36:37], v18 offset:20600
    ds_read_b64_tr_b16 v[38:39], v18 offset:23160
    s_waitcnt lgkmcnt(8)
    v_mfma_f32_16x16x32_bf16 v[68:71], v[44:47], v[208:211], v[68:71]
    v_mfma_f32_16x16x32_bf16 v[76:79], v[44:47], v[212:215], v[76:79]
    ds_read_b64_tr_b16 v[40:41], v18 offset:25680
    ds_read_b64_tr_b16 v[42:43], v18 offset:28240
    s_waitcnt lgkmcnt(8)
    v_mfma_f32_16x16x32_bf16 v[52:55], v[24:27], v[216:219], v[52:55]
    v_mfma_f32_16x16x32_bf16 v[60:63], v[24:27], v[220:223], v[60:63]
    ds_read_b64_tr_b16 v[44:45], v18 offset:25720
    ds_read_b64_tr_b16 v[46:47], v18 offset:28280
    s_waitcnt lgkmcnt(8)
    v_mfma_f32_16x16x32_bf16 v[68:71], v[28:31], v[216:219], v[68:71]
    v_mfma_f32_16x16x32_bf16 v[76:79], v[28:31], v[220:223], v[76:79]
    v_mov_b64 v[212:213], v[134:135]
    v_mov_b64 v[214:215], v[134:135]
    v_mov_b64 v[216:217], v[134:135]
    v_mov_b64 v[218:219], v[134:135]
    v_mov_b32 v210, s18
    v_mov_b32 v211, 0
    s_lshl_b32 s68, 0x10001, s50
    s_lshl_b32 s7, 0x10001, s5
    s_or_b32 s68, s68, s7
    s_cmp_eq_u32 s4, 0
    s_cselect_b32 s68, s68, 0
    s_cselect_b32 s69, 0, 0x3f
    s_mov_b64 exec, s[68:69]
    buffer_load_dwordx2 v[8:9], v0, s[32:35], 0 offen sc1
    s_mov_b64 exec, -1
    ds_read_b64_tr_b16 v[24:25], v18 offset:30800
    ds_read_b64_tr_b16 v[26:27], v18 offset:33360
    s_waitcnt lgkmcnt(8)
    v_mfma_f32_16x16x32_bf16 v[52:55], v[32:35], v[224:227], v[52:55]
    v_mfma_f32_16x16x32_bf16 v[60:63], v[32:35], v[228:231], v[60:63]
    ds_read_b64_tr_b16 v[28:29], v18 offset:30840
    ds_read_b64_tr_b16 v[30:31], v18 offset:33400
    s_waitcnt lgkmcnt(8)
    v_mfma_f32_16x16x32_bf16 v[68:71], v[36:39], v[224:227], v[68:71]
    v_mfma_f32_16x16x32_bf16 v[76:79], v[36:39], v[228:231], v[76:79]
    ds_read_b64_tr_b16 v[32:33], v18 offset:35920
    ds_read_b64_tr_b16 v[34:35], v18 offset:38480
    s_waitcnt lgkmcnt(8)
    v_mfma_f32_16x16x32_bf16 v[52:55], v[40:43], v[232:235], v[52:55]
    v_mfma_f32_16x16x32_bf16 v[60:63], v[40:43], v[236:239], v[60:63]
    ds_read_b64_tr_b16 v[36:37], v18 offset:35960
    ds_read_b64_tr_b16 v[38:39], v18 offset:38520
    s_waitcnt lgkmcnt(8)
    v_mfma_f32_16x16x32_bf16 v[68:71], v[44:47], v[232:235], v[68:71]
    v_mfma_f32_16x16x32_bf16 v[76:79], v[44:47], v[236:239], v[76:79]
    v_mov_b64 v[226:227], v[134:135]
    v_mov_b64 v[228:229], v[134:135]
    v_mov_b64 v[230:231], v[134:135]
    v_mov_b64 v[232:233], v[134:135]
    v_mov_b32 v224, s19
    v_mov_b32 v225, 0
    s_waitcnt lgkmcnt(6)
    v_mfma_f32_16x16x32_bf16 v[52:55], v[24:27], v[240:243], v[52:55]
    v_mfma_f32_16x16x32_bf16 v[60:63], v[24:27], v[244:247], v[60:63]
    s_waitcnt lgkmcnt(4)
    v_mfma_f32_16x16x32_bf16 v[68:71], v[28:31], v[240:243], v[68:71]
    v_mfma_f32_16x16x32_bf16 v[76:79], v[28:31], v[244:247], v[76:79]
    v_mov_b64 v[240:241], v[134:135]
    v_mov_b64 v[242:243], v[134:135]
    v_mov_b64 v[244:245], v[134:135]
    v_mov_b64 v[246:247], v[134:135]
    v_mov_b32 v238, s25
    v_mov_b32 v239, 0
    s_waitcnt lgkmcnt(2)
    v_mfma_f32_16x16x32_bf16 v[52:55], v[32:35], v[248:251], v[52:55]
    v_mfma_f32_16x16x32_bf16 v[60:63], v[32:35], v[252:255], v[60:63]
    s_waitcnt lgkmcnt(0)
    v_mfma_f32_16x16x32_bf16 v[68:71], v[36:39], v[248:251], v[68:71]
    v_mfma_f32_16x16x32_bf16 v[76:79], v[36:39], v[252:255], v[76:79]
L_att:
    s_waitcnt vmcnt(0)
    s_mov_b64 exec, s[68:69]
    v_subrev_co_u32 v8, vcc, s38, v8
    s_nop 1
    v_subb_co_u32 v9, vcc, v9, v7, vcc
    v_cmp_eq_u32 vcc, 0, v9
    s_or_b64 s[66:67], s[66:67], vcc
    s_mov_b64 exec, -1
    s_andn2_b64 s[70:71], s[68:69], s[66:67]
    s_cbranch_scc1 L_pw0
L_pb0:
    s_cmp_lg_u32 s4, 0
    s_cbranch_scc1 L_path1
    s_mul_i32 s7, s5, 10240
    s_add_u32 s7, s7, s46
    buffer_load_dwordx4 v[128:131], v2, s[32:35], s7 offen sc1
    s_mov_b64 exec, s[62:63]
    buffer_load_dwordx2 v[132:133], v3, s[32:35], s7 offen offset:2304 sc1
    s_mov_b64 exec, -1
    s_mul_i32 s48, s50, 10240
    s_add_u32 s48, s48, s46
    buffer_load_dwordx4 v[136:139], v2, s[32:35], s48 offen sc1
    s_mov_b64 exec, s[62:63]
    buffer_load_dwordx2 v[140:141], v3, s[32:35], s48 offen offset:2304 sc1
    s_mov_b64 exec, -1
    s_mov_b32 s7, 0x3ea52b5c
    s_cmp_ge_u32 s3, 4
    v_mul_f32 v52, s7, v52
    v_mul_f32 v53, s7, v53
    v_mul_f32 v54, s7, v54
    v_mul_f32 v55, s7, v55
    v_cvt_pk_bf16_f32 v48, v52, v53
    v_cvt_pk_bf16_f32 v49, v54, v55
    v_mul_f32 v60, s7, v60
    v_mul_f32 v61, s7, v61
    v_mul_f32 v62, s7, v62
    v_mul_f32 v63, s7, v63
    v_cvt_pk_bf16_f32 v50, v60, v61
    v_cvt_pk_bf16_f32 v51, v62, v63
    s_nop 0
    v_permlane16_swap_b32 v48, v50
    v_permlane16_swap_b32 v49, v51
    v_mul_f32 v68, s7, v68
    v_mul_f32 v69, s7, v69
    v_mul_f32 v70, s7, v70
    v_mul_f32 v71, s7, v71
    v_cvt_pk_bf16_f32 v56, v68, v69
    v_cvt_pk_bf16_f32 v57, v70, v71
    v_mul_f32 v76, s7, v76
    v_mul_f32 v77, s7, v77
    v_mul_f32 v78, s7, v78
    v_mul_f32 v79, s7, v79
    v_cvt_pk_bf16_f32 v58, v76, v77
    v_cvt_pk_bf16_f32 v59, v78, v79
    s_nop 0
    v_permlane16_swap_b32 v56, v58
    v_permlane16_swap_b32 v57, v59
    s_cbranch_scc1 L_pk0
    v_mul_f32 v84, s7, v84
    v_mul_f32 v85, s7, v85
    v_mul_f32 v86, s7, v86
    v_mul_f32 v87, s7, v87
    v_cvt_pk_bf16_f32 v64, v84, v85
    v_cvt_pk_bf16_f32 v65, v86, v87
    v_mul_f32 v88, s7, v88
    v_mul_f32 v89, s7, v89
    v_mul_f32 v90, s7, v90
    v_mul_f32 v91, s7, v91
    v_cvt_pk_bf16_f32 v66, v88, v89
    v_cvt_pk_bf16_f32 v67, v90, v91
L_pk0:
    s_lshr_b32 s7, s45, 1
    s_cmp_eq_u32 s7, 0
    s_cbranch_scc1 L_qown0
    buffer_store_dwordx4 v[48:51], v19, s[32:35], s22 offen offset:0 sc1
    buffer_store_dwordx4 v[56:59], v19, s[32:35], s22 offen offset:1280 sc1
    s_cmp_ge_u32 s3, 4
    s_cbranch_scc1 L_qd0
    buffer_store_dwordx2 v[64:65], v93, s[32:35], s22 offen offset:1024 sc1
    buffer_store_dwordx2 v[66:67], v93, s[32:35], s22 offen offset:1088 sc1
    s_branch L_qd0
L_qown0:
    v_add_u32 v19, s23, v19
    v_add_u32 v93, s23, v93
    ds_write_b128 v19, v[48:51] offset:0
    ds_write_b128 v19, v[56:59] offset:1280
    s_cmp_ge_u32 s3, 4
    s_cbranch_scc1 L_qd0
    ds_write_b64 v93, v[64:65] offset:1024
    ds_write_b64 v93, v[66:67] offset:1088
L_qd0:
    s_waitcnt lgkmcnt(0)
    s_barrier
    ds_read_b128 v[104:107], v92 offset:5120
    ds_read_b128 v[110:113], v94 offset:0
    s_mov_b64 exec, s[62:63]
    ds_read_b64 v[108:109], v95 offset:6144
    ds_read_b64 v[114:115], v16 offset:1024
    s_mov_b64 exec, -1
    s_mov_b32 s29, 0xffff
    s_mov_b32 s28, -1
    s_andn2_b64 s[28:29], s[28:29], s[66:67]
    s_cbranch_scc0 L_nop0
    s_mov_b64 exec, s[28:29]
    buffer_load_dwordx2 v[8:9], v6, s[32:35], 0 offen sc1
    s_mov_b64 exec, -1
L_nop0:
    s_add_u32 s49, s48, 2560
    buffer_load_dwordx4 v[150:153], v2, s[32:35], s49 offen sc1
    s_mov_b64 exec, s[62:63]
    buffer_load_dwordx2 v[154:155], v3, s[32:35], s49 offen offset:2304 sc1
    s_mov_b64 exec, s[64:65]
    buffer_load_dwordx4 v[142:145], v4, s[32:35], s48 offen offset:1024 sc1
    buffer_load_dwordx4 v[146:149], v5, s[32:35], s48 offen offset:1024 sc1
    s_mov_b64 exec, -1
    s_waitcnt vmcnt(6) lgkmcnt(0)
    v_mfma_f32_32x32x8bf16_1k v[16:31], v[132:133], v[108:109], 0
    v_mfma_f32_32x32x8bf16_1k v[32:47], v[132:133], v[114:115], 0
    v_mfma_f32_32x32x16_bf16 v[16:31], v[128:131], v[104:107], v[16:31]
    v_mfma_f32_32x32x16_bf16 v[32:47], v[128:131], v[110:113], v[32:47]
    s_nop 10
    v_max3_f32 v12, v16, v17, v18
    v_max3_f32 v10, v19, v20, v21
    v_max3_f32 v11, v32, v33, v34
    v_max3_f32 v55, v35, v36, v37
    v_max3_f32 v12, v12, v22, v23
    v_max3_f32 v10, v10, v24, v25
    v_max3_f32 v11, v11, v38, v39
    v_max3_f32 v55, v55, v40, v41
    v_max3_f32 v12, v12, v26, v27
    v_max3_f32 v10, v10, v28, v29
    v_max3_f32 v11, v11, v42, v43
    v_max3_f32 v55, v55, v44, v45
    v_max3_f32 v12, v12, v30, v31
    v_max3_f32 v11, v11, v46, v47
    v_max_f32 v12, v12, v10
    v_max_f32 v11, v11, v55
    v_mov_b32 v10, v12
    v_mov_b32 v55, v11
    s_nop 0
    v_permlane32_swap_b32 v10, v12
    v_permlane32_swap_b32 v55, v11
    v_max_f32 v12, v12, v10
    v_max_f32 v11, v11, v55
    v_sub_f32 v12, 0xc2b00000, v12
    v_sub_f32 v11, 0xc2b00000, v11
    v_cvt_pk_bf16_f32 v12, v12, 0
    v_cvt_pk_bf16_f32 v11, v11, 0
    v_cndmask_b32_e64 v108, v12, v108, s[62:63]
    v_cndmask_b32_e64 v114, v11, v114, s[62:63]
    s_waitcnt vmcnt(4)
    v_mfma_f32_32x32x8bf16_1k v[16:31], v[140:141], v[108:109], 0
    v_mfma_f32_32x32x16_bf16 v[16:31], v[136:139], v[104:107], v[16:31]
    s_add_u32 s48, s49, 2560
    buffer_load_dwordx4 v[164:167], v2, s[32:35], s48 offen sc1
    s_mov_b64 exec, s[62:63]
    buffer_load_dwordx2 v[168:169], v3, s[32:35], s48 offen offset:2304 sc1
    s_mov_b64 exec, s[64:65]
    buffer_load_dwordx4 v[156:159], v4, s[32:35], s49 offen offset:1024 sc1
    buffer_load_dwordx4 v[160:163], v5, s[32:35], s49 offen offset:1024 sc1
    s_mov_b64 exec, -1
    s_setprio 3
    v_mfma_f32_32x32x8bf16_1k v[32:47], v[140:141], v[114:115], 0
    s_nop 1
    v_exp_f32 v16, v16
    v_exp_f32 v17, v17
    v_exp_f32 v18, v18
    v_exp_f32 v19, v19
    v_exp_f32 v20, v20
    v_exp_f32 v21, v21
    v_exp_f32 v22, v22
    v_exp_f32 v23, v23
    v_cvt_pk_bf16_f32 v48, v16, v17
    v_cvt_pk_bf16_f32 v49, v18, v19
    v_cvt_pk_bf16_f32 v50, v20, v21
    v_cvt_pk_bf16_f32 v51, v22, v23
    v_mfma_f32_32x32x16_bf16 v[32:47], v[136:139], v[110:113], v[32:47]
    s_add_u32 s49, s48, 2560
    buffer_load_dwordx4 v[178:181], v2, s[32:35], s49 offen sc1
    s_mov_b64 exec, s[62:63]
    buffer_load_dwordx2 v[182:183], v3, s[32:35], s49 offen offset:2304 sc1
    s_mov_b64 exec, s[64:65]
    buffer_load_dwordx4 v[170:173], v4, s[32:35], s48 offen offset:1024 sc1
    buffer_load_dwordx4 v[174:177], v5, s[32:35], s48 offen offset:1024 sc1
    s_mov_b64 exec, -1
    v_exp_f32 v24, v24
    v_exp_f32 v25, v25
    v_exp_f32 v26, v26
    v_exp_f32 v27, v27
    v_exp_f32 v28, v28
    s_waitcnt vmcnt(8)
    v_mfma_f32_32x32x16_bf16 v[72:87], v[142:145], v[48:51], 0
    s_xor_b32 s24, s3, 4
    s_mul_i32 s24, s24, 3072
    s_add_u32 s24, s24, 102656
    v_add_u32 v134, s24, v2
    s_cmp_eq_u32 s44, 0
    s_cselect_b32 s24, 0xf149f2ca, 0
    s_cselect_b32 s40, 0, 0xf149f2ca
    v_mov_b32 v10, s24
    v_mov_b32 v11, s40
    s_mov_b32 s18, 0xffffffff
    s_mov_b32 s19, 0xfffffff0
    v_cndmask_b32_e64 v88, v11, v10, s[18:19]
    s_mov_b32 s30, 0xfffffffe
    s_mov_b32 s31, 0xffffffe0
    v_cndmask_b32_e64 v89, v11, v10, s[30:31]
    v_exp_f32 v29, v29
    v_exp_f32 v30, v30
    v_exp_f32 v31, v31
    v_cvt_pk_bf16_f32 v52, v24, v25
    v_cvt_pk_bf16_f32 v53, v26, v27
    v_cvt_pk_bf16_f32 v54, v28, v29
    v_cvt_pk_bf16_f32 v55, v30, v31
    s_setprio 2
    s_mov_b64 exec, s[28:29]
    v_subrev_co_u32 v8, vcc, s38, v8
    s_nop 1
    v_subb_co_u32 v9, vcc, v9, v7, vcc
    v_cmp_eq_u32 vcc, 0, v9
    s_or_b64 s[66:67], s[66:67], vcc
    s_mov_b64 exec, -1
    s_lshr_b32 s26, s26, 4
    s_and_b32 s50, s26, 15
    s_lshl_b32 s68, 0x10001, s50
    s_mov_b32 s69, 0
    s_andn2_b64 s[70:71], s[68:69], s[66:67]
    s_cbranch_scc1 L_pw1
L_pb1:
    v_mfma_f32_32x32x8bf16_1k v[16:31], v[154:155], v[108:109], 0
    v_exp_f32 v32, v32
    v_exp_f32 v33, v33
    v_exp_f32 v34, v34
    v_exp_f32 v35, v35
    v_exp_f32 v36, v36
    v_mfma_f32_32x32x16_bf16 v[72:87], v[146:149], v[52:55], v[72:87]
    v_exp_f32 v37, v37
    v_exp_f32 v38, v38
    v_exp_f32 v39, v39
    v_cvt_pk_bf16_f32 v48, v32, v33
    v_cvt_pk_bf16_f32 v49, v34, v35
    v_cvt_pk_bf16_f32 v50, v36, v37
    v_cvt_pk_bf16_f32 v51, v38, v39
    v_mfma_f32_32x32x16_bf16 v[16:31], v[150:153], v[104:107], v[16:31]
    s_mul_i32 s48, s50, 10240
    s_add_u32 s48, s48, s46
    buffer_load_dwordx4 v[136:139], v2, s[32:35], s48 offen sc1
    s_mov_b64 exec, s[62:63]
    buffer_load_dwordx2 v[140:141], v3, s[32:35], s48 offen offset:2304 sc1
    s_mov_b64 exec, s[64:65]
    buffer_load_dwordx4 v[184:187], v4, s[32:35], s49 offen offset:1024 sc1
    buffer_load_dwordx4 v[188:191], v5, s[32:35], s49 offen offset:1024 sc1
    s_mov_b64 exec, -1
    s_mov_b32 s29, 0xffff
    s_mov_b32 s28, -1
    s_andn2_b64 s[28:29], s[28:29], s[66:67]
    s_cbranch_scc0 L_nop1
    s_mov_b64 exec, s[28:29]
    buffer_load_dwordx2 v[8:9], v6, s[32:35], 0 offen sc1
    s_mov_b64 exec, -1
L_nop1:
    v_exp_f32 v40, v40
    v_exp_f32 v41, v41
    v_exp_f32 v42, v42
    v_exp_f32 v43, v43
    v_exp_f32 v44, v44
    v_mfma_f32_32x32x16_bf16 v[56:71], v[142:145], v[48:51], 0
    s_mov_b32 s18, 0xfffffffc
    s_mov_b32 s19, 0xffffffc0
    v_cndmask_b32_e64 v90, v11, v10, s[18:19]
    s_mov_b32 s30, 0xfffffff8
    s_mov_b32 s31, 0xffffff80
    v_cndmask_b32_e64 v91, v11, v10, s[30:31]
    s_mov_b32 s18, 0xffffff00
    s_mov_b32 s19, 0xfffff000
    v_cndmask_b32_e64 v92, v11, v10, s[18:19]
    s_mov_b32 s30, 0xfffffe00
    s_mov_b32 s31, 0xffffe000
    v_cndmask_b32_e64 v93, v11, v10, s[30:31]
    s_mov_b32 s18, 0xfffffc00
    s_mov_b32 s19, 0xffffc000
    v_cndmask_b32_e64 v94, v11, v10, s[18:19]
    v_exp_f32 v45, v45
    v_exp_f32 v46, v46
    v_exp_f32 v47, v47
    v_cvt_pk_bf16_f32 v52, v40, v41
    v_cvt_pk_bf16_f32 v53, v42, v43
    v_cvt_pk_bf16_f32 v54, v44, v45
    v_cvt_pk_bf16_f32 v55, v46, v47
    s_setprio 1
    v_mfma_f32_32x32x8bf16_1k v[32:47], v[154:155], v[114:115], 0
    v_exp_f32 v16, v16
    v_exp_f32 v17, v17
    v_exp_f32 v18, v18
    v_exp_f32 v19, v19
    v_exp_f32 v20, v20
    v_mfma_f32_32x32x16_bf16 v[56:71], v[146:149], v[52:55], v[56:71]
    v_exp_f32 v21, v21
    v_exp_f32 v22, v22
    v_exp_f32 v23, v23
    v_cvt_pk_bf16_f32 v48, v16, v17
    v_cvt_pk_bf16_f32 v49, v18, v19
    v_cvt_pk_bf16_f32 v50, v20, v21
    v_cvt_pk_bf16_f32 v51, v22, v23
    v_mfma_f32_32x32x16_bf16 v[32:47], v[150:153], v[110:113], v[32:47]
    s_add_u32 s49, s48, 2560
    buffer_load_dwordx4 v[150:153], v2, s[32:35], s49 offen sc1
    s_mov_b64 exec, s[62:63]
    buffer_load_dwordx2 v[154:155], v3, s[32:35], s49 offen offset:2304 sc1
    s_mov_b64 exec, s[64:65]
    buffer_load_dwordx4 v[142:145], v4, s[32:35], s48 offen offset:1024 sc1
    buffer_load_dwordx4 v[146:149], v5, s[32:35], s48 offen offset:1024 sc1
    s_mov_b64 exec, -1
    v_exp_f32 v24, v24
    v_exp_f32 v25, v25
    v_exp_f32 v26, v26
    v_exp_f32 v27, v27
    v_exp_f32 v28, v28
    s_waitcnt vmcnt(12)
    v_mfma_f32_32x32x16_bf16 v[72:87], v[156:159], v[48:51], v[72:87]
    s_mov_b32 s30, 0xfffff800
    s_mov_b32 s31, 0xffff8000
    v_cndmask_b32_e64 v95, v11, v10, s[30:31]
    s_mov_b32 s18, 0xffff0000
    s_mov_b32 s19, 0xfff00000
    v_cndmask_b32_e64 v96, v11, v10, s[18:19]
    s_mov_b32 s30, 0xfffe0000
    s_mov_b32 s31, 0xffe00000
    v_cndmask_b32_e64 v97, v11, v10, s[30:31]
    s_mov_b32 s18, 0xfffc0000
    s_mov_b32 s19, 0xffc00000
    v_cndmask_b32_e64 v98, v11, v10, s[18:19]
    s_mov_b32 s30, 0xfff80000
    s_mov_b32 s31, 0xff800000
    v_cndmask_b32_e64 v99, v11, v10, s[30:31]
    v_exp_f32 v29, v29
    v_exp_f32 v30, v30
    v_exp_f32 v31, v31
    v_cvt_pk_bf16_f32 v52, v24, v25
    v_cvt_pk_bf16_f32 v53, v26, v27
    v_cvt_pk_bf16_f32 v54, v28, v29
    v_cvt_pk_bf16_f32 v55, v30, v31
    s_setprio 0
    v_mfma_f32_32x32x8bf16_1k v[16:31], v[168:169], v[108:109], 0
    v_exp_f32 v32, v32
    v_exp_f32 v33, v33
    v_exp_f32 v34, v34
    v_exp_f32 v35, v35
    v_exp_f32 v36, v36
    v_mfma_f32_32x32x16_bf16 v[72:87], v[160:163], v[52:55], v[72:87]
    v_exp_f32 v37, v37
    v_exp_f32 v38, v38
    v_exp_f32 v39, v39
    v_cvt_pk_bf16_f32 v48, v32, v33
    v_cvt_pk_bf16_f32 v49, v34, v35
    v_cvt_pk_bf16_f32 v50, v36, v37
    v_cvt_pk_bf16_f32 v51, v38, v39
    v_mfma_f32_32x32x16_bf16 v[16:31], v[164:167], v[104:107], v[16:31]
    buffer_load_dwordx4 v13, s[8:11], s51 offen lds
    s_add_u32 m0, m0, 6400
    s_add_u32 s51, s51, 51200
    v_exp_f32 v40, v40
    v_exp_f32 v41, v41
    v_exp_f32 v42, v42
    v_exp_f32 v43, v43
    v_exp_f32 v44, v44
    v_mfma_f32_32x32x16_bf16 v[56:71], v[156:159], v[48:51], v[56:71]
    s_mov_b32 s18, 0xff000000
    s_mov_b32 s19, 0xf0000000
    v_cndmask_b32_e64 v100, v11, v10, s[18:19]
    s_mov_b32 s30, 0xfe000000
    s_mov_b32 s31, 0xe0000000
    v_cndmask_b32_e64 v101, v11, v10, s[30:31]
    s_mov_b32 s18, 0xfc000000
    s_mov_b32 s19, 0xc0000000
    v_cndmask_b32_e64 v102, v11, v10, s[18:19]
    s_mov_b32 s30, 0xf8000000
    s_mov_b32 s31, 0x80000000
    v_cndmask_b32_e64 v103, v11, v10, s[30:31]
    v_lshrrev_b32 v254, 4, v1
    v_and_b32 v255, 15, v1
    v_exp_f32 v45, v45
    v_exp_f32 v46, v46
    v_exp_f32 v47, v47
    v_cvt_pk_bf16_f32 v52, v40, v41
    v_cvt_pk_bf16_f32 v53, v42, v43
    v_cvt_pk_bf16_f32 v54, v44, v45
    v_cvt_pk_bf16_f32 v55, v46, v47
    s_setprio 3
    v_mfma_f32_32x32x8bf16_1k v[32:47], v[168:169], v[114:115], 0
    v_exp_f32 v16, v16
    v_exp_f32 v17, v17
    v_exp_f32 v18, v18
    v_exp_f32 v19, v19
    v_exp_f32 v20, v20
    v_mfma_f32_32x32x16_bf16 v[56:71], v[160:163], v[52:55], v[56:71]
    v_exp_f32 v21, v21
    v_exp_f32 v22, v22
    v_exp_f32 v23, v23
    v_cvt_pk_bf16_f32 v48, v16, v17
    v_cvt_pk_bf16_f32 v49, v18, v19
    v_cvt_pk_bf16_f32 v50, v20, v21
    v_cvt_pk_bf16_f32 v51, v22, v23
    v_mfma_f32_32x32x16_bf16 v[32:47], v[164:167], v[110:113], v[32:47]
    s_add_u32 s48, s49, 2560
    buffer_load_dwordx4 v[164:167], v2, s[32:35], s48 offen sc1
    s_mov_b64 exec, s[62:63]
    buffer_load_dwordx2 v[168:169], v3, s[32:35], s48 offen offset:2304 sc1
    s_mov_b64 exec, s[64:65]
    buffer_load_dwordx4 v[156:159], v4, s[32:35], s49 offen offset:1024 sc1
    buffer_load_dwordx4 v[160:163], v5, s[32:35], s49 offen offset:1024 sc1
    s_mov_b64 exec, -1
    v_exp_f32 v24, v24
    v_exp_f32 v25, v25
    v_exp_f32 v26, v26
    v_exp_f32 v27, v27
    v_exp_f32 v28, v28
    s_waitcnt vmcnt(13)
    v_mfma_f32_32x32x16_bf16 v[72:87], v[170:173], v[48:51], v[72:87]
    v_lshrrev_b32 v0, 5, v1
    v_and_b32 v12, 1, v254
    v_mul_u32_u24 v252, 2560, v255
    v_lshl_add_u32 v253, v254, 3, v252
    v_lshl_add_u32 v252, v12, 5, v252
    v_lshl_add_u32 v252, v0, 4, v252
    v_lshrrev_b32 v10, 2, v255
    s_and_b32 s24, s3, 1
    s_lshl_b32 s24, s24, 4
    v_add_u32 v255, s24, v255
    v_mul_u32_u24 v248, 1280, v0
    v_exp_f32 v29, v29
    v_exp_f32 v30, v30
    v_exp_f32 v31, v31
    v_cvt_pk_bf16_f32 v52, v24, v25
    v_cvt_pk_bf16_f32 v53, v26, v27
    v_cvt_pk_bf16_f32 v54, v28, v29
    v_cvt_pk_bf16_f32 v55, v30, v31
    s_setprio 2
    v_mfma_f32_32x32x8bf16_1k v[16:31], v[182:183], v[108:109], 0
    v_exp_f32 v32, v32
    v_exp_f32 v33, v33
    v_exp_f32 v34, v34
    v_exp_f32 v35, v35
    v_exp_f32 v36, v36
    v_mfma_f32_32x32x16_bf16 v[72:87], v[174:177], v[52:55], v[72:87]
    v_exp_f32 v37, v37
    v_exp_f32 v38, v38
    v_exp_f32 v39, v39
    v_cvt_pk_bf16_f32 v48, v32, v33
    v_cvt_pk_bf16_f32 v49, v34, v35
    v_cvt_pk_bf16_f32 v50, v36, v37
    v_cvt_pk_bf16_f32 v51, v38, v39
    v_mfma_f32_32x32x16_bf16 v[16:31], v[178:181], v[104:107], v[16:31]
    buffer_load_dwordx4 v13, s[8:11], s51 offen lds
    s_add_u32 m0, m0, 6400
    s_add_u32 s51, s51, 51200
    v_exp_f32 v40, v40
    v_exp_f32 v41, v41
    v_exp_f32 v42, v42
    v_exp_f32 v43, v43
    v_exp_f32 v44, v44
    v_mfma_f32_32x32x16_bf16 v[56:71], v[170:173], v[48:51], v[56:71]
    v_mov_b64 v[128:129], -1
    v_mov_b64 v[130:131], -1
    s_add_u32 s7, s16, 2621440
    buffer_store_dwordx4 v[128:131], v2, s[32:35], s16 offen sc1
    buffer_store_dwordx4 v[128:131], v2, s[32:35], s7 offen sc1
    s_mov_b64 exec, 0xffff
    buffer_store_dwordx4 v[128:131], v2, s[32:35], s16 offen offset:1024 sc1
    buffer_store_dwordx4 v[128:131], v2, s[32:35], s7 offen offset:1024 sc1
    s_mov_b64 exec, -1
    v_lshl_add_u32 v248, v12, 9, v248
    v_lshl_add_u32 v248, v255, 4, v248
    v_mul_u32_u24 v249, 1280, v254
    v_lshl_add_u32 v249, v255, 3, v249
    s_mul_i32 s24, s44, 320
    v_add_u32 v10, s24, v10
    v_mul_u32_u24 v250, 20, v0
    v_lshl_add_u32 v250, v12, 2, v250
    v_add_u32 v250, v250, v10
    v_mul_u32_u24 v251, 20, v254
    v_add3_u32 v251, v251, v10, 16
    v_exp_f32 v45, v45
    v_exp_f32 v46, v46
    v_exp_f32 v47, v47
    v_cvt_pk_bf16_f32 v52, v40, v41
    v_cvt_pk_bf16_f32 v53, v42, v43
    v_cvt_pk_bf16_f32 v54, v44, v45
    v_cvt_pk_bf16_f32 v55, v46, v47
    s_setprio 1
    v_mfma_f32_32x32x8bf16_1k v[32:47], v[182:183], v[114:115], 0
    v_exp_f32 v16, v16
    v_exp_f32 v17, v17
    v_exp_f32 v18, v18
    v_exp_f32 v19, v19
    v_exp_f32 v20, v20
    v_mfma_f32_32x32x16_bf16 v[56:71], v[174:177], v[52:55], v[56:71]
    v_exp_f32 v21, v21
    v_exp_f32 v22, v22
    v_exp_f32 v23, v23
    v_cvt_pk_bf16_f32 v48, v16, v17
    v_cvt_pk_bf16_f32 v49, v18, v19
    v_cvt_pk_bf16_f32 v50, v20, v21
    v_cvt_pk_bf16_f32 v51, v22, v23
    v_mfma_f32_32x32x16_bf16 v[32:47], v[178:181], v[110:113], v[32:47]
    s_add_u32 s49, s48, 2560
    buffer_load_dwordx4 v[178:181], v2, s[32:35], s49 offen sc1
    s_mov_b64 exec, s[62:63]
    buffer_load_dwordx2 v[182:183], v3, s[32:35], s49 offen offset:2304 sc1
    s_mov_b64 exec, s[64:65]
    buffer_load_dwordx4 v[170:173], v4, s[32:35], s48 offen offset:1024 sc1
    buffer_load_dwordx4 v[174:177], v5, s[32:35], s48 offen offset:1024 sc1
    s_mov_b64 exec, -1
    v_exp_f32 v24, v24
    v_exp_f32 v25, v25
    v_exp_f32 v26, v26
    v_exp_f32 v27, v27
    v_exp_f32 v28, v28
    s_waitcnt vmcnt(14)
    v_mfma_f32_32x32x16_bf16 v[72:87], v[184:187], v[48:51], v[72:87]
    v_and_b32 v10, 3, v1
    v_lshlrev_b32 v10, 3, v10
    v_mul_u32_u24 v250, 160, v250
    v_mul_u32_u24 v251, 160, v251
    v_add_u32 v250, v250, v10
    v_add_u32 v251, v251, v10
    v_exp_f32 v29, v29
    v_exp_f32 v30, v30
    v_exp_f32 v31, v31
    v_cvt_pk_bf16_f32 v52, v24, v25
    v_cvt_pk_bf16_f32 v53, v26, v27
    v_cvt_pk_bf16_f32 v54, v28, v29
    v_cvt_pk_bf16_f32 v55, v30, v31
    s_setprio 0
    v_mfma_f32_32x32x8bf16_1k v[16:31], v[140:141], v[108:109], 0
    v_exp_f32 v32, v32
    v_exp_f32 v33, v33
    v_exp_f32 v34, v34
    v_exp_f32 v35, v35
    v_exp_f32 v36, v36
    v_mfma_f32_32x32x16_bf16 v[72:87], v[188:191], v[52:55], v[72:87]
    v_exp_f32 v37, v37
    v_exp_f32 v38, v38
    v_exp_f32 v39, v39
    v_cvt_pk_bf16_f32 v48, v32, v33
    v_cvt_pk_bf16_f32 v49, v34, v35
    v_cvt_pk_bf16_f32 v50, v36, v37
    v_cvt_pk_bf16_f32 v51, v38, v39
    v_mfma_f32_32x32x16_bf16 v[16:31], v[136:139], v[104:107], v[16:31]
    v_exp_f32 v40, v40
    v_exp_f32 v41, v41
    v_exp_f32 v42, v42
    v_exp_f32 v43, v43
    v_exp_f32 v44, v44
    v_mfma_f32_32x32x16_bf16 v[56:71], v[184:187], v[48:51], v[56:71]
    v_exp_f32 v45, v45
    v_exp_f32 v46, v46
    v_exp_f32 v47, v47
    v_cvt_pk_bf16_f32 v52, v40, v41
    v_cvt_pk_bf16_f32 v53, v42, v43
    v_cvt_pk_bf16_f32 v54, v44, v45
    v_cvt_pk_bf16_f32 v55, v46, v47
    s_mov_b32 s54, 0
L_A0_loop:
    s_setprio 3
    s_waitcnt vmcnt(14)
    s_mov_b64 exec, s[28:29]
    v_subrev_co_u32 v8, vcc, s38, v8
    s_nop 1
    v_subb_co_u32 v9, vcc, v9, v7, vcc
    v_cmp_eq_u32 vcc, 0, v9
    s_or_b64 s[66:67], s[66:67], vcc
    s_mov_b64 exec, -1
    s_lshr_b32 s26, s26, 4
    s_and_b32 s50, s26, 15
    s_lshl_b32 s68, 0x10001, s50
    s_mov_b32 s69, 0
    s_andn2_b64 s[70:71], s[68:69], s[66:67]
    s_cbranch_scc1 L_pw2
L_pb2:
    v_mfma_f32_32x32x8bf16_1k v[32:47], v[140:141], v[114:115], 0
    v_exp_f32 v16, v16
    v_exp_f32 v17, v17
    v_exp_f32 v18, v18
    v_exp_f32 v19, v19
    v_exp_f32 v20, v20
    v_mfma_f32_32x32x16_bf16 v[56:71], v[188:191], v[52:55], v[56:71]
    v_exp_f32 v21, v21
    v_exp_f32 v22, v22
    v_exp_f32 v23, v23
    v_cvt_pk_bf16_f32 v48, v16, v17
    v_cvt_pk_bf16_f32 v49, v18, v19
    v_cvt_pk_bf16_f32 v50, v20, v21
    v_cvt_pk_bf16_f32 v51, v22, v23
    v_mfma_f32_32x32x16_bf16 v[32:47], v[136:139], v[110:113], v[32:47]
    s_mul_i32 s48, s50, 10240
    s_add_u32 s48, s48, s46
    buffer_load_dwordx4 v[136:139], v2, s[32:35], s48 offen sc1
    s_mov_b64 exec, s[62:63]
    buffer_load_dwordx2 v[140:141], v3, s[32:35], s48 offen offset:2304 sc1
    s_mov_b64 exec, s[64:65]
    buffer_load_dwordx4 v[184:187], v4, s[32:35], s49 offen offset:1024 sc1
    buffer_load_dwordx4 v[188:191], v5, s[32:35], s49 offen offset:1024 sc1
    s_mov_b64 exec, -1
    v_exp_f32 v24, v24
    v_exp_f32 v25, v25
    v_exp_f32 v26, v26
    v_exp_f32 v27, v27
    v_exp_f32 v28, v28
    s_waitcnt vmcnt(14)
    v_mfma_f32_32x32x16_bf16 v[72:87], v[142:145], v[48:51], v[72:87]
    v_exp_f32 v29, v29
    v_exp_f32 v30, v30
    v_exp_f32 v31, v31
    v_cvt_pk_bf16_f32 v52, v24, v25
    v_cvt_pk_bf16_f32 v53, v26, v27
    v_cvt_pk_bf16_f32 v54, v28, v29
    v_cvt_pk_bf16_f32 v55, v30, v31
    s_setprio 2
    v_mfma_f32_32x32x8bf16_1k v[16:31], v[154:155], v[108:109], 0
    v_exp_f32 v32, v32
    v_exp_f32 v33, v33
    v_exp_f32 v34, v34
    v_exp_f32 v35, v35
    v_exp_f32 v36, v36
    v_mfma_f32_32x32x16_bf16 v[72:87], v[146:149], v[52:55], v[72:87]
    v_exp_f32 v37, v37
    v_exp_f32 v38, v38
    v_exp_f32 v39, v39
    v_cvt_pk_bf16_f32 v48, v32, v33
    v_cvt_pk_bf16_f32 v49, v34, v35
    v_cvt_pk_bf16_f32 v50, v36, v37
    v_cvt_pk_bf16_f32 v51, v38, v39
    v_mfma_f32_32x32x16_bf16 v[16:31], v[150:153], v[104:107], v[16:31]
    s_cmp_ge_u32 s54, 4
    s_cselect_b32 s29, -1, 0xffff
    s_mov_b32 s28, -1
    s_andn2_b64 s[28:29], s[28:29], s[66:67]
    s_cbranch_scc0 L_nop2
    s_mov_b64 exec, s[28:29]
    buffer_load_dwordx2 v[8:9], v6, s[32:35], 0 offen sc1
    s_mov_b64 exec, -1
L_nop2:
    v_exp_f32 v40, v40
    v_exp_f32 v41, v41
    v_exp_f32 v42, v42
    v_exp_f32 v43, v43
    v_exp_f32 v44, v44
    v_mfma_f32_32x32x16_bf16 v[56:71], v[142:145], v[48:51], v[56:71]
    v_exp_f32 v45, v45
    v_exp_f32 v46, v46
    v_exp_f32 v47, v47
    v_cvt_pk_bf16_f32 v52, v40, v41
    v_cvt_pk_bf16_f32 v53, v42, v43
    v_cvt_pk_bf16_f32 v54, v44, v45
    v_cvt_pk_bf16_f32 v55, v46, v47
    s_setprio 1
    v_mfma_f32_32x32x8bf16_1k v[32:47], v[154:155], v[114:115], 0
    v_exp_f32 v16, v16
    v_exp_f32 v17, v17
    v_exp_f32 v18, v18
    v_exp_f32 v19, v19
    v_exp_f32 v20, v20
    v_mfma_f32_32x32x16_bf16 v[56:71], v[146:149], v[52:55], v[56:71]
    v_exp_f32 v21, v21
    v_exp_f32 v22, v22
    v_exp_f32 v23, v23
    v_cvt_pk_bf16_f32 v48, v16, v17
    v_cvt_pk_bf16_f32 v49, v18, v19
    v_cvt_pk_bf16_f32 v50, v20, v21
    v_cvt_pk_bf16_f32 v51, v22, v23
    v_mfma_f32_32x32x16_bf16 v[32:47], v[150:153], v[110:113], v[32:47]
    s_add_u32 s49, s48, 2560
    buffer_load_dwordx4 v[150:153], v2, s[32:35], s49 offen sc1
    s_mov_b64 exec, s[62:63]
    buffer_load_dwordx2 v[154:155], v3, s[32:35], s49 offen offset:2304 sc1
    s_mov_b64 exec, s[64:65]
    buffer_load_dwordx4 v[142:145], v4, s[32:35], s48 offen offset:1024 sc1
    buffer_load_dwordx4 v[146:149], v5, s[32:35], s48 offen offset:1024 sc1
    s_mov_b64 exec, -1
    v_exp_f32 v24, v24
    v_exp_f32 v25, v25
    v_exp_f32 v26, v26
    v_exp_f32 v27, v27
    v_exp_f32 v28, v28
    s_waitcnt vmcnt(13)
    v_mfma_f32_32x32x16_bf16 v[72:87], v[156:159], v[48:51], v[72:87]
    v_exp_f32 v29, v29
    v_exp_f32 v30, v30
    v_exp_f32 v31, v31
    v_cvt_pk_bf16_f32 v52, v24, v25
    v_cvt_pk_bf16_f32 v53, v26, v27
    v_cvt_pk_bf16_f32 v54, v28, v29
    v_cvt_pk_bf16_f32 v55, v30, v31
    s_setprio 0
    v_mfma_f32_32x32x8bf16_1k v[16:31], v[168:169], v[108:109], 0
    v_exp_f32 v32, v32
    v_exp_f32 v33, v33
    v_exp_f32 v34, v34
    v_exp_f32 v35, v35
    v_exp_f32 v36, v36
    v_mfma_f32_32x32x16_bf16 v[72:87], v[160:163], v[52:55], v[72:87]
    v_exp_f32 v37, v37
    v_exp_f32 v38, v38
    v_exp_f32 v39, v39
    v_cvt_pk_bf16_f32 v48, v32, v33
    v_cvt_pk_bf16_f32 v49, v34, v35
    v_cvt_pk_bf16_f32 v50, v36, v37
    v_cvt_pk_bf16_f32 v51, v38, v39
    v_mfma_f32_32x32x16_bf16 v[16:31], v[164:167], v[104:107], v[16:31]
    buffer_load_dwordx4 v13, s[8:11], s51 offen lds
    s_add_u32 m0, m0, 6400
    s_add_u32 s51, s51, 51200
    v_exp_f32 v40, v40
    v_exp_f32 v41, v41
    v_exp_f32 v42, v42
    v_exp_f32 v43, v43
    v_exp_f32 v44, v44
    v_mfma_f32_32x32x16_bf16 v[56:71], v[156:159], v[48:51], v[56:71]
    v_exp_f32 v45, v45
    v_exp_f32 v46, v46
    v_exp_f32 v47, v47
    v_cvt_pk_bf16_f32 v52, v40, v41
    v_cvt_pk_bf16_f32 v53, v42, v43
    v_cvt_pk_bf16_f32 v54, v44, v45
    v_cvt_pk_bf16_f32 v55, v46, v47
    s_setprio 3
    v_mfma_f32_32x32x8bf16_1k v[32:47], v[168:169], v[114:115], 0
    v_exp_f32 v16, v16
    v_exp_f32 v17, v17
    v_exp_f32 v18, v18
    v_exp_f32 v19, v19
    v_exp_f32 v20, v20
    v_mfma_f32_32x32x16_bf16 v[56:71], v[160:163], v[52:55], v[56:71]
    v_exp_f32 v21, v21
    v_exp_f32 v22, v22
    v_exp_f32 v23, v23
    v_cvt_pk_bf16_f32 v48, v16, v17
    v_cvt_pk_bf16_f32 v49, v18, v19
    v_cvt_pk_bf16_f32 v50, v20, v21
    v_cvt_pk_bf16_f32 v51, v22, v23
    v_mfma_f32_32x32x16_bf16 v[32:47], v[164:167], v[110:113], v[32:47]
    s_add_u32 s48, s49, 2560
    buffer_load_dwordx4 v[164:167], v2, s[32:35], s48 offen sc1
    s_mov_b64 exec, s[62:63]
    buffer_load_dwordx2 v[168:169], v3, s[32:35], s48 offen offset:2304 sc1
    s_mov_b64 exec, s[64:65]
    buffer_load_dwordx4 v[156:159], v4, s[32:35], s49 offen offset:1024 sc1
    buffer_load_dwordx4 v[160:163], v5, s[32:35], s49 offen offset:1024 sc1
    s_mov_b64 exec, -1
    v_exp_f32 v24, v24
    v_exp_f32 v25, v25
    v_exp_f32 v26, v26
    v_exp_f32 v27, v27
    v_exp_f32 v28, v28
    s_waitcnt vmcnt(13)
    v_mfma_f32_32x32x16_bf16 v[72:87], v[170:173], v[48:51], v[72:87]
    v_exp_f32 v29, v29
    v_exp_f32 v30, v30
    v_exp_f32 v31, v31
    v_cvt_pk_bf16_f32 v52, v24, v25
    v_cvt_pk_bf16_f32 v53, v26, v27
    v_cvt_pk_bf16_f32 v54, v28, v29
    v_cvt_pk_bf16_f32 v55, v30, v31
    s_setprio 2
    v_mfma_f32_32x32x8bf16_1k v[16:31], v[182:183], v[108:109], 0
    v_exp_f32 v32, v32
    v_exp_f32 v33, v33
    v_exp_f32 v34, v34
    v_exp_f32 v35, v35
    v_exp_f32 v36, v36
    v_mfma_f32_32x32x16_bf16 v[72:87], v[174:177], v[52:55], v[72:87]
    v_exp_f32 v37, v37
    v_exp_f32 v38, v38
    v_exp_f32 v39, v39
    v_cvt_pk_bf16_f32 v48, v32, v33
    v_cvt_pk_bf16_f32 v49, v34, v35
    v_cvt_pk_bf16_f32 v50, v36, v37
    v_cvt_pk_bf16_f32 v51, v38, v39
    v_mfma_f32_32x32x16_bf16 v[16:31], v[178:181], v[104:107], v[16:31]
    buffer_load_dwordx4 v13, s[8:11], s51 offen lds
    s_add_u32 m0, m0, 6400
    s_add_u32 s51, s51, 51200
    v_exp_f32 v40, v40
    v_exp_f32 v41, v41
    v_exp_f32 v42, v42
    v_exp_f32 v43, v43
    v_exp_f32 v44, v44
    v_mfma_f32_32x32x16_bf16 v[56:71], v[170:173], v[48:51], v[56:71]
    v_exp_f32 v45, v45
    v_exp_f32 v46, v46
    v_exp_f32 v47, v47
    v_cvt_pk_bf16_f32 v52, v40, v41
    v_cvt_pk_bf16_f32 v53, v42, v43
    v_cvt_pk_bf16_f32 v54, v44, v45
    v_cvt_pk_bf16_f32 v55, v46, v47
    s_setprio 1
    v_mfma_f32_32x32x8bf16_1k v[32:47], v[182:183], v[114:115], 0
    v_exp_f32 v16, v16
    v_exp_f32 v17, v17
    v_exp_f32 v18, v18
    v_exp_f32 v19, v19
    v_exp_f32 v20, v20
    v_mfma_f32_32x32x16_bf16 v[56:71], v[174:177], v[52:55], v[56:71]
    v_exp_f32 v21, v21
    v_exp_f32 v22, v22
    v_exp_f32 v23, v23
    v_cvt_pk_bf16_f32 v48, v16, v17
    v_cvt_pk_bf16_f32 v49, v18, v19
    v_cvt_pk_bf16_f32 v50, v20, v21
    v_cvt_pk_bf16_f32 v51, v22, v23
    v_mfma_f32_32x32x16_bf16 v[32:47], v[178:181], v[110:113], v[32:47]
    s_add_u32 s49, s48, 2560
    buffer_load_dwordx4 v[178:181], v2, s[32:35], s49 offen sc1
    s_mov_b64 exec, s[62:63]
    buffer_load_dwordx2 v[182:183], v3, s[32:35], s49 offen offset:2304 sc1
    s_mov_b64 exec, s[64:65]
    buffer_load_dwordx4 v[170:173], v4, s[32:35], s48 offen offset:1024 sc1
    buffer_load_dwordx4 v[174:177], v5, s[32:35], s48 offen offset:1024 sc1
    s_mov_b64 exec, -1
    v_exp_f32 v24, v24
    v_exp_f32 v25, v25
    v_exp_f32 v26, v26
    v_exp_f32 v27, v27
    v_exp_f32 v28, v28
    s_waitcnt vmcnt(14)
    v_mfma_f32_32x32x16_bf16 v[72:87], v[184:187], v[48:51], v[72:87]
    v_exp_f32 v29, v29
    v_exp_f32 v30, v30
    v_exp_f32 v31, v31
    v_cvt_pk_bf16_f32 v52, v24, v25
    v_cvt_pk_bf16_f32 v53, v26, v27
    v_cvt_pk_bf16_f32 v54, v28, v29
    v_cvt_pk_bf16_f32 v55, v30, v31
    s_setprio 0
    v_mfma_f32_32x32x8bf16_1k v[16:31], v[140:141], v[108:109], 0
    v_exp_f32 v32, v32
    v_exp_f32 v33, v33
    v_exp_f32 v34, v34
    v_exp_f32 v35, v35
    v_exp_f32 v36, v36
    v_mfma_f32_32x32x16_bf16 v[72:87], v[188:191], v[52:55], v[72:87]
    v_exp_f32 v37, v37
    v_exp_f32 v38, v38
    v_exp_f32 v39, v39
    v_cvt_pk_bf16_f32 v48, v32, v33
    v_cvt_pk_bf16_f32 v49, v34, v35
    v_cvt_pk_bf16_f32 v50, v36, v37
    v_cvt_pk_bf16_f32 v51, v38, v39
    v_mfma_f32_32x32x16_bf16 v[16:31], v[136:139], v[104:107], v[16:31]
    s_cmp_lg_u32 s54, 0
    s_cbranch_scc1 L_nog2_0
    v_mov_b32 v10, 159748
    v_mov_b32 v11, 1
    s_mov_b64 exec, 1
    ds_add_rtn_u32 v12, v10, v11
    s_mov_b64 exec, -1
    s_waitcnt lgkmcnt(0)
    v_readfirstlane_b32 s7, v12
    s_cmp_lg_u32 s7, 7
    s_cbranch_scc1 L_nof2_0
    v_mov_b32 v10, s36
    v_mov_b32 v11, s37
    s_mov_b64 exec, 1
    buffer_store_dwordx2 v[10:11], off, s[32:35], s52 sc1
    s_mov_b64 exec, -1
L_nof2_0:
L_nog2_0:
    v_exp_f32 v40, v40
    v_exp_f32 v41, v41
    v_exp_f32 v42, v42
    v_exp_f32 v43, v43
    v_exp_f32 v44, v44
    v_mfma_f32_32x32x16_bf16 v[56:71], v[184:187], v[48:51], v[56:71]
    s_add_u32 s54, s54, 1
    s_cmp_lt_u32 s54, 6
    v_exp_f32 v45, v45
    v_exp_f32 v46, v46
    v_exp_f32 v47, v47
    v_cvt_pk_bf16_f32 v52, v40, v41
    v_cvt_pk_bf16_f32 v53, v42, v43
    v_cvt_pk_bf16_f32 v54, v44, v45
    v_cvt_pk_bf16_f32 v55, v46, v47
    s_cbranch_scc1 L_A0_loop
    s_setprio 3
    s_waitcnt vmcnt(14)
    s_mov_b64 exec, s[28:29]
    v_subrev_co_u32 v8, vcc, s38, v8
    s_nop 1
    v_subb_co_u32 v9, vcc, v9, v7, vcc
    v_cmp_eq_u32 vcc, 0, v9
    s_or_b64 s[66:67], s[66:67], vcc
    s_mov_b64 exec, -1
    s_mov_b32 s68, 0
    s_mov_b32 s69, 0xffff
    s_andn2_b64 s[70:71], s[68:69], s[66:67]
    s_cbranch_scc1 L_pw3
L_pb3:
    v_mfma_f32_32x32x8bf16_1k v[32:47], v[140:141], v[114:115], 0
    v_exp_f32 v16, v16
    v_exp_f32 v17, v17
    v_exp_f32 v18, v18
    v_exp_f32 v19, v19
    v_exp_f32 v20, v20
    v_mfma_f32_32x32x16_bf16 v[56:71], v[188:191], v[52:55], v[56:71]
    v_exp_f32 v21, v21
    v_exp_f32 v22, v22
    v_exp_f32 v23, v23
    v_cvt_pk_bf16_f32 v48, v16, v17
    v_cvt_pk_bf16_f32 v49, v18, v19
    v_cvt_pk_bf16_f32 v50, v20, v21
    v_cvt_pk_bf16_f32 v51, v22, v23
    v_mfma_f32_32x32x16_bf16 v[32:47], v[136:139], v[110:113], v[32:47]
    s_mov_b64 exec, s[64:65]
    buffer_load_dwordx4 v[184:187], v4, s[32:35], s49 offen offset:1024 sc1
    buffer_load_dwordx4 v[188:191], v5, s[32:35], s49 offen offset:1024 sc1
    s_mov_b64 exec, -1
    buffer_load_dwordx4 v[128:131], v2, s[32:35], s61 offen sc1
    s_mov_b64 exec, s[62:63]
    buffer_load_dwordx2 v[132:133], v3, s[32:35], s61 offen offset:2304 sc1
    s_mov_b64 exec, -1
    v_exp_f32 v24, v24
    v_exp_f32 v25, v25
    v_exp_f32 v26, v26
    v_exp_f32 v27, v27
    v_exp_f32 v28, v28
    s_waitcnt vmcnt(14)
    v_mfma_f32_32x32x16_bf16 v[72:87], v[142:145], v[48:51], v[72:87]
    v_exp_f32 v29, v29
    v_exp_f32 v30, v30
    v_exp_f32 v31, v31
    v_cvt_pk_bf16_f32 v52, v24, v25
    v_cvt_pk_bf16_f32 v53, v26, v27
    v_cvt_pk_bf16_f32 v54, v28, v29
    v_cvt_pk_bf16_f32 v55, v30, v31
    s_setprio 2
    v_mfma_f32_32x32x8bf16_1k v[16:31], v[154:155], v[108:109], 0
    v_exp_f32 v32, v32
    v_exp_f32 v33, v33
    v_exp_f32 v34, v34
    v_exp_f32 v35, v35
    v_exp_f32 v36, v36
    v_mfma_f32_32x32x16_bf16 v[72:87], v[146:149], v[52:55], v[72:87]
    v_exp_f32 v37, v37
    v_exp_f32 v38, v38
    v_exp_f32 v39, v39
    v_cvt_pk_bf16_f32 v48, v32, v33
    v_cvt_pk_bf16_f32 v49, v34, v35
    v_cvt_pk_bf16_f32 v50, v36, v37
    v_cvt_pk_bf16_f32 v51, v38, v39
    v_mfma_f32_32x32x16_bf16 v[16:31], v[150:153], v[104:107], v[16:31]
    buffer_load_dwordx4 v13, s[8:11], s51 offen lds
    s_add_u32 m0, m0, 6400
    s_add_u32 s51, s51, 51200
    s_xor_b32 s7, s44, 1
    s_mul_i32 s7, s7, 5120
    s_add_u32 s7, s7, s47
    buffer_load_dwordx4 v[116:119], v2, s[32:35], s7 offen sc1
    s_mov_b64 exec, s[62:63]
    buffer_load_dwordx2 v[120:121], v3, s[32:35], s7 offen offset:1024 sc1
    s_mov_b64 exec, -1
    v_exp_f32 v40, v40
    v_exp_f32 v41, v41
    v_exp_f32 v42, v42
    v_exp_f32 v43, v43
    v_exp_f32 v44, v44
    v_mfma_f32_32x32x16_bf16 v[56:71], v[142:145], v[48:51], v[56:71]
    v_exp_f32 v45, v45
    v_exp_f32 v46, v46
    v_exp_f32 v47, v47
    v_cvt_pk_bf16_f32 v52, v40, v41
    v_cvt_pk_bf16_f32 v53, v42, v43
    v_cvt_pk_bf16_f32 v54, v44, v45
    v_cvt_pk_bf16_f32 v55, v46, v47
    s_setprio 1
    v_mfma_f32_32x32x8bf16_1k v[32:47], v[154:155], v[114:115], 0
    v_exp_f32 v16, v16
    v_exp_f32 v17, v17
    v_exp_f32 v18, v18
    v_exp_f32 v19, v19
    v_exp_f32 v20, v20
    v_mfma_f32_32x32x16_bf16 v[56:71], v[146:149], v[52:55], v[56:71]
    v_exp_f32 v21, v21
    v_exp_f32 v22, v22
    v_exp_f32 v23, v23
    v_cvt_pk_bf16_f32 v48, v16, v17
    v_cvt_pk_bf16_f32 v49, v18, v19
    v_cvt_pk_bf16_f32 v50, v20, v21
    v_cvt_pk_bf16_f32 v51, v22, v23
    v_mfma_f32_32x32x16_bf16 v[32:47], v[150:153], v[110:113], v[32:47]
    s_or_b32 s7, s44, 0
    s_mul_i32 s7, s7, 5120
    s_add_u32 s7, s7, s47
    buffer_load_dwordx4 v[122:125], v2, s[32:35], s7 offen sc1
    s_mov_b64 exec, s[62:63]
    buffer_load_dwordx2 v[126:127], v3, s[32:35], s7 offen offset:1024 sc1
    s_mov_b64 exec, -1
    buffer_load_dwordx4 v[192:195], v2, s[32:35], s56 offen sc1
    s_mov_b64 exec, s[62:63]
    buffer_load_dwordx2 v[196:197], v3, s[32:35], s56 offen offset:2304 sc1
    s_mov_b64 exec, s[64:65]
    buffer_load_dwordx4 v[198:201], v4, s[32:35], s56 offen offset:1024 sc1
    buffer_load_dwordx4 v[202:205], v5, s[32:35], s56 offen offset:1024 sc1
    s_mov_b64 exec, -1
    v_exp_f32 v24, v24
    v_exp_f32 v25, v25
    v_exp_f32 v26, v26
    v_exp_f32 v27, v27
    v_exp_f32 v28, v28
    s_waitcnt vmcnt(18)
    v_mfma_f32_32x32x16_bf16 v[72:87], v[156:159], v[48:51], v[72:87]
    v_exp_f32 v29, v29
    v_exp_f32 v30, v30
    v_exp_f32 v31, v31
    v_cvt_pk_bf16_f32 v52, v24, v25
    v_cvt_pk_bf16_f32 v53, v26, v27
    v_cvt_pk_bf16_f32 v54, v28, v29
    v_cvt_pk_bf16_f32 v55, v30, v31
    s_setprio 0
    v_mfma_f32_32x32x8bf16_1k v[16:31], v[168:169], v[108:109], 0
    v_exp_f32 v32, v32
    v_exp_f32 v33, v33
    v_exp_f32 v34, v34
    v_exp_f32 v35, v35
    v_exp_f32 v36, v36
    v_mfma_f32_32x32x16_bf16 v[72:87], v[160:163], v[52:55], v[72:87]
    v_exp_f32 v37, v37
    v_exp_f32 v38, v38
    v_exp_f32 v39, v39
    v_cvt_pk_bf16_f32 v48, v32, v33
    v_cvt_pk_bf16_f32 v49, v34, v35
    v_cvt_pk_bf16_f32 v50, v36, v37
    v_cvt_pk_bf16_f32 v51, v38, v39
    v_mfma_f32_32x32x16_bf16 v[16:31], v[164:167], v[104:107], v[16:31]
    buffer_load_dwordx4 v13, s[8:11], s51 offen lds
    s_add_u32 m0, m0, 6400
    s_add_u32 s51, s51, 51200
    buffer_load_dwordx4 v[206:209], v2, s[32:35], s57 offen sc1
    s_mov_b64 exec, s[62:63]
    buffer_load_dwordx2 v[210:211], v3, s[32:35], s57 offen offset:2304 sc1
    s_mov_b64 exec, s[64:65]
    buffer_load_dwordx4 v[212:215], v4, s[32:35], s57 offen offset:1024 sc1
    buffer_load_dwordx4 v[216:219], v5, s[32:35], s57 offen offset:1024 sc1
    s_mov_b64 exec, -1
    v_exp_f32 v40, v40
    v_exp_f32 v41, v41
    v_exp_f32 v42, v42
    v_exp_f32 v43, v43
    v_exp_f32 v44, v44
    v_mfma_f32_32x32x16_bf16 v[56:71], v[156:159], v[48:51], v[56:71]
    v_exp_f32 v45, v45
    v_exp_f32 v46, v46
    v_exp_f32 v47, v47
    v_cvt_pk_bf16_f32 v52, v40, v41
    v_cvt_pk_bf16_f32 v53, v42, v43
    v_cvt_pk_bf16_f32 v54, v44, v45
    v_cvt_pk_bf16_f32 v55, v46, v47
    s_setprio 3
    v_mfma_f32_32x32x8bf16_1k v[32:47], v[168:169], v[114:115], 0
    v_exp_f32 v16, v16
    v_exp_f32 v17, v17
    v_exp_f32 v18, v18
    v_exp_f32 v19, v19
    v_exp_f32 v20, v20
    v_mfma_f32_32x32x16_bf16 v[56:71], v[160:163], v[52:55], v[56:71]
    v_exp_f32 v21, v21
    v_exp_f32 v22, v22
    v_exp_f32 v23, v23
    v_cvt_pk_bf16_f32 v48, v16, v17
    v_cvt_pk_bf16_f32 v49, v18, v19
    v_cvt_pk_bf16_f32 v50, v20, v21
    v_cvt_pk_bf16_f32 v51, v22, v23
    v_mfma_f32_32x32x16_bf16 v[32:47], v[164:167], v[110:113], v[32:47]
    buffer_load_dwordx4 v[220:223], v2, s[32:35], s58 offen sc1
    s_mov_b64 exec, s[62:63]
    buffer_load_dwordx2 v[224:225], v3, s[32:35], s58 offen offset:2304 sc1
    s_mov_b64 exec, s[64:65]
    buffer_load_dwordx4 v[226:229], v4, s[32:35], s58 offen offset:1024 sc1
    buffer_load_dwordx4 v[230:233], v5, s[32:35], s58 offen offset:1024 sc1
    s_mov_b64 exec, -1
    v_exp_f32 v24, v24
    v_exp_f32 v25, v25
    v_exp_f32 v26, v26
    v_exp_f32 v27, v27
    v_exp_f32 v28, v28
    s_waitcnt vmcnt(22)
    v_mfma_f32_32x32x16_bf16 v[72:87], v[170:173], v[48:51], v[72:87]
    v_exp_f32 v29, v29
    v_exp_f32 v30, v30
    v_exp_f32 v31, v31
    v_cvt_pk_bf16_f32 v52, v24, v25
    v_cvt_pk_bf16_f32 v53, v26, v27
    v_cvt_pk_bf16_f32 v54, v28, v29
    v_cvt_pk_bf16_f32 v55, v30, v31
    s_setprio 2
    v_mfma_f32_32x32x8bf16_1k v[16:31], v[182:183], v[108:109], 0
    v_exp_f32 v32, v32
    v_exp_f32 v33, v33
    v_exp_f32 v34, v34
    v_exp_f32 v35, v35
    v_exp_f32 v36, v36
    v_mfma_f32_32x32x16_bf16 v[72:87], v[174:177], v[52:55], v[72:87]
    v_exp_f32 v37, v37
    v_exp_f32 v38, v38
    v_exp_f32 v39, v39
    v_cvt_pk_bf16_f32 v48, v32, v33
    v_cvt_pk_bf16_f32 v49, v34, v35
    v_cvt_pk_bf16_f32 v50, v36, v37
    v_cvt_pk_bf16_f32 v51, v38, v39
    v_mfma_f32_32x32x16_bf16 v[16:31], v[178:181], v[104:107], v[16:31]
    buffer_load_dwordx4 v[234:237], v2, s[32:35], s59 offen sc1
    s_mov_b64 exec, s[62:63]
    buffer_load_dwordx2 v[238:239], v3, s[32:35], s59 offen offset:2304 sc1
    s_mov_b64 exec, s[64:65]
    buffer_load_dwordx4 v[240:243], v4, s[32:35], s59 offen offset:1024 sc1
    buffer_load_dwordx4 v[244:247], v5, s[32:35], s59 offen offset:1024 sc1
    s_mov_b64 exec, -1
    v_exp_f32 v40, v40
    v_exp_f32 v41, v41
    v_exp_f32 v42, v42
    v_exp_f32 v43, v43
    v_exp_f32 v44, v44
    v_mfma_f32_32x32x16_bf16 v[56:71], v[170:173], v[48:51], v[56:71]
    v_exp_f32 v45, v45
    v_exp_f32 v46, v46
    v_exp_f32 v47, v47
    v_cvt_pk_bf16_f32 v52, v40, v41
    v_cvt_pk_bf16_f32 v53, v42, v43
    v_cvt_pk_bf16_f32 v54, v44, v45
    v_cvt_pk_bf16_f32 v55, v46, v47
    s_setprio 1
    v_mfma_f32_32x32x8bf16_1k v[32:47], v[182:183], v[114:115], 0
    v_exp_f32 v16, v16
    v_exp_f32 v17, v17
    v_exp_f32 v18, v18
    v_exp_f32 v19, v19
    v_exp_f32 v20, v20
    v_mfma_f32_32x32x16_bf16 v[56:71], v[174:177], v[52:55], v[56:71]
    v_exp_f32 v21, v21
    v_exp_f32 v22, v22
    v_exp_f32 v23, v23
    v_cvt_pk_bf16_f32 v48, v16, v17
    v_cvt_pk_bf16_f32 v49, v18, v19
    v_cvt_pk_bf16_f32 v50, v20, v21
    v_cvt_pk_bf16_f32 v51, v22, v23
    v_mfma_f32_32x32x16_bf16 v[32:47], v[178:181], v[110:113], v[32:47]
    buffer_load_dwordx4 v[136:139], v2, s[32:35], s60 offen sc1
    s_mov_b64 exec, s[62:63]
    buffer_load_dwordx2 v[140:141], v3, s[32:35], s60 offen offset:2304 sc1
    s_mov_b64 exec, s[64:65]
    buffer_load_dwordx4 v[142:145], v4, s[32:35], s60 offen offset:1024 sc1
    buffer_load_dwordx4 v[146:149], v5, s[32:35], s60 offen offset:1024 sc1
    s_mov_b64 exec, -1
    v_exp_f32 v24, v24
    v_exp_f32 v25, v25
    v_exp_f32 v26, v26
    v_exp_f32 v27, v27
    v_exp_f32 v28, v28
    s_waitcnt vmcnt(28)
    v_mfma_f32_32x32x16_bf16 v[72:87], v[184:187], v[48:51], v[72:87]
    v_exp_f32 v29, v29
    v_exp_f32 v30, v30
    v_exp_f32 v31, v31
    v_cvt_pk_bf16_f32 v52, v24, v25
    v_cvt_pk_bf16_f32 v53, v26, v27
    v_cvt_pk_bf16_f32 v54, v28, v29
    v_cvt_pk_bf16_f32 v55, v30, v31
    s_setprio 0
    v_exp_f32 v32, v32
    v_exp_f32 v33, v33
    v_exp_f32 v34, v34
    v_exp_f32 v35, v35
    v_exp_f32 v36, v36
    v_mfma_f32_32x32x16_bf16 v[72:87], v[188:191], v[52:55], v[72:87]
    v_exp_f32 v37, v37
    v_exp_f32 v38, v38
    v_exp_f32 v39, v39
    v_cvt_pk_bf16_f32 v48, v32, v33
    v_cvt_pk_bf16_f32 v49, v34, v35
    v_cvt_pk_bf16_f32 v50, v36, v37
    v_cvt_pk_bf16_f32 v51, v38, v39
    v_exp_f32 v40, v40
    v_exp_f32 v41, v41
    v_exp_f32 v42, v42
    v_exp_f32 v43, v43
    v_exp_f32 v44, v44
    v_mfma_f32_32x32x16_bf16 v[56:71], v[184:187], v[48:51], v[56:71]
    v_exp_f32 v45, v45
    v_exp_f32 v46, v46
    v_exp_f32 v47, v47
    v_cvt_pk_bf16_f32 v52, v40, v41
    v_cvt_pk_bf16_f32 v53, v42, v43
    v_cvt_pk_bf16_f32 v54, v44, v45
    v_cvt_pk_bf16_f32 v55, v46, v47
    s_nop 1
    v_mfma_f32_32x32x16_bf16 v[56:71], v[188:191], v[52:55], v[56:71]
    s_setprio 3
    ds_write_b128 v14, v[72:75] offset:0
    ds_write_b128 v14, v[76:79] offset:1024
    ds_write_b128 v14, v[80:83] offset:2048
    s_waitcnt vmcnt(21)
    v_max3_u32 v10, v116, v117, v118
    v_max3_u32 v11, v119, v120, v121
    v_max3_u32 v10, v10, v122, v123
    v_max3_u32 v11, v11, v124, v125
    v_max3_u32 v10, v10, v126, v127
    v_max_u32 v10, v10, v11
    v_cmp_eq_u32 vcc, -1, v10
    s_cmp_lg_u64 vcc, 0
    s_cbranch_scc1 L_qw1
L_qb1:
    v_mfma_f32_32x32x8bf16_1k v[16:31], v[132:133], v[120:121], 0
    v_mfma_f32_32x32x8bf16_1k v[32:47], v[132:133], v[126:127], 0
    s_cmp_eq_u32 s53, 0
    s_cbranch_scc1 L_t0_0
L_t0b_0:
    v_mfma_f32_32x32x16_bf16 v[16:31], v[128:131], v[116:119], v[16:31]
    v_mfma_f32_32x32x16_bf16 v[32:47], v[128:131], v[122:125], v[32:47]
    s_waitcnt vmcnt(16)
    s_waitcnt lgkmcnt(0)
    s_barrier
    ds_read_b128 v[72:75], v134 offset:0
    ds_read_b128 v[76:79], v134 offset:1024
    ds_read_b128 v[80:83], v134 offset:2048
    s_nop 4
    v_max3_f32 v12, v16, v17, v18
    v_max3_f32 v10, v19, v20, v21
    v_max3_f32 v11, v32, v33, v34
    v_max3_f32 v55, v35, v36, v37
    v_max3_f32 v12, v12, v22, v23
    v_max3_f32 v10, v10, v24, v25
    v_max3_f32 v11, v11, v38, v39
    v_max3_f32 v55, v55, v40, v41
    v_max3_f32 v12, v12, v26, v27
    v_max3_f32 v10, v10, v28, v29
    v_max3_f32 v11, v11, v42, v43
    v_max3_f32 v55, v55, v44, v45
    v_max3_f32 v12, v12, v30, v31
    v_max3_f32 v11, v11, v46, v47
    v_max_f32 v12, v12, v10
    v_max_f32 v11, v11, v55
    v_mov_b32 v10, v12
    v_mov_b32 v55, v11
    s_nop 0
    v_permlane32_swap_b32 v10, v12
    v_permlane32_swap_b32 v55, v11
    v_max_f32 v12, v12, v10
    v_max_f32 v11, v11, v55
    v_sub_f32 v12, 0xc2b00000, v12
    v_sub_f32 v11, 0xc2b00000, v11
    v_cvt_pk_bf16_f32 v12, v12, v15
    v_cvt_pk_bf16_f32 v11, v11, v15
    v_cndmask_b32_e64 v120, v12, v120, s[62:63]
    v_cndmask_b32_e64 v126, v11, v126, s[62:63]
    s_waitcnt lgkmcnt(0)
    v_pk_add_f32 v[64:65], v[64:65], v[80:81]
    v_pk_add_f32 v[66:67], v[66:67], v[82:83]
    v_cmp_lt_f32 vcc, 0x0d800000, v64
    s_mov_b32 s7, vcc_hi
    v_cmp_gt_f32 vcc, 0x71800000, v64
    s_and_b32 s7, s7, vcc_hi
    v_pk_add_f32 v[56:57], v[56:57], v[72:73]
    v_pk_add_f32 v[58:59], v[58:59], v[74:75]
    v_pk_add_f32 v[60:61], v[60:61], v[76:77]
    v_pk_add_f32 v[62:63], v[62:63], v[78:79]
    s_mov_b32 s100, 0
    s_cmp_eq_u32 s7, -1
    s_cbranch_scc0 L_fb
L_ret0:
    v_mov_b32 v10, v64
    v_mov_b32 v11, v64
    v_mfma_f32_32x32x8bf16_1k v[32:47], v[196:197], v[126:127], v[88:103]
    s_nop 0
    v_permlane32_swap_b32 v10, v11
    v_rcp_f32 v11, v11
    v_mfma_f32_32x32x16_bf16 v[32:47], v[192:195], v[122:125], v[32:47]
    v_mul_f32 v56, v11, v56
    v_mul_f32 v57, v11, v57
    v_mul_f32 v58, v11, v58
    v_mul_f32 v59, v11, v59
    v_mul_f32 v60, v11, v60
    v_mul_f32 v61, v11, v61
    v_mul_f32 v62, v11, v62
    v_mul_f32 v63, v11, v63
    v_mul_f32 v64, v11, v64
    v_mul_f32 v65, v11, v65
    v_mul_f32 v66, v11, v66
    v_mul_f32 v67, v11, v67
    v_cvt_pk_bf16_f32 v72, v56, v57
    v_cvt_pk_bf16_f32 v73, v58, v59
    v_cvt_pk_bf16_f32 v74, v60, v61
    v_cvt_pk_bf16_f32 v75, v62, v63
    v_cvt_pk_bf16_f32 v76, v64, v65
    v_cvt_pk_bf16_f32 v77, v66, v67
    buffer_store_dwordx4 v[72:75], v2, s[32:35], s16 offen sc1
    s_mov_b64 exec, s[62:63]
    buffer_store_dwordx2 v[76:77], v3, s[32:35], s16 offen offset:1024 sc1
    s_mov_b64 exec, -1
    s_setprio 2
    s_waitcnt vmcnt(16)
    v_mfma_f32_32x32x8bf16_1k v[16:31], v[210:211], v[120:121], v[88:103]
    v_exp_f32 v32, v32
    v_exp_f32 v33, v33
    v_exp_f32 v34, v34
    v_exp_f32 v35, v35
    v_exp_f32 v36, v36
    v_exp_f32 v37, v37
    v_exp_f32 v38, v38
    v_exp_f32 v39, v39
    v_cvt_pk_bf16_f32 v48, v32, v33
    v_cvt_pk_bf16_f32 v49, v34, v35
    v_cvt_pk_bf16_f32 v50, v36, v37
    v_cvt_pk_bf16_f32 v51, v38, v39
    v_mfma_f32_32x32x16_bf16 v[16:31], v[206:209], v[116:119], v[16:31]
    v_exp_f32 v40, v40
    v_exp_f32 v41, v41
    v_exp_f32 v42, v42
    v_exp_f32 v43, v43
    v_exp_f32 v44, v44
    v_mfma_f32_32x32x16_bf16 v[56:71], v[198:201], v[48:51], 0
    v_exp_f32 v45, v45
    v_exp_f32 v46, v46
    v_exp_f32 v47, v47
    v_cvt_pk_bf16_f32 v52, v40, v41
    v_cvt_pk_bf16_f32 v53, v42, v43
    v_cvt_pk_bf16_f32 v54, v44, v45
    v_cvt_pk_bf16_f32 v55, v46, v47
    v_mfma_f32_32x32x8bf16_1k v[32:47], v[210:211], v[126:127], 0
    v_exp_f32 v16, v16
    v_exp_f32 v17, v17
    v_exp_f32 v18, v18
    v_exp_f32 v19, v19
    v_exp_f32 v20, v20
    v_mfma_f32_32x32x16_bf16 v[56:71], v[202:205], v[52:55], v[56:71]
    v_exp_f32 v21, v21
    v_exp_f32 v22, v22
    v_exp_f32 v23, v23
    v_cvt_pk_bf16_f32 v48, v16, v17
    v_cvt_pk_bf16_f32 v49, v18, v19
    v_cvt_pk_bf16_f32 v50, v20, v21
    v_cvt_pk_bf16_f32 v51, v22, v23
    v_mfma_f32_32x32x16_bf16 v[32:47], v[206:209], v[122:125], v[32:47]
    v_exp_f32 v24, v24
    v_exp_f32 v25, v25
    v_exp_f32 v26, v26
    v_exp_f32 v27, v27
    v_exp_f32 v28, v28
    s_waitcnt vmcnt(14)
    v_mfma_f32_32x32x16_bf16 v[72:87], v[212:215], v[48:51], 0
    v_exp_f32 v29, v29
    v_exp_f32 v30, v30
    v_exp_f32 v31, v31
    v_cvt_pk_bf16_f32 v52, v24, v25
    v_cvt_pk_bf16_f32 v53, v26, v27
    v_cvt_pk_bf16_f32 v54, v28, v29
    v_cvt_pk_bf16_f32 v55, v30, v31
    s_setprio 2
    s_waitcnt vmcnt(12)
    v_mfma_f32_32x32x8bf16_1k v[16:31], v[224:225], v[120:121], 0
    v_exp_f32 v32, v32
    v_exp_f32 v33, v33
    v_exp_f32 v34, v34
    v_exp_f32 v35, v35
    v_exp_f32 v36, v36
    v_mfma_f32_32x32x16_bf16 v[72:87], v[216:219], v[52:55], v[72:87]
    v_exp_f32 v37, v37
    v_exp_f32 v38, v38
    v_exp_f32 v39, v39
    v_cvt_pk_bf16_f32 v48, v32, v33
    v_cvt_pk_bf16_f32 v49, v34, v35
    v_cvt_pk_bf16_f32 v50, v36, v37
    v_cvt_pk_bf16_f32 v51, v38, v39
    v_mfma_f32_32x32x16_bf16 v[16:31], v[220:223], v[116:119], v[16:31]
    v_exp_f32 v40, v40
    v_exp_f32 v41, v41
    v_exp_f32 v42, v42
    v_exp_f32 v43, v43
    v_exp_f32 v44, v44
    v_mfma_f32_32x32x16_bf16 v[56:71], v[212:215], v[48:51], v[56:71]
    v_exp_f32 v45, v45
    v_exp_f32 v46, v46
    v_exp_f32 v47, v47
    v_cvt_pk_bf16_f32 v52, v40, v41
    v_cvt_pk_bf16_f32 v53, v42, v43
    v_cvt_pk_bf16_f32 v54, v44, v45
    v_cvt_pk_bf16_f32 v55, v46, v47
    v_mfma_f32_32x32x8bf16_1k v[32:47], v[224:225], v[126:127], 0
    v_exp_f32 v16, v16
    v_exp_f32 v17, v17
    v_exp_f32 v18, v18
    v_exp_f32 v19, v19
    v_exp_f32 v20, v20
    v_mfma_f32_32x32x16_bf16 v[56:71], v[216:219], v[52:55], v[56:71]
    v_exp_f32 v21, v21
    v_exp_f32 v22, v22
    v_exp_f32 v23, v23
    v_cvt_pk_bf16_f32 v48, v16, v17
    v_cvt_pk_bf16_f32 v49, v18, v19
    v_cvt_pk_bf16_f32 v50, v20, v21
    v_cvt_pk_bf16_f32 v51, v22, v23
    v_mfma_f32_32x32x16_bf16 v[32:47], v[220:223], v[122:125], v[32:47]
    ds_read_b64_tr_b16 v[88:89], v250 offset:38528
    ds_read_b64_tr_b16 v[90:91], v250 offset:39808
    ds_read_b64_tr_b16 v[92:93], v250 offset:44800
    ds_read_b64_tr_b16 v[94:95], v250 offset:46080
    ds_read_b64_tr_b16 v[96:97], v250 offset:44832
    ds_read_b64_tr_b16 v[98:99], v250 offset:46112
    ds_read_b64_tr_b16 v[100:101], v250 offset:44864
    ds_read_b64_tr_b16 v[102:103], v250 offset:46144
    ds_read_b64_tr_b16 v[128:129], v250 offset:44896
    ds_read_b64_tr_b16 v[130:131], v250 offset:46176
    v_exp_f32 v24, v24
    v_exp_f32 v25, v25
    v_exp_f32 v26, v26
    v_exp_f32 v27, v27
    v_exp_f32 v28, v28
    s_waitcnt vmcnt(10)
    v_mfma_f32_32x32x16_bf16 v[72:87], v[226:229], v[48:51], v[72:87]
    v_exp_f32 v29, v29
    v_exp_f32 v30, v30
    v_exp_f32 v31, v31
    v_cvt_pk_bf16_f32 v52, v24, v25
    v_cvt_pk_bf16_f32 v53, v26, v27
    v_cvt_pk_bf16_f32 v54, v28, v29
    v_cvt_pk_bf16_f32 v55, v30, v31
    s_setprio 1
    s_waitcnt vmcnt(8)
    v_mfma_f32_32x32x8bf16_1k v[16:31], v[238:239], v[120:121], 0
    v_exp_f32 v32, v32
    v_exp_f32 v33, v33
    v_exp_f32 v34, v34
    v_exp_f32 v35, v35
    v_exp_f32 v36, v36
    v_mfma_f32_32x32x16_bf16 v[72:87], v[230:233], v[52:55], v[72:87]
    v_exp_f32 v37, v37
    v_exp_f32 v38, v38
    v_exp_f32 v39, v39
    v_cvt_pk_bf16_f32 v48, v32, v33
    v_cvt_pk_bf16_f32 v49, v34, v35
    v_cvt_pk_bf16_f32 v50, v36, v37
    v_cvt_pk_bf16_f32 v51, v38, v39
    v_mfma_f32_32x32x16_bf16 v[16:31], v[234:237], v[116:119], v[16:31]
    ds_read_b64_tr_b16 v[192:193], v250 offset:25600
    ds_read_b64_tr_b16 v[194:195], v250 offset:26880
    ds_read_b64_tr_b16 v[196:197], v250 offset:25632
    ds_read_b64_tr_b16 v[198:199], v250 offset:26912
    ds_read_b64_tr_b16 v[200:201], v250 offset:25664
    ds_read_b64_tr_b16 v[202:203], v250 offset:26944
    ds_read_b64_tr_b16 v[204:205], v250 offset:25696
    ds_read_b64_tr_b16 v[206:207], v250 offset:26976
    ds_read_b64_tr_b16 v[208:209], v250 offset:25728
    ds_read_b64_tr_b16 v[210:211], v250 offset:27008
    ds_read_b64_tr_b16 v[212:213], v250 offset:32000
    ds_read_b64_tr_b16 v[214:215], v250 offset:33280
    ds_read_b64_tr_b16 v[216:217], v250 offset:32032
    ds_read_b64_tr_b16 v[218:219], v250 offset:33312
    v_exp_f32 v40, v40
    v_exp_f32 v41, v41
    v_exp_f32 v42, v42
    v_exp_f32 v43, v43
    v_exp_f32 v44, v44
    v_mfma_f32_32x32x16_bf16 v[56:71], v[226:229], v[48:51], v[56:71]
    v_exp_f32 v45, v45
    v_exp_f32 v46, v46
    v_exp_f32 v47, v47
    v_cvt_pk_bf16_f32 v52, v40, v41
    v_cvt_pk_bf16_f32 v53, v42, v43
    v_cvt_pk_bf16_f32 v54, v44, v45
    v_cvt_pk_bf16_f32 v55, v46, v47
    v_mfma_f32_32x32x8bf16_1k v[32:47], v[238:239], v[126:127], 0
    v_exp_f32 v16, v16
    v_exp_f32 v17, v17
    v_exp_f32 v18, v18
    v_exp_f32 v19, v19
    v_exp_f32 v20, v20
    v_mfma_f32_32x32x16_bf16 v[56:71], v[230:233], v[52:55], v[56:71]
    v_exp_f32 v21, v21
    v_exp_f32 v22, v22
    v_exp_f32 v23, v23
    v_cvt_pk_bf16_f32 v48, v16, v17
    v_cvt_pk_bf16_f32 v49, v18, v19
    v_cvt_pk_bf16_f32 v50, v20, v21
    v_cvt_pk_bf16_f32 v51, v22, v23
    v_mfma_f32_32x32x16_bf16 v[32:47], v[234:237], v[122:125], v[32:47]
    s_mov_b32 s68, 0
    s_mov_b32 s69, 0xffff0000
    s_andn2_b64 s[70:71], s[68:69], s[66:67]
    s_cbranch_scc1 L_pw4
L_pb4:
    v_exp_f32 v24, v24
    v_exp_f32 v25, v25
    v_exp_f32 v26, v26
    v_exp_f32 v27, v27
    v_exp_f32 v28, v28
    s_waitcnt vmcnt(6)
    v_mfma_f32_32x32x16_bf16 v[72:87], v[240:243], v[48:51], v[72:87]
    v_exp_f32 v29, v29
    v_exp_f32 v30, v30
    v_exp_f32 v31, v31
    v_cvt_pk_bf16_f32 v52, v24, v25
    v_cvt_pk_bf16_f32 v53, v26, v27
    v_cvt_pk_bf16_f32 v54, v28, v29
    v_cvt_pk_bf16_f32 v55, v30, v31
    s_setprio 0
    s_waitcnt vmcnt(4)
    v_mfma_f32_32x32x8bf16_1k v[16:31], v[140:141], v[120:121], 0
    v_exp_f32 v32, v32
    v_exp_f32 v33, v33
    v_exp_f32 v34, v34
    v_exp_f32 v35, v35
    v_exp_f32 v36, v36
    v_mfma_f32_32x32x16_bf16 v[72:87], v[244:247], v[52:55], v[72:87]
    v_exp_f32 v37, v37
    v_exp_f32 v38, v38
    v_exp_f32 v39, v39
    v_cvt_pk_bf16_f32 v48, v32, v33
    v_cvt_pk_bf16_f32 v49, v34, v35
    v_cvt_pk_bf16_f32 v50, v36, v37
    v_cvt_pk_bf16_f32 v51, v38, v39
    v_mfma_f32_32x32x16_bf16 v[16:31], v[136:139], v[116:119], v[16:31]
    s_add_u32 s7, s42, 0
    buffer_load_dwordx4 v[150:153], v248, s[32:35], s7 offen offset:0 sc1
    buffer_load_dwordx4 v[154:157], v248, s[32:35], s7 offen offset:2560 sc1
    s_add_u32 s7, s42, 5120
    buffer_load_dwordx4 v[158:161], v248, s[32:35], s7 offen offset:0 sc1
    buffer_load_dwordx4 v[162:165], v248, s[32:35], s7 offen offset:2560 sc1
    s_add_u32 s7, s42, 0
    buffer_load_dwordx2 v[166:167], v249, s[32:35], s7 offen offset:1024 sc1
    s_add_u32 s7, s42, 5120
    buffer_load_dwordx2 v[168:169], v249, s[32:35], s7 offen offset:1024 sc1
    v_exp_f32 v40, v40
    v_exp_f32 v41, v41
    v_exp_f32 v42, v42
    v_exp_f32 v43, v43
    v_exp_f32 v44, v44
    v_mfma_f32_32x32x16_bf16 v[56:71], v[240:243], v[48:51], v[56:71]
    v_exp_f32 v45, v45
    v_exp_f32 v46, v46
    v_exp_f32 v47, v47
    v_cvt_pk_bf16_f32 v52, v40, v41
    v_cvt_pk_bf16_f32 v53, v42, v43
    v_cvt_pk_bf16_f32 v54, v44, v45
    v_cvt_pk_bf16_f32 v55, v46, v47
    v_mfma_f32_32x32x8bf16_1k v[32:47], v[140:141], v[126:127], 0
    v_exp_f32 v16, v16
    v_exp_f32 v17, v17
    v_exp_f32 v18, v18
    v_exp_f32 v19, v19
    v_exp_f32 v20, v20
    v_mfma_f32_32x32x16_bf16 v[56:71], v[244:247], v[52:55], v[56:71]
    v_exp_f32 v21, v21
    v_exp_f32 v22, v22
    v_exp_f32 v23, v23
    v_cvt_pk_bf16_f32 v48, v16, v17
    v_cvt_pk_bf16_f32 v49, v18, v19
    v_cvt_pk_bf16_f32 v50, v20, v21
    v_cvt_pk_bf16_f32 v51, v22, v23
    v_mfma_f32_32x32x16_bf16 v[32:47], v[136:139], v[122:125], v[32:47]
    s_add_u32 s7, s42, 10240
    buffer_load_dwordx4 v[170:173], v248, s[32:35], s7 offen offset:0 sc1
    buffer_load_dwordx4 v[174:177], v248, s[32:35], s7 offen offset:2560 sc1
    s_add_u32 s7, s42, 15360
    buffer_load_dwordx4 v[178:181], v248, s[32:35], s7 offen offset:0 sc1
    buffer_load_dwordx4 v[182:185], v248, s[32:35], s7 offen offset:2560 sc1
    s_add_u32 s7, s42, 10240
    buffer_load_dwordx2 v[186:187], v249, s[32:35], s7 offen offset:1024 sc1
    s_add_u32 s7, s42, 15360
    buffer_load_dwordx2 v[188:189], v249, s[32:35], s7 offen offset:1024 sc1
    ds_read_b64_tr_b16 v[220:221], v250 offset:32064
    ds_read_b64_tr_b16 v[222:223], v250 offset:33344
    ds_read_b64_tr_b16 v[224:225], v250 offset:32096
    ds_read_b64_tr_b16 v[226:227], v250 offset:33376
    ds_read_b64_tr_b16 v[228:229], v250 offset:32128
    ds_read_b64_tr_b16 v[230:231], v250 offset:33408
    v_exp_f32 v24, v24
    v_exp_f32 v25, v25
    v_exp_f32 v26, v26
    v_exp_f32 v27, v27
    v_exp_f32 v28, v28
    s_waitcnt vmcnt(14)
    v_mfma_f32_32x32x16_bf16 v[72:87], v[142:145], v[48:51], v[72:87]
    v_exp_f32 v29, v29
    v_exp_f32 v30, v30
    v_exp_f32 v31, v31
    v_cvt_pk_bf16_f32 v52, v24, v25
    v_cvt_pk_bf16_f32 v53, v26, v27
    v_cvt_pk_bf16_f32 v54, v28, v29
    v_cvt_pk_bf16_f32 v55, v30, v31
    v_exp_f32 v32, v32
    v_exp_f32 v33, v33
    v_exp_f32 v34, v34
    v_exp_f32 v35, v35
    v_exp_f32 v36, v36
    v_mfma_f32_32x32x16_bf16 v[72:87], v[146:149], v[52:55], v[72:87]
    v_exp_f32 v37, v37
    v_exp_f32 v38, v38
    v_exp_f32 v39, v39
    v_cvt_pk_bf16_f32 v48, v32, v33
    v_cvt_pk_bf16_f32 v49, v34, v35
    v_cvt_pk_bf16_f32 v50, v36, v37
    v_cvt_pk_bf16_f32 v51, v38, v39
    ds_read_b64_tr_b16 v[232:233], v250 offset:38400
    ds_read_b64_tr_b16 v[234:235], v250 offset:39680
    ds_read_b64_tr_b16 v[236:237], v250 offset:38432
    ds_read_b64_tr_b16 v[238:239], v250 offset:39712
    ds_read_b64_tr_b16 v[240:241], v250 offset:38464
    ds_read_b64_tr_b16 v[242:243], v250 offset:39744
    ds_read_b64_tr_b16 v[244:245], v250 offset:38496
    ds_read_b64_tr_b16 v[246:247], v250 offset:39776
    ds_read_b64_tr_b16 v[136:137], v250 offset:44928
    ds_read_b64_tr_b16 v[138:139], v250 offset:46208
    v_exp_f32 v40, v40
    v_exp_f32 v41, v41
    v_exp_f32 v42, v42
    v_exp_f32 v43, v43
    v_exp_f32 v44, v44
    v_mfma_f32_32x32x16_bf16 v[56:71], v[142:145], v[48:51], v[56:71]
    v_exp_f32 v45, v45
    v_exp_f32 v46, v46
    v_exp_f32 v47, v47
    v_cvt_pk_bf16_f32 v52, v40, v41
    v_cvt_pk_bf16_f32 v53, v42, v43
    v_cvt_pk_bf16_f32 v54, v44, v45
    v_cvt_pk_bf16_f32 v55, v46, v47
    s_nop 1
    v_mfma_f32_32x32x16_bf16 v[56:71], v[146:149], v[52:55], v[56:71]
    ds_read_b64_tr_b16 v[140:141], v251 offset:25600
    ds_read_b64_tr_b16 v[142:143], v251 offset:38400
    ds_read_b64_tr_b16 v[144:145], v251 offset:25632
    ds_read_b64_tr_b16 v[146:147], v251 offset:38432
    s_setprio 3
    ds_write_b128 v14, v[72:75] offset:24576
    ds_write_b128 v14, v[76:79] offset:25600
    ds_write_b128 v14, v[80:83] offset:26624
    s_waitcnt lgkmcnt(0)
    s_barrier
    ds_read_b128 v[72:75], v134 offset:24576
    ds_read_b128 v[76:79], v134 offset:25600
    ds_read_b128 v[80:83], v134 offset:26624
    s_waitcnt lgkmcnt(0)
    v_pk_add_f32 v[64:65], v[64:65], v[80:81]
    v_pk_add_f32 v[66:67], v[66:67], v[82:83]
    v_cmp_lt_f32 vcc, 0x0d800000, v64
    s_mov_b32 s7, vcc_hi
    v_cmp_gt_f32 vcc, 0x71800000, v64
    s_and_b32 s7, s7, vcc_hi
    v_pk_add_f32 v[56:57], v[56:57], v[72:73]
    v_pk_add_f32 v[58:59], v[58:59], v[74:75]
    v_pk_add_f32 v[60:61], v[60:61], v[76:77]
    v_pk_add_f32 v[62:63], v[62:63], v[78:79]
    s_mov_b32 s100, 1
    s_cmp_eq_u32 s7, -1
    s_cbranch_scc0 L_fb
L_ret1:
    v_mov_b32 v10, v64
    v_mov_b32 v11, v64
    s_nop 1
    v_permlane32_swap_b32 v10, v11
    v_rcp_f32 v11, v11
    s_nop 0
    v_mul_f32 v56, v11, v56
    v_mul_f32 v57, v11, v57
    v_mul_f32 v58, v11, v58
    v_mul_f32 v59, v11, v59
    v_mul_f32 v60, v11, v60
    v_mul_f32 v61, v11, v61
    v_mul_f32 v62, v11, v62
    v_mul_f32 v63, v11, v63
    v_mul_f32 v64, v11, v64
    v_mul_f32 v65, v11, v65
    v_mul_f32 v66, v11, v66
    v_mul_f32 v67, v11, v67
    v_cvt_pk_bf16_f32 v72, v56, v57
    v_cvt_pk_bf16_f32 v73, v58, v59
    v_cvt_pk_bf16_f32 v74, v60, v61
    v_cvt_pk_bf16_f32 v75, v62, v63
    v_cvt_pk_bf16_f32 v76, v64, v65
    v_cvt_pk_bf16_f32 v77, v66, v67
    s_add_u32 s7, s16, 2621440
    buffer_store_dwordx4 v[72:75], v2, s[32:35], s7 offen sc1
    s_mov_b64 exec, s[62:63]
    buffer_store_dwordx2 v[76:77], v3, s[32:35], s7 offen offset:1024 sc1
    s_mov_b64 exec, -1
    s_branch L_out
L_path1:
    buffer_load_dwordx4 v[128:131], v2, s[32:35], s61 offen sc1
    s_mov_b64 exec, s[62:63]
    buffer_load_dwordx2 v[132:133], v3, s[32:35], s61 offen offset:2304 sc1
    s_mov_b64 exec, -1
    buffer_load_dwordx4 v[234:237], v2, s[32:35], s56 offen sc1
    s_mov_b64 exec, s[62:63]
    buffer_load_dwordx2 v[238:239], v3, s[32:35], s56 offen offset:2304 sc1
    s_mov_b64 exec, s[64:65]
    buffer_load_dwordx4 v[240:243], v4, s[32:35], s56 offen offset:1024 sc1
    buffer_load_dwordx4 v[244:247], v5, s[32:35], s56 offen offset:1024 sc1
    s_mov_b64 exec, -1
    s_mov_b32 s7, 0x3ea52b5c
    s_cmp_ge_u32 s3, 4
    v_mul_f32 v52, s7, v52
    v_mul_f32 v53, s7, v53
    v_mul_f32 v54, s7, v54
    v_mul_f32 v55, s7, v55
    v_cvt_pk_bf16_f32 v48, v52, v53
    v_cvt_pk_bf16_f32 v49, v54, v55
    v_mul_f32 v60, s7, v60
    v_mul_f32 v61, s7, v61
    v_mul_f32 v62, s7, v62
    v_mul_f32 v63, s7, v63
    v_cvt_pk_bf16_f32 v50, v60, v61
    v_cvt_pk_bf16_f32 v51, v62, v63
    s_nop 0
    v_permlane16_swap_b32 v48, v50
    v_permlane16_swap_b32 v49, v51
    v_mul_f32 v68, s7, v68
    v_mul_f32 v69, s7, v69
    v_mul_f32 v70, s7, v70
    v_mul_f32 v71, s7, v71
    v_cvt_pk_bf16_f32 v56, v68, v69
    v_cvt_pk_bf16_f32 v57, v70, v71
    v_mul_f32 v76, s7, v76
    v_mul_f32 v77, s7, v77
    v_mul_f32 v78, s7, v78
    v_mul_f32 v79, s7, v79
    v_cvt_pk_bf16_f32 v58, v76, v77
    v_cvt_pk_bf16_f32 v59, v78, v79
    s_nop 0
    v_permlane16_swap_b32 v56, v58
    v_permlane16_swap_b32 v57, v59
    s_cbranch_scc1 L_pk1
    v_mul_f32 v84, s7, v84
    v_mul_f32 v85, s7, v85
    v_mul_f32 v86, s7, v86
    v_mul_f32 v87, s7, v87
    v_cvt_pk_bf16_f32 v64, v84, v85
    v_cvt_pk_bf16_f32 v65, v86, v87
    v_mul_f32 v88, s7, v88
    v_mul_f32 v89, s7, v89
    v_mul_f32 v90, s7, v90
    v_mul_f32 v91, s7, v91
    v_cvt_pk_bf16_f32 v66, v88, v89
    v_cvt_pk_bf16_f32 v67, v90, v91
L_pk1:
    s_lshr_b32 s7, s45, 1
    s_cmp_eq_u32 s7, 1
    s_cbranch_scc1 L_qown1
    buffer_store_dwordx4 v[48:51], v19, s[32:35], s22 offen offset:0 sc1
    buffer_store_dwordx4 v[56:59], v19, s[32:35], s22 offen offset:1280 sc1
    s_cmp_ge_u32 s3, 4
    s_cbranch_scc1 L_qd1
    buffer_store_dwordx2 v[64:65], v93, s[32:35], s22 offen offset:1024 sc1
    buffer_store_dwordx2 v[66:67], v93, s[32:35], s22 offen offset:1088 sc1
    s_branch L_qd1
L_qown1:
    v_add_u32 v19, s23, v19
    v_add_u32 v93, s23, v93
    ds_write_b128 v19, v[48:51] offset:0
    ds_write_b128 v19, v[56:59] offset:1280
    s_cmp_ge_u32 s3, 4
    s_cbranch_scc1 L_qd1
    ds_write_b64 v93, v[64:65] offset:1024
    ds_write_b64 v93, v[66:67] offset:1088
L_qd1:
    s_waitcnt lgkmcnt(0)
    s_barrier
    ds_read_b128 v[116:119], v92 offset:5120
    ds_read_b128 v[122:125], v94 offset:0
    s_mov_b64 exec, s[62:63]
    ds_read_b64 v[120:121], v95 offset:6144
    ds_read_b64 v[126:127], v16 offset:1024
    s_mov_b64 exec, -1
    buffer_load_dwordx4 v[136:139], v2, s[32:35], s57 offen sc1
    s_mov_b64 exec, s[62:63]
    buffer_load_dwordx2 v[140:141], v3, s[32:35], s57 offen offset:2304 sc1
    s_mov_b64 exec, s[64:65]
    buffer_load_dwordx4 v[142:145], v4, s[32:35], s57 offen offset:1024 sc1
    buffer_load_dwordx4 v[146:149], v5, s[32:35], s57 offen offset:1024 sc1
    s_mov_b64 exec, -1
    s_xor_b32 s24, s3, 4
    s_mul_i32 s24, s24, 3072
    s_add_u32 s24, s24, 102656
    v_add_u32 v134, s24, v2
    s_cmp_eq_u32 s44, 0
    s_cselect_b32 s24, 0xf149f2ca, 0
    s_cselect_b32 s40, 0, 0xf149f2ca
    v_mov_b32 v10, s24
    v_mov_b32 v11, s40
    s_mov_b32 s68, 0xffffffff
    s_mov_b32 s69, 0xfffffff0
    v_cndmask_b32_e64 v88, v11, v10, s[68:69]
    s_mov_b32 s70, 0xfffffffe
    s_mov_b32 s71, 0xffffffe0
    v_cndmask_b32_e64 v89, v11, v10, s[70:71]
    s_mov_b32 s68, 0xfffffffc
    s_mov_b32 s69, 0xffffffc0
    v_cndmask_b32_e64 v90, v11, v10, s[68:69]
    s_mov_b32 s70, 0xfffffff8
    s_mov_b32 s71, 0xffffff80
    v_cndmask_b32_e64 v91, v11, v10, s[70:71]
    s_mov_b32 s68, 0xffffff00
    s_mov_b32 s69, 0xfffff000
    v_cndmask_b32_e64 v92, v11, v10, s[68:69]
    s_mov_b32 s70, 0xfffffe00
    s_mov_b32 s71, 0xffffe000
    v_cndmask_b32_e64 v93, v11, v10, s[70:71]
    s_mov_b32 s68, 0xfffffc00
    s_mov_b32 s69, 0xffffc000
    v_cndmask_b32_e64 v94, v11, v10, s[68:69]
    s_mov_b32 s70, 0xfffff800
    s_mov_b32 s71, 0xffff8000
    v_cndmask_b32_e64 v95, v11, v10, s[70:71]
    s_mov_b32 s68, 0xffff0000
    s_mov_b32 s69, 0xfff00000
    v_cndmask_b32_e64 v96, v11, v10, s[68:69]
    s_mov_b32 s70, 0xfffe0000
    s_mov_b32 s71, 0xffe00000
    v_cndmask_b32_e64 v97, v11, v10, s[70:71]
    s_mov_b32 s68, 0xfffc0000
    s_mov_b32 s69, 0xffc00000
    v_cndmask_b32_e64 v98, v11, v10, s[68:69]
    s_mov_b32 s70, 0xfff80000
    s_mov_b32 s71, 0xff800000
    v_cndmask_b32_e64 v99, v11, v10, s[70:71]
    s_mov_b32 s68, 0xff000000
    s_mov_b32 s69, 0xf0000000
    v_cndmask_b32_e64 v100, v11, v10, s[68:69]
    s_mov_b32 s70, 0xfe000000
    s_mov_b32 s71, 0xe0000000
    v_cndmask_b32_e64 v101, v11, v10, s[70:71]
    s_mov_b32 s68, 0xfc000000
    s_mov_b32 s69, 0xc0000000
    v_cndmask_b32_e64 v102, v11, v10, s[68:69]
    s_mov_b32 s70, 0xf8000000
    s_mov_b32 s71, 0x80000000
    v_cndmask_b32_e64 v103, v11, v10, s[70:71]
    s_waitcnt vmcnt(8) lgkmcnt(0)
    v_mfma_f32_32x32x8bf16_1k v[16:31], v[132:133], v[120:121], 0
    v_mfma_f32_32x32x8bf16_1k v[32:47], v[132:133], v[126:127], 0
    s_cmp_eq_u32 s53, 0
    s_cbranch_scc1 L_t0_1
L_t0b_1:
    v_mfma_f32_32x32x16_bf16 v[16:31], v[128:131], v[116:119], v[16:31]
    v_mfma_f32_32x32x16_bf16 v[32:47], v[128:131], v[122:125], v[32:47]
    s_nop 10
    v_max3_f32 v12, v16, v17, v18
    v_max3_f32 v10, v19, v20, v21
    v_max3_f32 v11, v32, v33, v34
    v_max3_f32 v55, v35, v36, v37
    v_max3_f32 v12, v12, v22, v23
    v_max3_f32 v10, v10, v24, v25
    v_max3_f32 v11, v11, v38, v39
    v_max3_f32 v55, v55, v40, v41
    v_max3_f32 v12, v12, v26, v27
    v_max3_f32 v10, v10, v28, v29
    v_max3_f32 v11, v11, v42, v43
    v_max3_f32 v55, v55, v44, v45
    v_max3_f32 v12, v12, v30, v31
    v_max3_f32 v11, v11, v46, v47
    v_max_f32 v12, v12, v10
    v_max_f32 v11, v11, v55
    v_mov_b32 v10, v12
    v_mov_b32 v55, v11
    s_nop 0
    v_permlane32_swap_b32 v10, v12
    v_permlane32_swap_b32 v55, v11
    v_max_f32 v12, v12, v10
    v_max_f32 v11, v11, v55
    v_sub_f32 v12, 0xc2b00000, v12
    v_sub_f32 v11, 0xc2b00000, v11
    v_cvt_pk_bf16_f32 v12, v12, v15
    v_cvt_pk_bf16_f32 v11, v11, v15
    v_cndmask_b32_e64 v120, v12, v120, s[62:63]
    v_cndmask_b32_e64 v126, v11, v126, s[62:63]
    s_waitcnt vmcnt(6)
    s_nop 0
    v_mfma_f32_32x32x8bf16_1k v[32:47], v[238:239], v[126:127], v[88:103]
    v_mfma_f32_32x32x16_bf16 v[32:47], v[234:237], v[122:125], v[32:47]
    buffer_load_dwordx4 v[150:153], v2, s[32:35], s58 offen sc1
    s_mov_b64 exec, s[62:63]
    buffer_load_dwordx2 v[154:155], v3, s[32:35], s58 offen offset:2304 sc1
    s_mov_b64 exec, s[64:65]
    buffer_load_dwordx4 v[156:159], v4, s[32:35], s58 offen offset:1024 sc1
    buffer_load_dwordx4 v[160:163], v5, s[32:35], s58 offen offset:1024 sc1
    s_mov_b64 exec, -1
    s_setprio 3
    s_waitcnt vmcnt(6)
    v_mfma_f32_32x32x8bf16_1k v[16:31], v[140:141], v[120:121], v[88:103]
    s_nop 1
    v_exp_f32 v32, v32
    v_exp_f32 v33, v33
    v_exp_f32 v34, v34
    v_exp_f32 v35, v35
    v_exp_f32 v36, v36
    v_exp_f32 v37, v37
    v_exp_f32 v38, v38
    v_exp_f32 v39, v39
    v_cvt_pk_bf16_f32 v48, v32, v33
    v_cvt_pk_bf16_f32 v49, v34, v35
    v_cvt_pk_bf16_f32 v50, v36, v37
    v_cvt_pk_bf16_f32 v51, v38, v39
    v_mfma_f32_32x32x16_bf16 v[16:31], v[136:139], v[116:119], v[16:31]
    s_mov_b32 s29, 0xffff
    s_mov_b32 s28, -1
    s_andn2_b64 s[28:29], s[28:29], s[66:67]
    s_cbranch_scc0 L_nop3
    s_mov_b64 exec, s[28:29]
    buffer_load_dwordx2 v[8:9], v6, s[32:35], 0 offen sc1
    s_mov_b64 exec, -1
L_nop3:
    v_exp_f32 v40, v40
    v_exp_f32 v41, v41
    v_exp_f32 v42, v42
    v_exp_f32 v43, v43
    v_exp_f32 v44, v44
    v_mfma_f32_32x32x16_bf16 v[56:71], v[240:243], v[48:51], 0
    v_lshrrev_b32 v254, 4, v1
    v_and_b32 v255, 15, v1
    v_lshrrev_b32 v0, 5, v1
    v_and_b32 v12, 1, v254
    v_mul_u32_u24 v252, 2560, v255
    v_lshl_add_u32 v253, v254, 3, v252
    v_lshl_add_u32 v252, v12, 5, v252
    v_lshl_add_u32 v252, v0, 4, v252
    v_lshrrev_b32 v10, 2, v255
    s_and_b32 s24, s3, 1
    s_lshl_b32 s24, s24, 4
    v_exp_f32 v45, v45
    v_exp_f32 v46, v46
    v_exp_f32 v47, v47
    v_cvt_pk_bf16_f32 v52, v40, v41
    v_cvt_pk_bf16_f32 v53, v42, v43
    v_cvt_pk_bf16_f32 v54, v44, v45
    v_cvt_pk_bf16_f32 v55, v46, v47
    v_mfma_f32_32x32x8bf16_1k v[32:47], v[140:141], v[126:127], 0
    v_exp_f32 v16, v16
    v_exp_f32 v17, v17
    v_exp_f32 v18, v18
    v_exp_f32 v19, v19
    v_exp_f32 v20, v20
    v_mfma_f32_32x32x16_bf16 v[56:71], v[244:247], v[52:55], v[56:71]
    v_exp_f32 v21, v21
    v_exp_f32 v22, v22
    v_exp_f32 v23, v23
    v_cvt_pk_bf16_f32 v48, v16, v17
    v_cvt_pk_bf16_f32 v49, v18, v19
    v_cvt_pk_bf16_f32 v50, v20, v21
    v_cvt_pk_bf16_f32 v51, v22, v23
    v_mfma_f32_32x32x16_bf16 v[32:47], v[136:139], v[122:125], v[32:47]
    buffer_load_dwordx4 v[164:167], v2, s[32:35], s59 offen sc1
    s_mov_b64 exec, s[62:63]
    buffer_load_dwordx2 v[168:169], v3, s[32:35], s59 offen offset:2304 sc1
    s_mov_b64 exec, s[64:65]
    buffer_load_dwordx4 v[170:173], v4, s[32:35], s59 offen offset:1024 sc1
    buffer_load_dwordx4 v[174:177], v5, s[32:35], s59 offen offset:1024 sc1
    s_mov_b64 exec, -1
    v_exp_f32 v24, v24
    v_exp_f32 v25, v25
    v_exp_f32 v26, v26
    v_exp_f32 v27, v27
    v_exp_f32 v28, v28
    s_waitcnt vmcnt(8)
    v_mfma_f32_32x32x16_bf16 v[72:87], v[142:145], v[48:51], 0
    v_add_u32 v255, s24, v255
    v_mul_u32_u24 v248, 1280, v0
    v_lshl_add_u32 v248, v12, 9, v248
    v_lshl_add_u32 v248, v255, 4, v248
    v_mul_u32_u24 v249, 1280, v254
    v_lshl_add_u32 v249, v255, 3, v249
    s_mul_i32 s24, s44, 320
    v_add_u32 v10, s24, v10
    v_mul_u32_u24 v250, 20, v0
    v_lshl_add_u32 v250, v12, 2, v250
    v_add_u32 v250, v250, v10
    v_exp_f32 v29, v29
    v_exp_f32 v30, v30
    v_exp_f32 v31, v31
    v_cvt_pk_bf16_f32 v52, v24, v25
    v_cvt_pk_bf16_f32 v53, v26, v27
    v_cvt_pk_bf16_f32 v54, v28, v29
    v_cvt_pk_bf16_f32 v55, v30, v31
    s_setprio 2
    s_waitcnt vmcnt(6)
    v_mfma_f32_32x32x8bf16_1k v[16:31], v[154:155], v[120:121], 0
    v_exp_f32 v32, v32
    v_exp_f32 v33, v33
    v_exp_f32 v34, v34
    v_exp_f32 v35, v35
    v_exp_f32 v36, v36
    v_mfma_f32_32x32x16_bf16 v[72:87], v[146:149], v[52:55], v[72:87]
    v_exp_f32 v37, v37
    v_exp_f32 v38, v38
    v_exp_f32 v39, v39
    v_cvt_pk_bf16_f32 v48, v32, v33
    v_cvt_pk_bf16_f32 v49, v34, v35
    v_cvt_pk_bf16_f32 v50, v36, v37
    v_cvt_pk_bf16_f32 v51, v38, v39
    v_mfma_f32_32x32x16_bf16 v[16:31], v[150:153], v[116:119], v[16:31]
    v_exp_f32 v40, v40
    v_exp_f32 v41, v41
    v_exp_f32 v42, v42
    v_exp_f32 v43, v43
    v_exp_f32 v44, v44
    v_mfma_f32_32x32x16_bf16 v[56:71], v[142:145], v[48:51], v[56:71]
    v_mul_u32_u24 v251, 20, v254
    v_add3_u32 v251, v251, v10, 16
    v_and_b32 v10, 3, v1
    v_lshlrev_b32 v10, 3, v10
    v_mul_u32_u24 v250, 160, v250
    v_mul_u32_u24 v251, 160, v251
    v_add_u32 v250, v250, v10
    v_add_u32 v251, v251, v10
    v_exp_f32 v45, v45
    v_exp_f32 v46, v46
    v_exp_f32 v47, v47
    v_cvt_pk_bf16_f32 v52, v40, v41
    v_cvt_pk_bf16_f32 v53, v42, v43
    v_cvt_pk_bf16_f32 v54, v44, v45
    v_cvt_pk_bf16_f32 v55, v46, v47
    v_mfma_f32_32x32x8bf16_1k v[32:47], v[154:155], v[126:127], 0
    v_exp_f32 v16, v16
    v_exp_f32 v17, v17
    v_exp_f32 v18, v18
    v_exp_f32 v19, v19
    v_exp_f32 v20, v20
    v_mfma_f32_32x32x16_bf16 v[56:71], v[146:149], v[52:55], v[56:71]
    v_exp_f32 v21, v21
    v_exp_f32 v22, v22
    v_exp_f32 v23, v23
    v_cvt_pk_bf16_f32 v48, v16, v17
    v_cvt_pk_bf16_f32 v49, v18, v19
    v_cvt_pk_bf16_f32 v50, v20, v21
    v_cvt_pk_bf16_f32 v51, v22, v23
    v_mfma_f32_32x32x16_bf16 v[32:47], v[150:153], v[122:125], v[32:47]
    s_waitcnt vmcnt(4)
    s_mov_b64 exec, s[28:29]
    v_subrev_co_u32 v8, vcc, s38, v8
    s_nop 1
    v_subb_co_u32 v9, vcc, v9, v7, vcc
    v_cmp_eq_u32 vcc, 0, v9
    s_or_b64 s[66:67], s[66:67], vcc
    s_mov_b64 exec, -1
    s_lshl_b32 s68, 0x10001, s50
    s_lshl_b32 s7, 0x10001, s5
    s_or_b32 s68, s68, s7
    s_mov_b32 s69, 0x8000
    s_andn2_b64 s[70:71], s[68:69], s[66:67]
    s_cbranch_scc1 L_pw5
L_pb5:
    buffer_load_dwordx4 v[178:181], v2, s[32:35], s60 offen sc1
    s_mov_b64 exec, s[62:63]
    buffer_load_dwordx2 v[182:183], v3, s[32:35], s60 offen offset:2304 sc1
    s_mov_b64 exec, s[64:65]
    buffer_load_dwordx4 v[184:187], v4, s[32:35], s60 offen offset:1024 sc1
    buffer_load_dwordx4 v[188:191], v5, s[32:35], s60 offen offset:1024 sc1
    s_mov_b64 exec, -1
    s_mul_i32 s7, s5, 10240
    s_add_u32 s7, s7, s46
    buffer_load_dwordx4 v[128:131], v2, s[32:35], s7 offen sc1
    s_mov_b64 exec, s[62:63]
    buffer_load_dwordx2 v[132:133], v3, s[32:35], s7 offen offset:2304 sc1
    s_mov_b64 exec, -1
    s_mul_i32 s48, s50, 10240
    s_add_u32 s48, s48, s46
    buffer_load_dwordx4 v[192:195], v2, s[32:35], s48 offen sc1
    s_mov_b64 exec, s[62:63]
    buffer_load_dwordx2 v[196:197], v3, s[32:35], s48 offen offset:2304 sc1
    s_mov_b64 exec, -1
    v_exp_f32 v24, v24
    v_exp_f32 v25, v25
    v_exp_f32 v26, v26
    v_exp_f32 v27, v27
    v_exp_f32 v28, v28
    v_mfma_f32_32x32x16_bf16 v[72:87], v[156:159], v[48:51], v[72:87]
    v_exp_f32 v29, v29
    v_exp_f32 v30, v30
    v_exp_f32 v31, v31
    v_cvt_pk_bf16_f32 v52, v24, v25
    v_cvt_pk_bf16_f32 v53, v26, v27
    v_cvt_pk_bf16_f32 v54, v28, v29
    v_cvt_pk_bf16_f32 v55, v30, v31
    s_setprio 1
    s_waitcnt vmcnt(10)
    v_mfma_f32_32x32x8bf16_1k v[16:31], v[168:169], v[120:121], 0
    v_exp_f32 v32, v32
    v_exp_f32 v33, v33
    v_exp_f32 v34, v34
    v_exp_f32 v35, v35
    v_exp_f32 v36, v36
    v_mfma_f32_32x32x16_bf16 v[72:87], v[160:163], v[52:55], v[72:87]
    v_exp_f32 v37, v37
    v_exp_f32 v38, v38
    v_exp_f32 v39, v39
    v_cvt_pk_bf16_f32 v48, v32, v33
    v_cvt_pk_bf16_f32 v49, v34, v35
    v_cvt_pk_bf16_f32 v50, v36, v37
    v_cvt_pk_bf16_f32 v51, v38, v39
    v_mfma_f32_32x32x16_bf16 v[16:31], v[164:167], v[116:119], v[16:31]
    s_xor_b32 s7, s44, 1
    s_mul_i32 s7, s7, 5120
    s_add_u32 s7, s7, s47
    buffer_load_dwordx4 v[104:107], v2, s[32:35], s7 offen sc1
    s_mov_b64 exec, s[62:63]
    buffer_load_dwordx2 v[108:109], v3, s[32:35], s7 offen offset:1024 sc1
    s_mov_b64 exec, -1
    s_or_b32 s7, s44, 0
    s_mul_i32 s7, s7, 5120
    s_add_u32 s7, s7, s47
    buffer_load_dwordx4 v[110:113], v2, s[32:35], s7 offen sc1
    s_mov_b64 exec, s[62:63]
    buffer_load_dwordx2 v[114:115], v3, s[32:35], s7 offen offset:1024 sc1
    s_mov_b64 exec, -1
    v_exp_f32 v40, v40
    v_exp_f32 v41, v41
    v_exp_f32 v42, v42
    v_exp_f32 v43, v43
    v_exp_f32 v44, v44
    v_mfma_f32_32x32x16_bf16 v[56:71], v[156:159], v[48:51], v[56:71]
    v_exp_f32 v45, v45
    v_exp_f32 v46, v46
    v_exp_f32 v47, v47
    v_cvt_pk_bf16_f32 v52, v40, v41
    v_cvt_pk_bf16_f32 v53, v42, v43
    v_cvt_pk_bf16_f32 v54, v44, v45
    v_cvt_pk_bf16_f32 v55, v46, v47
    v_mfma_f32_32x32x8bf16_1k v[32:47], v[168:169], v[126:127], 0
    v_exp_f32 v16, v16
    v_exp_f32 v17, v17
    v_exp_f32 v18, v18
    v_exp_f32 v19, v19
    v_exp_f32 v20, v20
    v_mfma_f32_32x32x16_bf16 v[56:71], v[160:163], v[52:55], v[56:71]
    v_exp_f32 v21, v21
    v_exp_f32 v22, v22
    v_exp_f32 v23, v23
    v_cvt_pk_bf16_f32 v48, v16, v17
    v_cvt_pk_bf16_f32 v49, v18, v19
    v_cvt_pk_bf16_f32 v50, v20, v21
    v_cvt_pk_bf16_f32 v51, v22, v23
    v_mfma_f32_32x32x16_bf16 v[32:47], v[164:167], v[122:125], v[32:47]
    s_add_u32 s49, s48, 2560
    buffer_load_dwordx4 v[206:209], v2, s[32:35], s49 offen sc1
    s_mov_b64 exec, s[62:63]
    buffer_load_dwordx2 v[210:211], v3, s[32:35], s49 offen offset:2304 sc1
    s_mov_b64 exec, s[64:65]
    buffer_load_dwordx4 v[198:201], v4, s[32:35], s48 offen offset:1024 sc1
    buffer_load_dwordx4 v[202:205], v5, s[32:35], s48 offen offset:1024 sc1
    s_mov_b64 exec, -1
    v_exp_f32 v24, v24
    v_exp_f32 v25, v25
    v_exp_f32 v26, v26
    v_exp_f32 v27, v27
    v_exp_f32 v28, v28
    s_waitcnt vmcnt(16)
    v_mfma_f32_32x32x16_bf16 v[72:87], v[170:173], v[48:51], v[72:87]
    v_exp_f32 v29, v29
    v_exp_f32 v30, v30
    v_exp_f32 v31, v31
    v_cvt_pk_bf16_f32 v52, v24, v25
    v_cvt_pk_bf16_f32 v53, v26, v27
    v_cvt_pk_bf16_f32 v54, v28, v29
    v_cvt_pk_bf16_f32 v55, v30, v31
    s_setprio 0
    s_waitcnt vmcnt(14)
    v_mfma_f32_32x32x8bf16_1k v[16:31], v[182:183], v[120:121], 0
    v_exp_f32 v32, v32
    v_exp_f32 v33, v33
    v_exp_f32 v34, v34
    v_exp_f32 v35, v35
    v_exp_f32 v36, v36
    v_mfma_f32_32x32x16_bf16 v[72:87], v[174:177], v[52:55], v[72:87]
    v_exp_f32 v37, v37
    v_exp_f32 v38, v38
    v_exp_f32 v39, v39
    v_cvt_pk_bf16_f32 v48, v32, v33
    v_cvt_pk_bf16_f32 v49, v34, v35
    v_cvt_pk_bf16_f32 v50, v36, v37
    v_cvt_pk_bf16_f32 v51, v38, v39
    v_mfma_f32_32x32x16_bf16 v[16:31], v[178:181], v[116:119], v[16:31]
    s_add_u32 s48, s49, 2560
    buffer_load_dwordx4 v[220:223], v2, s[32:35], s48 offen sc1
    s_mov_b64 exec, s[62:63]
    buffer_load_dwordx2 v[224:225], v3, s[32:35], s48 offen offset:2304 sc1
    s_mov_b64 exec, s[64:65]
    buffer_load_dwordx4 v[212:215], v4, s[32:35], s49 offen offset:1024 sc1
    buffer_load_dwordx4 v[216:219], v5, s[32:35], s49 offen offset:1024 sc1
    s_mov_b64 exec, -1
    v_exp_f32 v40, v40
    v_exp_f32 v41, v41
    v_exp_f32 v42, v42
    v_exp_f32 v43, v43
    v_exp_f32 v44, v44
    v_mfma_f32_32x32x16_bf16 v[56:71], v[170:173], v[48:51], v[56:71]
    v_exp_f32 v45, v45
    v_exp_f32 v46, v46
    v_exp_f32 v47, v47
    v_cvt_pk_bf16_f32 v52, v40, v41
    v_cvt_pk_bf16_f32 v53, v42, v43
    v_cvt_pk_bf16_f32 v54, v44, v45
    v_cvt_pk_bf16_f32 v55, v46, v47
    v_mfma_f32_32x32x8bf16_1k v[32:47], v[182:183], v[126:127], 0
    v_exp_f32 v16, v16
    v_exp_f32 v17, v17
    v_exp_f32 v18, v18
    v_exp_f32 v19, v19
    v_exp_f32 v20, v20
    v_mfma_f32_32x32x16_bf16 v[56:71], v[174:177], v[52:55], v[56:71]
    v_exp_f32 v21, v21
    v_exp_f32 v22, v22
    v_exp_f32 v23, v23
    v_cvt_pk_bf16_f32 v48, v16, v17
    v_cvt_pk_bf16_f32 v49, v18, v19
    v_cvt_pk_bf16_f32 v50, v20, v21
    v_cvt_pk_bf16_f32 v51, v22, v23
    v_mfma_f32_32x32x16_bf16 v[32:47], v[178:181], v[122:125], v[32:47]
    s_add_u32 s49, s48, 2560
    buffer_load_dwordx4 v[234:237], v2, s[32:35], s49 offen sc1
    s_mov_b64 exec, s[62:63]
    buffer_load_dwordx2 v[238:239], v3, s[32:35], s49 offen offset:2304 sc1
    s_mov_b64 exec, s[64:65]
    buffer_load_dwordx4 v[226:229], v4, s[32:35], s48 offen offset:1024 sc1
    buffer_load_dwordx4 v[230:233], v5, s[32:35], s48 offen offset:1024 sc1
    s_mov_b64 exec, -1
    v_exp_f32 v24, v24
    v_exp_f32 v25, v25
    v_exp_f32 v26, v26
    v_exp_f32 v27, v27
    v_exp_f32 v28, v28
    s_waitcnt vmcnt(20)
    v_mfma_f32_32x32x16_bf16 v[72:87], v[184:187], v[48:51], v[72:87]
    v_exp_f32 v29, v29
    v_exp_f32 v30, v30
    v_exp_f32 v31, v31
    v_cvt_pk_bf16_f32 v52, v24, v25
    v_cvt_pk_bf16_f32 v53, v26, v27
    v_cvt_pk_bf16_f32 v54, v28, v29
    v_cvt_pk_bf16_f32 v55, v30, v31
    v_exp_f32 v32, v32
    v_exp_f32 v33, v33
    v_exp_f32 v34, v34
    v_exp_f32 v35, v35
    v_exp_f32 v36, v36
    v_mfma_f32_32x32x16_bf16 v[72:87], v[188:191], v[52:55], v[72:87]
    v_exp_f32 v37, v37
    v_exp_f32 v38, v38
    v_exp_f32 v39, v39
    v_cvt_pk_bf16_f32 v48, v32, v33
    v_cvt_pk_bf16_f32 v49, v34, v35
    v_cvt_pk_bf16_f32 v50, v36, v37
    v_cvt_pk_bf16_f32 v51, v38, v39
    v_exp_f32 v40, v40
    v_exp_f32 v41, v41
    v_exp_f32 v42, v42
    v_exp_f32 v43, v43
    v_exp_f32 v44, v44
    v_mfma_f32_32x32x16_bf16 v[56:71], v[184:187], v[48:51], v[56:71]
    v_exp_f32 v45, v45
    v_exp_f32 v46, v46
    v_exp_f32 v47, v47
    v_cvt_pk_bf16_f32 v52, v40, v41
    v_cvt_pk_bf16_f32 v53, v42, v43
    v_cvt_pk_bf16_f32 v54, v44, v45
    v_cvt_pk_bf16_f32 v55, v46, v47
    s_nop 1
    v_mfma_f32_32x32x16_bf16 v[56:71], v[188:191], v[52:55], v[56:71]
    s_setprio 3
    ds_write_b128 v14, v[72:75] offset:0
    ds_write_b128 v14, v[76:79] offset:1024
    ds_write_b128 v14, v[80:83] offset:2048
    s_waitcnt vmcnt(12)
    v_max3_u32 v10, v104, v105, v106
    v_max3_u32 v11, v107, v108, v109
    v_max3_u32 v10, v10, v110, v111
    v_max3_u32 v11, v11, v112, v113
    v_max3_u32 v10, v10, v114, v115
    v_max_u32 v10, v10, v11
    v_cmp_eq_u32 vcc, -1, v10
    s_cmp_lg_u64 vcc, 0
    s_cbranch_scc1 L_qw0
L_qb0:
    v_mfma_f32_32x32x8bf16_1k v[16:31], v[132:133], v[108:109], 0
    v_mfma_f32_32x32x8bf16_1k v[32:47], v[132:133], v[114:115], 0
    v_mfma_f32_32x32x16_bf16 v[16:31], v[128:131], v[104:107], v[16:31]
    v_mfma_f32_32x32x16_bf16 v[32:47], v[128:131], v[110:113], v[32:47]
    s_waitcnt lgkmcnt(0)
    s_barrier
    ds_read_b128 v[72:75], v134 offset:0
    ds_read_b128 v[76:79], v134 offset:1024
    ds_read_b128 v[80:83], v134 offset:2048
    s_nop 5
    v_max3_f32 v12, v16, v17, v18
    v_max3_f32 v10, v19, v20, v21
    v_max3_f32 v11, v32, v33, v34
    v_max3_f32 v55, v35, v36, v37
    v_max3_f32 v12, v12, v22, v23
    v_max3_f32 v10, v10, v24, v25
    v_max3_f32 v11, v11, v38, v39
    v_max3_f32 v55, v55, v40, v41
    v_max3_f32 v12, v12, v26, v27
    v_max3_f32 v10, v10, v28, v29
    v_max3_f32 v11, v11, v42, v43
    v_max3_f32 v55, v55, v44, v45
    v_max3_f32 v12, v12, v30, v31
    v_max3_f32 v11, v11, v46, v47
    v_max_f32 v12, v12, v10
    v_max_f32 v11, v11, v55
    v_mov_b32 v10, v12
    v_mov_b32 v55, v11
    s_nop 0
    v_permlane32_swap_b32 v10, v12
    v_permlane32_swap_b32 v55, v11
    v_max_f32 v12, v12, v10
    v_max_f32 v11, v11, v55
    v_sub_f32 v12, 0xc2b00000, v12
    v_sub_f32 v11, 0xc2b00000, v11
    v_cvt_pk_bf16_f32 v12, v12, 0
    v_cvt_pk_bf16_f32 v11, v11, 0
    v_cndmask_b32_e64 v108, v12, v108, s[62:63]
    v_cndmask_b32_e64 v114, v11, v114, s[62:63]
    s_waitcnt lgkmcnt(0)
    v_pk_add_f32 v[64:65], v[64:65], v[80:81]
    v_pk_add_f32 v[66:67], v[66:67], v[82:83]
    v_cmp_lt_f32 vcc, 0x0d800000, v64
    s_mov_b32 s7, vcc_hi
    v_cmp_gt_f32 vcc, 0x71800000, v64
    s_and_b32 s7, s7, vcc_hi
    v_pk_add_f32 v[56:57], v[56:57], v[72:73]
    v_pk_add_f32 v[58:59], v[58:59], v[74:75]
    v_pk_add_f32 v[60:61], v[60:61], v[76:77]
    v_pk_add_f32 v[62:63], v[62:63], v[78:79]
    s_mov_b32 s100, 2
    s_cmp_eq_u32 s7, -1
    s_cbranch_scc0 L_fb
L_ret2:
    v_mov_b32 v10, v64
    v_mov_b32 v11, v64
    v_mfma_f32_32x32x8bf16_1k v[16:31], v[196:197], v[108:109], 0
    s_nop 0
    v_permlane32_swap_b32 v10, v11
    v_rcp_f32 v11, v11
    v_mfma_f32_32x32x16_bf16 v[16:31], v[192:195], v[104:107], v[16:31]
    v_mul_f32 v56, v11, v56
    v_mul_f32 v57, v11, v57
    v_mul_f32 v58, v11, v58
    v_mul_f32 v59, v11, v59
    v_mul_f32 v60, v11, v60
    v_mul_f32 v61, v11, v61
    v_mul_f32 v62, v11, v62
    v_mul_f32 v63, v11, v63
    v_mul_f32 v64, v11, v64
    v_mul_f32 v65, v11, v65
    v_mul_f32 v66, v11, v66
    v_mul_f32 v67, v11, v67
    v_cvt_pk_bf16_f32 v72, v56, v57
    v_cvt_pk_bf16_f32 v73, v58, v59
    v_cvt_pk_bf16_f32 v74, v60, v61
    v_cvt_pk_bf16_f32 v75, v62, v63
    v_cvt_pk_bf16_f32 v76, v64, v65
    v_cvt_pk_bf16_f32 v77, v66, v67
    s_add_u32 s7, s16, 2621440
    buffer_store_dwordx4 v[72:75], v2, s[32:35], s7 offen sc1
    s_mov_b64 exec, s[62:63]
    buffer_store_dwordx2 v[76:77], v3, s[32:35], s7 offen offset:1024 sc1
    s_mov_b64 exec, -1
    s_setprio 2
    s_lshr_b32 s26, s26, 4
    s_and_b32 s50, s26, 15
    s_lshl_b32 s68, 0x10001, s50
    s_mov_b32 s69, 0
    s_andn2_b64 s[70:71], s[68:69], s[66:67]
    s_cbranch_scc1 L_pw6
L_pb6:
    v_mfma_f32_32x32x8bf16_1k v[32:47], v[196:197], v[114:115], 0
    v_exp_f32 v16, v16
    v_exp_f32 v17, v17
    v_exp_f32 v18, v18
    v_exp_f32 v19, v19
    v_exp_f32 v20, v20
    v_exp_f32 v21, v21
    v_exp_f32 v22, v22
    v_exp_f32 v23, v23
    v_cvt_pk_bf16_f32 v48, v16, v17
    v_cvt_pk_bf16_f32 v49, v18, v19
    v_cvt_pk_bf16_f32 v50, v20, v21
    v_cvt_pk_bf16_f32 v51, v22, v23
    v_mfma_f32_32x32x16_bf16 v[32:47], v[192:195], v[110:113], v[32:47]
    s_mul_i32 s48, s50, 10240
    s_add_u32 s48, s48, s46
    buffer_load_dwordx4 v[192:195], v2, s[32:35], s48 offen sc1
    s_mov_b64 exec, s[62:63]
    buffer_load_dwordx2 v[196:197], v3, s[32:35], s48 offen offset:2304 sc1
    s_mov_b64 exec, s[64:65]
    buffer_load_dwordx4 v[240:243], v4, s[32:35], s49 offen offset:1024 sc1
    buffer_load_dwordx4 v[244:247], v5, s[32:35], s49 offen offset:1024 sc1
    s_mov_b64 exec, -1
    v_exp_f32 v24, v24
    v_exp_f32 v25, v25
    v_exp_f32 v26, v26
    v_exp_f32 v27, v27
    v_exp_f32 v28, v28
    s_waitcnt vmcnt(14)
    v_mfma_f32_32x32x16_bf16 v[72:87], v[198:201], v[48:51], 0
    v_exp_f32 v29, v29
    v_exp_f32 v30, v30
    v_exp_f32 v31, v31
    v_cvt_pk_bf16_f32 v52, v24, v25
    v_cvt_pk_bf16_f32 v53, v26, v27
    v_cvt_pk_bf16_f32 v54, v28, v29
    v_cvt_pk_bf16_f32 v55, v30, v31
    s_setprio 2
    v_mfma_f32_32x32x8bf16_1k v[16:31], v[210:211], v[108:109], 0
    v_exp_f32 v32, v32
    v_exp_f32 v33, v33
    v_exp_f32 v34, v34
    v_exp_f32 v35, v35
    v_exp_f32 v36, v36
    v_mfma_f32_32x32x16_bf16 v[72:87], v[202:205], v[52:55], v[72:87]
    v_exp_f32 v37, v37
    v_exp_f32 v38, v38
    v_exp_f32 v39, v39
    v_cvt_pk_bf16_f32 v48, v32, v33
    v_cvt_pk_bf16_f32 v49, v34, v35
    v_cvt_pk_bf16_f32 v50, v36, v37
    v_cvt_pk_bf16_f32 v51, v38, v39
    v_mfma_f32_32x32x16_bf16 v[16:31], v[206:209], v[104:107], v[16:31]
    s_mov_b32 s29, 0xffff
    s_mov_b32 s28, -1
    s_andn2_b64 s[28:29], s[28:29], s[66:67]
    s_cbranch_scc0 L_nop4
    s_mov_b64 exec, s[28:29]
    buffer_load_dwordx2 v[8:9], v6, s[32:35], 0 offen sc1
    s_mov_b64 exec, -1
L_nop4:
    v_exp_f32 v40, v40
    v_exp_f32 v41, v41
    v_exp_f32 v42, v42
    v_exp_f32 v43, v43
    v_exp_f32 v44, v44
    v_mfma_f32_32x32x16_bf16 v[56:71], v[198:201], v[48:51], 0
    v_exp_f32 v45, v45
    v_exp_f32 v46, v46
    v_exp_f32 v47, v47
    v_cvt_pk_bf16_f32 v52, v40, v41
    v_cvt_pk_bf16_f32 v53, v42, v43
    v_cvt_pk_bf16_f32 v54, v44, v45
    v_cvt_pk_bf16_f32 v55, v46, v47
    s_setprio 1
    v_mfma_f32_32x32x8bf16_1k v[32:47], v[210:211], v[114:115], 0
    v_exp_f32 v16, v16
    v_exp_f32 v17, v17
    v_exp_f32 v18, v18
    v_exp_f32 v19, v19
    v_exp_f32 v20, v20
    v_mfma_f32_32x32x16_bf16 v[56:71], v[202:205], v[52:55], v[56:71]
    v_exp_f32 v21, v21
    v_exp_f32 v22, v22
    v_exp_f32 v23, v23
    v_cvt_pk_bf16_f32 v48, v16, v17
    v_cvt_pk_bf16_f32 v49, v18, v19
    v_cvt_pk_bf16_f32 v50, v20, v21
    v_cvt_pk_bf16_f32 v51, v22, v23
    v_mfma_f32_32x32x16_bf16 v[32:47], v[206:209], v[110:113], v[32:47]
    s_add_u32 s49, s48, 2560
    buffer_load_dwordx4 v[206:209], v2, s[32:35], s49 offen sc1
    s_mov_b64 exec, s[62:63]
    buffer_load_dwordx2 v[210:211], v3, s[32:35], s49 offen offset:2304 sc1
    s_mov_b64 exec, s[64:65]
    buffer_load_dwordx4 v[198:201], v4, s[32:35], s48 offen offset:1024 sc1
    buffer_load_dwordx4 v[202:205], v5, s[32:35], s48 offen offset:1024 sc1
    s_mov_b64 exec, -1
    v_exp_f32 v24, v24
    v_exp_f32 v25, v25
    v_exp_f32 v26, v26
    v_exp_f32 v27, v27
    v_exp_f32 v28, v28
    s_waitcnt vmcnt(14)
    v_mfma_f32_32x32x16_bf16 v[72:87], v[212:215], v[48:51], v[72:87]
    v_exp_f32 v29, v29
    v_exp_f32 v30, v30
    v_exp_f32 v31, v31
    v_cvt_pk_bf16_f32 v52, v24, v25
    v_cvt_pk_bf16_f32 v53, v26, v27
    v_cvt_pk_bf16_f32 v54, v28, v29
    v_cvt_pk_bf16_f32 v55, v30, v31
    s_setprio 0
    v_mfma_f32_32x32x8bf16_1k v[16:31], v[224:225], v[108:109], 0
    v_exp_f32 v32, v32
    v_exp_f32 v33, v33
    v_exp_f32 v34, v34
    v_exp_f32 v35, v35
    v_exp_f32 v36, v36
    v_mfma_f32_32x32x16_bf16 v[72:87], v[216:219], v[52:55], v[72:87]
    v_exp_f32 v37, v37
    v_exp_f32 v38, v38
    v_exp_f32 v39, v39
    v_cvt_pk_bf16_f32 v48, v32, v33
    v_cvt_pk_bf16_f32 v49, v34, v35
    v_cvt_pk_bf16_f32 v50, v36, v37
    v_cvt_pk_bf16_f32 v51, v38, v39
    v_mfma_f32_32x32x16_bf16 v[16:31], v[220:223], v[104:107], v[16:31]
    buffer_load_dwordx4 v13, s[8:11], s51 offen lds
    s_add_u32 m0, m0, 6400
    s_add_u32 s51, s51, 51200
    v_exp_f32 v40, v40
    v_exp_f32 v41, v41
    v_exp_f32 v42, v42
    v_exp_f32 v43, v43
    v_exp_f32 v44, v44
    v_mfma_f32_32x32x16_bf16 v[56:71], v[212:215], v[48:51], v[56:71]
    v_exp_f32 v45, v45
    v_exp_f32 v46, v46
    v_exp_f32 v47, v47
    v_cvt_pk_bf16_f32 v52, v40, v41
    v_cvt_pk_bf16_f32 v53, v42, v43
    v_cvt_pk_bf16_f32 v54, v44, v45
    v_cvt_pk_bf16_f32 v55, v46, v47
    s_setprio 3
    v_mfma_f32_32x32x8bf16_1k v[32:47], v[224:225], v[114:115], 0
    v_exp_f32 v16, v16
    v_exp_f32 v17, v17
    v_exp_f32 v18, v18
    v_exp_f32 v19, v19
    v_exp_f32 v20, v20
    v_mfma_f32_32x32x16_bf16 v[56:71], v[216:219], v[52:55], v[56:71]
    v_exp_f32 v21, v21
    v_exp_f32 v22, v22
    v_exp_f32 v23, v23
    v_cvt_pk_bf16_f32 v48, v16, v17
    v_cvt_pk_bf16_f32 v49, v18, v19
    v_cvt_pk_bf16_f32 v50, v20, v21
    v_cvt_pk_bf16_f32 v51, v22, v23
    v_mfma_f32_32x32x16_bf16 v[32:47], v[220:223], v[110:113], v[32:47]
    s_add_u32 s48, s49, 2560
    buffer_load_dwordx4 v[220:223], v2, s[32:35], s48 offen sc1
    s_mov_b64 exec, s[62:63]
    buffer_load_dwordx2 v[224:225], v3, s[32:35], s48 offen offset:2304 sc1
    s_mov_b64 exec, s[64:65]
    buffer_load_dwordx4 v[212:215], v4, s[32:35], s49 offen offset:1024 sc1
    buffer_load_dwordx4 v[216:219], v5, s[32:35], s49 offen offset:1024 sc1
    s_mov_b64 exec, -1
    v_exp_f32 v24, v24
    v_exp_f32 v25, v25
    v_exp_f32 v26, v26
    v_exp_f32 v27, v27
    v_exp_f32 v28, v28
    s_waitcnt vmcnt(15)
    v_mfma_f32_32x32x16_bf16 v[72:87], v[226:229], v[48:51], v[72:87]
    v_exp_f32 v29, v29
    v_exp_f32 v30, v30
    v_exp_f32 v31, v31
    v_cvt_pk_bf16_f32 v52, v24, v25
    v_cvt_pk_bf16_f32 v53, v26, v27
    v_cvt_pk_bf16_f32 v54, v28, v29
    v_cvt_pk_bf16_f32 v55, v30, v31
    s_setprio 2
    v_mfma_f32_32x32x8bf16_1k v[16:31], v[238:239], v[108:109], 0
    v_exp_f32 v32, v32
    v_exp_f32 v33, v33
    v_exp_f32 v34, v34
    v_exp_f32 v35, v35
    v_exp_f32 v36, v36
    v_mfma_f32_32x32x16_bf16 v[72:87], v[230:233], v[52:55], v[72:87]
    v_exp_f32 v37, v37
    v_exp_f32 v38, v38
    v_exp_f32 v39, v39
    v_cvt_pk_bf16_f32 v48, v32, v33
    v_cvt_pk_bf16_f32 v49, v34, v35
    v_cvt_pk_bf16_f32 v50, v36, v37
    v_cvt_pk_bf16_f32 v51, v38, v39
    v_mfma_f32_32x32x16_bf16 v[16:31], v[234:237], v[104:107], v[16:31]
    buffer_load_dwordx4 v13, s[8:11], s51 offen lds
    s_add_u32 m0, m0, 6400
    s_add_u32 s51, s51, 51200
    v_exp_f32 v40, v40
    v_exp_f32 v41, v41
    v_exp_f32 v42, v42
    v_exp_f32 v43, v43
    v_exp_f32 v44, v44
    v_mfma_f32_32x32x16_bf16 v[56:71], v[226:229], v[48:51], v[56:71]
    v_mov_b64 v[128:129], -1
    v_mov_b64 v[130:131], -1
    buffer_store_dwordx4 v[128:131], v2, s[32:35], s16 offen sc1
    s_mov_b64 exec, 0xffff
    buffer_store_dwordx4 v[128:131], v2, s[32:35], s16 offen offset:1024 sc1
    s_mov_b64 exec, -1
    v_exp_f32 v45, v45
    v_exp_f32 v46, v46
    v_exp_f32 v47, v47
    v_cvt_pk_bf16_f32 v52, v40, v41
    v_cvt_pk_bf16_f32 v53, v42, v43
    v_cvt_pk_bf16_f32 v54, v44, v45
    v_cvt_pk_bf16_f32 v55, v46, v47
    s_setprio 1
    v_mfma_f32_32x32x8bf16_1k v[32:47], v[238:239], v[114:115], 0
    v_exp_f32 v16, v16
    v_exp_f32 v17, v17
    v_exp_f32 v18, v18
    v_exp_f32 v19, v19
    v_exp_f32 v20, v20
    v_mfma_f32_32x32x16_bf16 v[56:71], v[230:233], v[52:55], v[56:71]
    v_exp_f32 v21, v21
    v_exp_f32 v22, v22
    v_exp_f32 v23, v23
    v_cvt_pk_bf16_f32 v48, v16, v17
    v_cvt_pk_bf16_f32 v49, v18, v19
    v_cvt_pk_bf16_f32 v50, v20, v21
    v_cvt_pk_bf16_f32 v51, v22, v23
    v_mfma_f32_32x32x16_bf16 v[32:47], v[234:237], v[110:113], v[32:47]
    s_add_u32 s49, s48, 2560
    buffer_load_dwordx4 v[234:237], v2, s[32:35], s49 offen sc1
    s_mov_b64 exec, s[62:63]
    buffer_load_dwordx2 v[238:239], v3, s[32:35], s49 offen offset:2304 sc1
    s_mov_b64 exec, s[64:65]
    buffer_load_dwordx4 v[226:229], v4, s[32:35], s48 offen offset:1024 sc1
    buffer_load_dwordx4 v[230:233], v5, s[32:35], s48 offen offset:1024 sc1
    s_mov_b64 exec, -1
    v_exp_f32 v24, v24
    v_exp_f32 v25, v25
    v_exp_f32 v26, v26
    v_exp_f32 v27, v27
    v_exp_f32 v28, v28
    s_waitcnt vmcnt(14)
    v_mfma_f32_32x32x16_bf16 v[72:87], v[240:243], v[48:51], v[72:87]
    v_exp_f32 v29, v29
    v_exp_f32 v30, v30
    v_exp_f32 v31, v31
    v_cvt_pk_bf16_f32 v52, v24, v25
    v_cvt_pk_bf16_f32 v53, v26, v27
    v_cvt_pk_bf16_f32 v54, v28, v29
    v_cvt_pk_bf16_f32 v55, v30, v31
    s_setprio 0
    v_mfma_f32_32x32x8bf16_1k v[16:31], v[196:197], v[108:109], 0
    v_exp_f32 v32, v32
    v_exp_f32 v33, v33
    v_exp_f32 v34, v34
    v_exp_f32 v35, v35
    v_exp_f32 v36, v36
    v_mfma_f32_32x32x16_bf16 v[72:87], v[244:247], v[52:55], v[72:87]
    v_exp_f32 v37, v37
    v_exp_f32 v38, v38
    v_exp_f32 v39, v39
    v_cvt_pk_bf16_f32 v48, v32, v33
    v_cvt_pk_bf16_f32 v49, v34, v35
    v_cvt_pk_bf16_f32 v50, v36, v37
    v_cvt_pk_bf16_f32 v51, v38, v39
    v_mfma_f32_32x32x16_bf16 v[16:31], v[192:195], v[104:107], v[16:31]
    v_exp_f32 v40, v40
    v_exp_f32 v41, v41
    v_exp_f32 v42, v42
    v_exp_f32 v43, v43
    v_exp_f32 v44, v44
    v_mfma_f32_32x32x16_bf16 v[56:71], v[240:243], v[48:51], v[56:71]
    v_exp_f32 v45, v45
    v_exp_f32 v46, v46
    v_exp_f32 v47, v47
    v_cvt_pk_bf16_f32 v52, v40, v41
    v_cvt_pk_bf16_f32 v53, v42, v43
    v_cvt_pk_bf16_f32 v54, v44, v45
    v_cvt_pk_bf16_f32 v55, v46, v47
    s_mov_b32 s54, 0
L_A1_loop:
    s_setprio 3
    s_waitcnt vmcnt(14)
    s_mov_b64 exec, s[28:29]
    v_subrev_co_u32 v8, vcc, s38, v8
    s_nop 1
    v_subb_co_u32 v9, vcc, v9, v7, vcc
    v_cmp_eq_u32 vcc, 0, v9
    s_or_b64 s[66:67], s[66:67], vcc
    s_mov_b64 exec, -1
    s_lshr_b32 s26, s26, 4
    s_and_b32 s50, s26, 15
    s_lshl_b32 s68, 0x10001, s50
    s_mov_b32 s69, 0
    s_andn2_b64 s[70:71], s[68:69], s[66:67]
    s_cbranch_scc1 L_pw7
L_pb7:
    v_mfma_f32_32x32x8bf16_1k v[32:47], v[196:197], v[114:115], 0
    v_exp_f32 v16, v16
    v_exp_f32 v17, v17
    v_exp_f32 v18, v18
    v_exp_f32 v19, v19
    v_exp_f32 v20, v20
    v_mfma_f32_32x32x16_bf16 v[56:71], v[244:247], v[52:55], v[56:71]
    v_exp_f32 v21, v21
    v_exp_f32 v22, v22
    v_exp_f32 v23, v23
    v_cvt_pk_bf16_f32 v48, v16, v17
    v_cvt_pk_bf16_f32 v49, v18, v19
    v_cvt_pk_bf16_f32 v50, v20, v21
    v_cvt_pk_bf16_f32 v51, v22, v23
    v_mfma_f32_32x32x16_bf16 v[32:47], v[192:195], v[110:113], v[32:47]
    s_mul_i32 s48, s50, 10240
    s_add_u32 s48, s48, s46
    buffer_load_dwordx4 v[192:195], v2, s[32:35], s48 offen sc1
    s_mov_b64 exec, s[62:63]
    buffer_load_dwordx2 v[196:197], v3, s[32:35], s48 offen offset:2304 sc1
    s_mov_b64 exec, s[64:65]
    buffer_load_dwordx4 v[240:243], v4, s[32:35], s49 offen offset:1024 sc1
    buffer_load_dwordx4 v[244:247], v5, s[32:35], s49 offen offset:1024 sc1
    s_mov_b64 exec, -1
    v_exp_f32 v24, v24
    v_exp_f32 v25, v25
    v_exp_f32 v26, v26
    v_exp_f32 v27, v27
    v_exp_f32 v28, v28
    s_waitcnt vmcnt(14)
    v_mfma_f32_32x32x16_bf16 v[72:87], v[198:201], v[48:51], v[72:87]
    v_exp_f32 v29, v29
    v_exp_f32 v30, v30
    v_exp_f32 v31, v31
    v_cvt_pk_bf16_f32 v52, v24, v25
    v_cvt_pk_bf16_f32 v53, v26, v27
    v_cvt_pk_bf16_f32 v54, v28, v29
    v_cvt_pk_bf16_f32 v55, v30, v31
    s_setprio 2
    v_mfma_f32_32x32x8bf16_1k v[16:31], v[210:211], v[108:109], 0
    v_exp_f32 v32, v32
    v_exp_f32 v33, v33
    v_exp_f32 v34, v34
    v_exp_f32 v35, v35
    v_exp_f32 v36, v36
    v_mfma_f32_32x32x16_bf16 v[72:87], v[202:205], v[52:55], v[72:87]
    v_exp_f32 v37, v37
    v_exp_f32 v38, v38
    v_exp_f32 v39, v39
    v_cvt_pk_bf16_f32 v48, v32, v33
    v_cvt_pk_bf16_f32 v49, v34, v35
    v_cvt_pk_bf16_f32 v50, v36, v37
    v_cvt_pk_bf16_f32 v51, v38, v39
    v_mfma_f32_32x32x16_bf16 v[16:31], v[206:209], v[104:107], v[16:31]
    s_cmp_ge_u32 s54, 4
    s_cselect_b32 s29, -1, 0xffff
    s_mov_b32 s28, -1
    s_andn2_b64 s[28:29], s[28:29], s[66:67]
    s_cbranch_scc0 L_nop5
    s_mov_b64 exec, s[28:29]
    buffer_load_dwordx2 v[8:9], v6, s[32:35], 0 offen sc1
    s_mov_b64 exec, -1
L_nop5:
    v_exp_f32 v40, v40
    v_exp_f32 v41, v41
    v_exp_f32 v42, v42
    v_exp_f32 v43, v43
    v_exp_f32 v44, v44
    v_mfma_f32_32x32x16_bf16 v[56:71], v[198:201], v[48:51], v[56:71]
    v_exp_f32 v45, v45
    v_exp_f32 v46, v46
    v_exp_f32 v47, v47
    v_cvt_pk_bf16_f32 v52, v40, v41
    v_cvt_pk_bf16_f32 v53, v42, v43
    v_cvt_pk_bf16_f32 v54, v44, v45
    v_cvt_pk_bf16_f32 v55, v46, v47
    s_setprio 1
    v_mfma_f32_32x32x8bf16_1k v[32:47], v[210:211], v[114:115], 0
    v_exp_f32 v16, v16
    v_exp_f32 v17, v17
    v_exp_f32 v18, v18
    v_exp_f32 v19, v19
    v_exp_f32 v20, v20
    v_mfma_f32_32x32x16_bf16 v[56:71], v[202:205], v[52:55], v[56:71]
    v_exp_f32 v21, v21
    v_exp_f32 v22, v22
    v_exp_f32 v23, v23
    v_cvt_pk_bf16_f32 v48, v16, v17
    v_cvt_pk_bf16_f32 v49, v18, v19
    v_cvt_pk_bf16_f32 v50, v20, v21
    v_cvt_pk_bf16_f32 v51, v22, v23
    v_mfma_f32_32x32x16_bf16 v[32:47], v[206:209], v[110:113], v[32:47]
    s_add_u32 s49, s48, 2560
    buffer_load_dwordx4 v[206:209], v2, s[32:35], s49 offen sc1
    s_mov_b64 exec, s[62:63]
    buffer_load_dwordx2 v[210:211], v3, s[32:35], s49 offen offset:2304 sc1
    s_mov_b64 exec, s[64:65]
    buffer_load_dwordx4 v[198:201], v4, s[32:35], s48 offen offset:1024 sc1
    buffer_load_dwordx4 v[202:205], v5, s[32:35], s48 offen offset:1024 sc1
    s_mov_b64 exec, -1
    v_exp_f32 v24, v24
    v_exp_f32 v25, v25
    v_exp_f32 v26, v26
    v_exp_f32 v27, v27
    v_exp_f32 v28, v28
    s_waitcnt vmcnt(13)
    v_mfma_f32_32x32x16_bf16 v[72:87], v[212:215], v[48:51], v[72:87]
    v_exp_f32 v29, v29
    v_exp_f32 v30, v30
    v_exp_f32 v31, v31
    v_cvt_pk_bf16_f32 v52, v24, v25
    v_cvt_pk_bf16_f32 v53, v26, v27
    v_cvt_pk_bf16_f32 v54, v28, v29
    v_cvt_pk_bf16_f32 v55, v30, v31
    s_setprio 0
    v_mfma_f32_32x32x8bf16_1k v[16:31], v[224:225], v[108:109], 0
    v_exp_f32 v32, v32
    v_exp_f32 v33, v33
    v_exp_f32 v34, v34
    v_exp_f32 v35, v35
    v_exp_f32 v36, v36
    v_mfma_f32_32x32x16_bf16 v[72:87], v[216:219], v[52:55], v[72:87]
    v_exp_f32 v37, v37
    v_exp_f32 v38, v38
    v_exp_f32 v39, v39
    v_cvt_pk_bf16_f32 v48, v32, v33
    v_cvt_pk_bf16_f32 v49, v34, v35
    v_cvt_pk_bf16_f32 v50, v36, v37
    v_cvt_pk_bf16_f32 v51, v38, v39
    v_mfma_f32_32x32x16_bf16 v[16:31], v[220:223], v[104:107], v[16:31]
    buffer_load_dwordx4 v13, s[8:11], s51 offen lds
    s_add_u32 m0, m0, 6400
    s_add_u32 s51, s51, 51200
    v_exp_f32 v40, v40
    v_exp_f32 v41, v41
    v_exp_f32 v42, v42
    v_exp_f32 v43, v43
    v_exp_f32 v44, v44
    v_mfma_f32_32x32x16_bf16 v[56:71], v[212:215], v[48:51], v[56:71]
    v_exp_f32 v45, v45
    v_exp_f32 v46, v46
    v_exp_f32 v47, v47
    v_cvt_pk_bf16_f32 v52, v40, v41
    v_cvt_pk_bf16_f32 v53, v42, v43
    v_cvt_pk_bf16_f32 v54, v44, v45
    v_cvt_pk_bf16_f32 v55, v46, v47
    s_setprio 3
    v_mfma_f32_32x32x8bf16_1k v[32:47], v[224:225], v[114:115], 0
    v_exp_f32 v16, v16
    v_exp_f32 v17, v17
    v_exp_f32 v18, v18
    v_exp_f32 v19, v19
    v_exp_f32 v20, v20
    v_mfma_f32_32x32x16_bf16 v[56:71], v[216:219], v[52:55], v[56:71]
    v_exp_f32 v21, v21
    v_exp_f32 v22, v22
    v_exp_f32 v23, v23
    v_cvt_pk_bf16_f32 v48, v16, v17
    v_cvt_pk_bf16_f32 v49, v18, v19
    v_cvt_pk_bf16_f32 v50, v20, v21
    v_cvt_pk_bf16_f32 v51, v22, v23
    v_mfma_f32_32x32x16_bf16 v[32:47], v[220:223], v[110:113], v[32:47]
    s_add_u32 s48, s49, 2560
    buffer_load_dwordx4 v[220:223], v2, s[32:35], s48 offen sc1
    s_mov_b64 exec, s[62:63]
    buffer_load_dwordx2 v[224:225], v3, s[32:35], s48 offen offset:2304 sc1
    s_mov_b64 exec, s[64:65]
    buffer_load_dwordx4 v[212:215], v4, s[32:35], s49 offen offset:1024 sc1
    buffer_load_dwordx4 v[216:219], v5, s[32:35], s49 offen offset:1024 sc1
    s_mov_b64 exec, -1
    v_exp_f32 v24, v24
    v_exp_f32 v25, v25
    v_exp_f32 v26, v26
    v_exp_f32 v27, v27
    v_exp_f32 v28, v28
    s_waitcnt vmcnt(13)
    v_mfma_f32_32x32x16_bf16 v[72:87], v[226:229], v[48:51], v[72:87]
    v_exp_f32 v29, v29
    v_exp_f32 v30, v30
    v_exp_f32 v31, v31
    v_cvt_pk_bf16_f32 v52, v24, v25
    v_cvt_pk_bf16_f32 v53, v26, v27
    v_cvt_pk_bf16_f32 v54, v28, v29
    v_cvt_pk_bf16_f32 v55, v30, v31
    s_setprio 2
    v_mfma_f32_32x32x8bf16_1k v[16:31], v[238:239], v[108:109], 0
    v_exp_f32 v32, v32
    v_exp_f32 v33, v33
    v_exp_f32 v34, v34
    v_exp_f32 v35, v35
    v_exp_f32 v36, v36
    v_mfma_f32_32x32x16_bf16 v[72:87], v[230:233], v[52:55], v[72:87]
    v_exp_f32 v37, v37
    v_exp_f32 v38, v38
    v_exp_f32 v39, v39
    v_cvt_pk_bf16_f32 v48, v32, v33
    v_cvt_pk_bf16_f32 v49, v34, v35
    v_cvt_pk_bf16_f32 v50, v36, v37
    v_cvt_pk_bf16_f32 v51, v38, v39
    v_mfma_f32_32x32x16_bf16 v[16:31], v[234:237], v[104:107], v[16:31]
    buffer_load_dwordx4 v13, s[8:11], s51 offen lds
    s_add_u32 m0, m0, 6400
    s_add_u32 s51, s51, 51200
    v_exp_f32 v40, v40
    v_exp_f32 v41, v41
    v_exp_f32 v42, v42
    v_exp_f32 v43, v43
    v_exp_f32 v44, v44
    v_mfma_f32_32x32x16_bf16 v[56:71], v[226:229], v[48:51], v[56:71]
    v_exp_f32 v45, v45
    v_exp_f32 v46, v46
    v_exp_f32 v47, v47
    v_cvt_pk_bf16_f32 v52, v40, v41
    v_cvt_pk_bf16_f32 v53, v42, v43
    v_cvt_pk_bf16_f32 v54, v44, v45
    v_cvt_pk_bf16_f32 v55, v46, v47
    s_setprio 1
    v_mfma_f32_32x32x8bf16_1k v[32:47], v[238:239], v[114:115], 0
    v_exp_f32 v16, v16
    v_exp_f32 v17, v17
    v_exp_f32 v18, v18
    v_exp_f32 v19, v19
    v_exp_f32 v20, v20
    v_mfma_f32_32x32x16_bf16 v[56:71], v[230:233], v[52:55], v[56:71]
    v_exp_f32 v21, v21
    v_exp_f32 v22, v22
    v_exp_f32 v23, v23
    v_cvt_pk_bf16_f32 v48, v16, v17
    v_cvt_pk_bf16_f32 v49, v18, v19
    v_cvt_pk_bf16_f32 v50, v20, v21
    v_cvt_pk_bf16_f32 v51, v22, v23
    v_mfma_f32_32x32x16_bf16 v[32:47], v[234:237], v[110:113], v[32:47]
    s_add_u32 s49, s48, 2560
    buffer_load_dwordx4 v[234:237], v2, s[32:35], s49 offen sc1
    s_mov_b64 exec, s[62:63]
    buffer_load_dwordx2 v[238:239], v3, s[32:35], s49 offen offset:2304 sc1
    s_mov_b64 exec, s[64:65]
    buffer_load_dwordx4 v[226:229], v4, s[32:35], s48 offen offset:1024 sc1
    buffer_load_dwordx4 v[230:233], v5, s[32:35], s48 offen offset:1024 sc1
    s_mov_b64 exec, -1
    v_exp_f32 v24, v24
    v_exp_f32 v25, v25
    v_exp_f32 v26, v26
    v_exp_f32 v27, v27
    v_exp_f32 v28, v28
    s_waitcnt vmcnt(14)
    v_mfma_f32_32x32x16_bf16 v[72:87], v[240:243], v[48:51], v[72:87]
    v_exp_f32 v29, v29
    v_exp_f32 v30, v30
    v_exp_f32 v31, v31
    v_cvt_pk_bf16_f32 v52, v24, v25
    v_cvt_pk_bf16_f32 v53, v26, v27
    v_cvt_pk_bf16_f32 v54, v28, v29
    v_cvt_pk_bf16_f32 v55, v30, v31
    s_setprio 0
    v_mfma_f32_32x32x8bf16_1k v[16:31], v[196:197], v[108:109], 0
    v_exp_f32 v32, v32
    v_exp_f32 v33, v33
    v_exp_f32 v34, v34
    v_exp_f32 v35, v35
    v_exp_f32 v36, v36
    v_mfma_f32_32x32x16_bf16 v[72:87], v[244:247], v[52:55], v[72:87]
    v_exp_f32 v37, v37
    v_exp_f32 v38, v38
    v_exp_f32 v39, v39
    v_cvt_pk_bf16_f32 v48, v32, v33
    v_cvt_pk_bf16_f32 v49, v34, v35
    v_cvt_pk_bf16_f32 v50, v36, v37
    v_cvt_pk_bf16_f32 v51, v38, v39
    v_mfma_f32_32x32x16_bf16 v[16:31], v[192:195], v[104:107], v[16:31]
    s_cmp_lg_u32 s54, 0
    s_cbranch_scc1 L_nog2_1
    v_mov_b32 v10, 159748
    v_mov_b32 v11, 1
    s_mov_b64 exec, 1
    ds_add_rtn_u32 v12, v10, v11
    s_mov_b64 exec, -1
    s_waitcnt lgkmcnt(0)
    v_readfirstlane_b32 s7, v12
    s_cmp_lg_u32 s7, 7
    s_cbranch_scc1 L_nof2_1
    v_mov_b32 v10, s36
    v_mov_b32 v11, s37
    s_mov_b64 exec, 1
    buffer_store_dwordx2 v[10:11], off, s[32:35], s52 sc1
    s_mov_b64 exec, -1
L_nof2_1:
L_nog2_1:
    v_exp_f32 v40, v40
    v_exp_f32 v41, v41
    v_exp_f32 v42, v42
    v_exp_f32 v43, v43
    v_exp_f32 v44, v44
    v_mfma_f32_32x32x16_bf16 v[56:71], v[240:243], v[48:51], v[56:71]
    s_add_u32 s54, s54, 1
    s_cmp_lt_u32 s54, 6
    v_exp_f32 v45, v45
    v_exp_f32 v46, v46
    v_exp_f32 v47, v47
    v_cvt_pk_bf16_f32 v52, v40, v41
    v_cvt_pk_bf16_f32 v53, v42, v43
    v_cvt_pk_bf16_f32 v54, v44, v45
    v_cvt_pk_bf16_f32 v55, v46, v47
    s_cbranch_scc1 L_A1_loop
    s_setprio 3
    s_waitcnt vmcnt(14)
    s_mov_b64 exec, s[28:29]
    v_subrev_co_u32 v8, vcc, s38, v8
    s_nop 1
    v_subb_co_u32 v9, vcc, v9, v7, vcc
    v_cmp_eq_u32 vcc, 0, v9
    s_or_b64 s[66:67], s[66:67], vcc
    s_mov_b64 exec, -1
    s_mov_b32 s68, 0
    s_mov_b32 s69, 0xffff0000
    s_andn2_b64 s[70:71], s[68:69], s[66:67]
    s_cbranch_scc1 L_pw8
L_pb8:
    v_mfma_f32_32x32x8bf16_1k v[32:47], v[196:197], v[114:115], 0
    v_exp_f32 v16, v16
    v_exp_f32 v17, v17
    v_exp_f32 v18, v18
    v_exp_f32 v19, v19
    v_exp_f32 v20, v20
    v_mfma_f32_32x32x16_bf16 v[56:71], v[244:247], v[52:55], v[56:71]
    v_exp_f32 v21, v21
    v_exp_f32 v22, v22
    v_exp_f32 v23, v23
    v_cvt_pk_bf16_f32 v48, v16, v17
    v_cvt_pk_bf16_f32 v49, v18, v19
    v_cvt_pk_bf16_f32 v50, v20, v21
    v_cvt_pk_bf16_f32 v51, v22, v23
    v_mfma_f32_32x32x16_bf16 v[32:47], v[192:195], v[110:113], v[32:47]
    s_mov_b64 exec, s[64:65]
    buffer_load_dwordx4 v[240:243], v4, s[32:35], s49 offen offset:1024 sc1
    buffer_load_dwordx4 v[244:247], v5, s[32:35], s49 offen offset:1024 sc1
    s_mov_b64 exec, -1
    v_exp_f32 v24, v24
    v_exp_f32 v25, v25
    v_exp_f32 v26, v26
    v_exp_f32 v27, v27
    v_exp_f32 v28, v28
    s_waitcnt vmcnt(12)
    v_mfma_f32_32x32x16_bf16 v[72:87], v[198:201], v[48:51], v[72:87]
    v_exp_f32 v29, v29
    v_exp_f32 v30, v30
    v_exp_f32 v31, v31
    v_cvt_pk_bf16_f32 v52, v24, v25
    v_cvt_pk_bf16_f32 v53, v26, v27
    v_cvt_pk_bf16_f32 v54, v28, v29
    v_cvt_pk_bf16_f32 v55, v30, v31
    s_setprio 2
    v_mfma_f32_32x32x8bf16_1k v[16:31], v[210:211], v[108:109], 0
    v_exp_f32 v32, v32
    v_exp_f32 v33, v33
    v_exp_f32 v34, v34
    v_exp_f32 v35, v35
    v_exp_f32 v36, v36
    v_mfma_f32_32x32x16_bf16 v[72:87], v[202:205], v[52:55], v[72:87]
    v_exp_f32 v37, v37
    v_exp_f32 v38, v38
    v_exp_f32 v39, v39
    v_cvt_pk_bf16_f32 v48, v32, v33
    v_cvt_pk_bf16_f32 v49, v34, v35
    v_cvt_pk_bf16_f32 v50, v36, v37
    v_cvt_pk_bf16_f32 v51, v38, v39
    v_mfma_f32_32x32x16_bf16 v[16:31], v[206:209], v[104:107], v[16:31]
    buffer_load_dwordx4 v13, s[8:11], s51 offen lds
    s_add_u32 m0, m0, 6400
    s_add_u32 s51, s51, 51200
    v_exp_f32 v40, v40
    v_exp_f32 v41, v41
    v_exp_f32 v42, v42
    v_exp_f32 v43, v43
    v_exp_f32 v44, v44
    v_mfma_f32_32x32x16_bf16 v[56:71], v[198:201], v[48:51], v[56:71]
    v_exp_f32 v45, v45
    v_exp_f32 v46, v46
    v_exp_f32 v47, v47
    v_cvt_pk_bf16_f32 v52, v40, v41
    v_cvt_pk_bf16_f32 v53, v42, v43
    v_cvt_pk_bf16_f32 v54, v44, v45
    v_cvt_pk_bf16_f32 v55, v46, v47
    s_setprio 1
    v_mfma_f32_32x32x8bf16_1k v[32:47], v[210:211], v[114:115], 0
    v_exp_f32 v16, v16
    v_exp_f32 v17, v17
    v_exp_f32 v18, v18
    v_exp_f32 v19, v19
    v_exp_f32 v20, v20
    v_mfma_f32_32x32x16_bf16 v[56:71], v[202:205], v[52:55], v[56:71]
    v_exp_f32 v21, v21
    v_exp_f32 v22, v22
    v_exp_f32 v23, v23
    v_cvt_pk_bf16_f32 v48, v16, v17
    v_cvt_pk_bf16_f32 v49, v18, v19
    v_cvt_pk_bf16_f32 v50, v20, v21
    v_cvt_pk_bf16_f32 v51, v22, v23
    v_mfma_f32_32x32x16_bf16 v[32:47], v[206:209], v[110:113], v[32:47]
    v_exp_f32 v24, v24
    v_exp_f32 v25, v25
    v_exp_f32 v26, v26
    v_exp_f32 v27, v27
    v_exp_f32 v28, v28
    s_waitcnt vmcnt(8)
    v_mfma_f32_32x32x16_bf16 v[72:87], v[212:215], v[48:51], v[72:87]
    v_exp_f32 v29, v29
    v_exp_f32 v30, v30
    v_exp_f32 v31, v31
    v_cvt_pk_bf16_f32 v52, v24, v25
    v_cvt_pk_bf16_f32 v53, v26, v27
    v_cvt_pk_bf16_f32 v54, v28, v29
    v_cvt_pk_bf16_f32 v55, v30, v31
    s_setprio 0
    v_mfma_f32_32x32x8bf16_1k v[16:31], v[224:225], v[108:109], 0
    v_exp_f32 v32, v32
    v_exp_f32 v33, v33
    v_exp_f32 v34, v34
    v_exp_f32 v35, v35
    v_exp_f32 v36, v36
    v_mfma_f32_32x32x16_bf16 v[72:87], v[216:219], v[52:55], v[72:87]
    v_exp_f32 v37, v37
    v_exp_f32 v38, v38
    v_exp_f32 v39, v39
    v_cvt_pk_bf16_f32 v48, v32, v33
    v_cvt_pk_bf16_f32 v49, v34, v35
    v_cvt_pk_bf16_f32 v50, v36, v37
    v_cvt_pk_bf16_f32 v51, v38, v39
    v_mfma_f32_32x32x16_bf16 v[16:31], v[220:223], v[104:107], v[16:31]
    buffer_load_dwordx4 v13, s[8:11], s51 offen lds
    s_add_u32 m0, m0, 6400
    s_add_u32 s51, s51, 51200
    v_exp_f32 v40, v40
    v_exp_f32 v41, v41
    v_exp_f32 v42, v42
    v_exp_f32 v43, v43
    v_exp_f32 v44, v44
    v_mfma_f32_32x32x16_bf16 v[56:71], v[212:215], v[48:51], v[56:71]
    v_exp_f32 v45, v45
    v_exp_f32 v46, v46
    v_exp_f32 v47, v47
    v_cvt_pk_bf16_f32 v52, v40, v41
    v_cvt_pk_bf16_f32 v53, v42, v43
    v_cvt_pk_bf16_f32 v54, v44, v45
    v_cvt_pk_bf16_f32 v55, v46, v47
    s_setprio 3
    v_mfma_f32_32x32x8bf16_1k v[32:47], v[224:225], v[114:115], 0
    v_exp_f32 v16, v16
    v_exp_f32 v17, v17
    v_exp_f32 v18, v18
    v_exp_f32 v19, v19
    v_exp_f32 v20, v20
    v_mfma_f32_32x32x16_bf16 v[56:71], v[216:219], v[52:55], v[56:71]
    v_exp_f32 v21, v21
    v_exp_f32 v22, v22
    v_exp_f32 v23, v23
    v_cvt_pk_bf16_f32 v48, v16, v17
    v_cvt_pk_bf16_f32 v49, v18, v19
    v_cvt_pk_bf16_f32 v50, v20, v21
    v_cvt_pk_bf16_f32 v51, v22, v23
    v_mfma_f32_32x32x16_bf16 v[32:47], v[220:223], v[110:113], v[32:47]
    v_exp_f32 v24, v24
    v_exp_f32 v25, v25
    v_exp_f32 v26, v26
    v_exp_f32 v27, v27
    v_exp_f32 v28, v28
    s_waitcnt vmcnt(4)
    v_mfma_f32_32x32x16_bf16 v[72:87], v[226:229], v[48:51], v[72:87]
    v_exp_f32 v29, v29
    v_exp_f32 v30, v30
    v_exp_f32 v31, v31
    v_cvt_pk_bf16_f32 v52, v24, v25
    v_cvt_pk_bf16_f32 v53, v26, v27
    v_cvt_pk_bf16_f32 v54, v28, v29
    v_cvt_pk_bf16_f32 v55, v30, v31
    s_setprio 2
    v_mfma_f32_32x32x8bf16_1k v[16:31], v[238:239], v[108:109], 0
    v_exp_f32 v32, v32
    v_exp_f32 v33, v33
    v_exp_f32 v34, v34
    v_exp_f32 v35, v35
    v_exp_f32 v36, v36
    v_mfma_f32_32x32x16_bf16 v[72:87], v[230:233], v[52:55], v[72:87]
    v_exp_f32 v37, v37
    v_exp_f32 v38, v38
    v_exp_f32 v39, v39
    v_cvt_pk_bf16_f32 v48, v32, v33
    v_cvt_pk_bf16_f32 v49, v34, v35
    v_cvt_pk_bf16_f32 v50, v36, v37
    v_cvt_pk_bf16_f32 v51, v38, v39
    v_mfma_f32_32x32x16_bf16 v[16:31], v[234:237], v[104:107], v[16:31]
    s_add_u32 s7, s42, 0
    buffer_load_dwordx4 v[150:153], v248, s[32:35], s7 offen offset:0 sc1
    buffer_load_dwordx4 v[154:157], v248, s[32:35], s7 offen offset:2560 sc1
    s_add_u32 s7, s42, 5120
    buffer_load_dwordx4 v[158:161], v248, s[32:35], s7 offen offset:0 sc1
    buffer_load_dwordx4 v[162:165], v248, s[32:35], s7 offen offset:2560 sc1
    s_add_u32 s7, s42, 0
    buffer_load_dwordx2 v[166:167], v249, s[32:35], s7 offen offset:1024 sc1
    s_add_u32 s7, s42, 5120
    buffer_load_dwordx2 v[168:169], v249, s[32:35], s7 offen offset:1024 sc1
    v_exp_f32 v40, v40
    v_exp_f32 v41, v41
    v_exp_f32 v42, v42
    v_exp_f32 v43, v43
    v_exp_f32 v44, v44
    v_mfma_f32_32x32x16_bf16 v[56:71], v[226:229], v[48:51], v[56:71]
    v_exp_f32 v45, v45
    v_exp_f32 v46, v46
    v_exp_f32 v47, v47
    v_cvt_pk_bf16_f32 v52, v40, v41
    v_cvt_pk_bf16_f32 v53, v42, v43
    v_cvt_pk_bf16_f32 v54, v44, v45
    v_cvt_pk_bf16_f32 v55, v46, v47
    s_setprio 1
    v_mfma_f32_32x32x8bf16_1k v[32:47], v[238:239], v[114:115], 0
    v_exp_f32 v16, v16
    v_exp_f32 v17, v17
    v_exp_f32 v18, v18
    v_exp_f32 v19, v19
    v_exp_f32 v20, v20
    v_mfma_f32_32x32x16_bf16 v[56:71], v[230:233], v[52:55], v[56:71]
    v_exp_f32 v21, v21
    v_exp_f32 v22, v22
    v_exp_f32 v23, v23
    v_cvt_pk_bf16_f32 v48, v16, v17
    v_cvt_pk_bf16_f32 v49, v18, v19
    v_cvt_pk_bf16_f32 v50, v20, v21
    v_cvt_pk_bf16_f32 v51, v22, v23
    v_mfma_f32_32x32x16_bf16 v[32:47], v[234:237], v[110:113], v[32:47]
    s_add_u32 s7, s42, 10240
    buffer_load_dwordx4 v[170:173], v248, s[32:35], s7 offen offset:0 sc1
    buffer_load_dwordx4 v[174:177], v248, s[32:35], s7 offen offset:2560 sc1
    s_add_u32 s7, s42, 15360
    buffer_load_dwordx4 v[178:181], v248, s[32:35], s7 offen offset:0 sc1
    buffer_load_dwordx4 v[182:185], v248, s[32:35], s7 offen offset:2560 sc1
    s_add_u32 s7, s42, 10240
    buffer_load_dwordx2 v[186:187], v249, s[32:35], s7 offen offset:1024 sc1
    s_add_u32 s7, s42, 15360
    buffer_load_dwordx2 v[188:189], v249, s[32:35], s7 offen offset:1024 sc1
    v_exp_f32 v24, v24
    v_exp_f32 v25, v25
    v_exp_f32 v26, v26
    v_exp_f32 v27, v27
    v_exp_f32 v28, v28
    s_waitcnt vmcnt(14)
    v_mfma_f32_32x32x16_bf16 v[72:87], v[240:243], v[48:51], v[72:87]
    v_exp_f32 v29, v29
    v_exp_f32 v30, v30
    v_exp_f32 v31, v31
    v_cvt_pk_bf16_f32 v52, v24, v25
    v_cvt_pk_bf16_f32 v53, v26, v27
    v_cvt_pk_bf16_f32 v54, v28, v29
    v_cvt_pk_bf16_f32 v55, v30, v31
    s_setprio 0
    v_exp_f32 v32, v32
    v_exp_f32 v33, v33
    v_exp_f32 v34, v34
    v_exp_f32 v35, v35
    v_exp_f32 v36, v36
    v_mfma_f32_32x32x16_bf16 v[72:87], v[244:247], v[52:55], v[72:87]
    v_exp_f32 v37, v37
    v_exp_f32 v38, v38
    v_exp_f32 v39, v39
    v_cvt_pk_bf16_f32 v48, v32, v33
    v_cvt_pk_bf16_f32 v49, v34, v35
    v_cvt_pk_bf16_f32 v50, v36, v37
    v_cvt_pk_bf16_f32 v51, v38, v39
    v_exp_f32 v40, v40
    v_exp_f32 v41, v41
    v_exp_f32 v42, v42
    v_exp_f32 v43, v43
    v_exp_f32 v44, v44
    v_mfma_f32_32x32x16_bf16 v[56:71], v[240:243], v[48:51], v[56:71]
    v_exp_f32 v45, v45
    v_exp_f32 v46, v46
    v_exp_f32 v47, v47
    v_cvt_pk_bf16_f32 v52, v40, v41
    v_cvt_pk_bf16_f32 v53, v42, v43
    v_cvt_pk_bf16_f32 v54, v44, v45
    v_cvt_pk_bf16_f32 v55, v46, v47
    s_nop 1
    v_mfma_f32_32x32x16_bf16 v[56:71], v[244:247], v[52:55], v[56:71]
    s_setprio 3
    ds_write_b128 v14, v[72:75] offset:24576
    ds_write_b128 v14, v[76:79] offset:25600
    ds_write_b128 v14, v[80:83] offset:26624
    s_waitcnt vmcnt(12)
    s_waitcnt lgkmcnt(0)
    s_barrier
    ds_read_b128 v[72:75], v134 offset:24576
    ds_read_b128 v[76:79], v134 offset:25600
    ds_read_b128 v[80:83], v134 offset:26624
    s_waitcnt lgkmcnt(0)
    s_nop 0
    v_pk_add_f32 v[64:65], v[64:65], v[80:81]
    v_pk_add_f32 v[66:67], v[66:67], v[82:83]
    v_cmp_lt_f32 vcc, 0x0d800000, v64
    s_mov_b32 s7, vcc_hi
    v_cmp_gt_f32 vcc, 0x71800000, v64
    s_and_b32 s7, s7, vcc_hi
    v_pk_add_f32 v[56:57], v[56:57], v[72:73]
    v_pk_add_f32 v[58:59], v[58:59], v[74:75]
    v_pk_add_f32 v[60:61], v[60:61], v[76:77]
    v_pk_add_f32 v[62:63], v[62:63], v[78:79]
    s_mov_b32 s100, 3
    s_cmp_eq_u32 s7, -1
    s_cbranch_scc0 L_fb
L_ret3:
    v_mov_b32 v10, v64
    v_mov_b32 v11, v64
    s_nop 1
    v_permlane32_swap_b32 v10, v11
    v_rcp_f32 v11, v11
    s_nop 0
    v_mul_f32 v56, v11, v56
    v_mul_f32 v57, v11, v57
    v_mul_f32 v58, v11, v58
    v_mul_f32 v59, v11, v59
    v_mul_f32 v60, v11, v60
    v_mul_f32 v61, v11, v61
    v_mul_f32 v62, v11, v62
    v_mul_f32 v63, v11, v63
    v_mul_f32 v64, v11, v64
    v_mul_f32 v65, v11, v65
    v_mul_f32 v66, v11, v66
    v_mul_f32 v67, v11, v67
    v_cvt_pk_bf16_f32 v72, v56, v57
    v_cvt_pk_bf16_f32 v73, v58, v59
    v_cvt_pk_bf16_f32 v74, v60, v61
    v_cvt_pk_bf16_f32 v75, v62, v63
    v_cvt_pk_bf16_f32 v76, v64, v65
    v_cvt_pk_bf16_f32 v77, v66, v67
    buffer_store_dwordx4 v[72:75], v2, s[32:35], s16 offen sc1
    s_mov_b64 exec, s[62:63]
    buffer_store_dwordx2 v[76:77], v3, s[32:35], s16 offen offset:1024 sc1
    s_mov_b64 exec, -1
    ds_read_b64_tr_b16 v[192:193], v250 offset:25600
    ds_read_b64_tr_b16 v[194:195], v250 offset:26880
    ds_read_b64_tr_b16 v[196:197], v250 offset:25632
    ds_read_b64_tr_b16 v[198:199], v250 offset:26912
    ds_read_b64_tr_b16 v[200:201], v250 offset:25664
    ds_read_b64_tr_b16 v[202:203], v250 offset:26944
    ds_read_b64_tr_b16 v[204:205], v250 offset:25696
    ds_read_b64_tr_b16 v[206:207], v250 offset:26976
    ds_read_b64_tr_b16 v[208:209], v250 offset:25728
    ds_read_b64_tr_b16 v[210:211], v250 offset:27008
    ds_read_b64_tr_b16 v[212:213], v250 offset:32000
    ds_read_b64_tr_b16 v[214:215], v250 offset:33280
    ds_read_b64_tr_b16 v[216:217], v250 offset:32032
    ds_read_b64_tr_b16 v[218:219], v250 offset:33312
    ds_read_b64_tr_b16 v[220:221], v250 offset:32064
    ds_read_b64_tr_b16 v[222:223], v250 offset:33344
    ds_read_b64_tr_b16 v[224:225], v250 offset:32096
    ds_read_b64_tr_b16 v[226:227], v250 offset:33376
    ds_read_b64_tr_b16 v[228:229], v250 offset:32128
    ds_read_b64_tr_b16 v[230:231], v250 offset:33408
    ds_read_b64_tr_b16 v[232:233], v250 offset:38400
    ds_read_b64_tr_b16 v[234:235], v250 offset:39680
    ds_read_b64_tr_b16 v[236:237], v250 offset:38432
    ds_read_b64_tr_b16 v[238:239], v250 offset:39712
    ds_read_b64_tr_b16 v[240:241], v250 offset:38464
    ds_read_b64_tr_b16 v[242:243], v250 offset:39744
    ds_read_b64_tr_b16 v[244:245], v250 offset:38496
    ds_read_b64_tr_b16 v[246:247], v250 offset:39776
    ds_read_b64_tr_b16 v[88:89], v250 offset:38528
    ds_read_b64_tr_b16 v[90:91], v250 offset:39808
    ds_read_b64_tr_b16 v[92:93], v250 offset:44800
    ds_read_b64_tr_b16 v[94:95], v250 offset:46080
    ds_read_b64_tr_b16 v[96:97], v250 offset:44832
    ds_read_b64_tr_b16 v[98:99], v250 offset:46112
    ds_read_b64_tr_b16 v[100:101], v250 offset:44864
    ds_read_b64_tr_b16 v[102:103], v250 offset:46144
    ds_read_b64_tr_b16 v[128:129], v250 offset:44896
    ds_read_b64_tr_b16 v[130:131], v250 offset:46176
    ds_read_b64_tr_b16 v[136:137], v250 offset:44928
    ds_read_b64_tr_b16 v[138:139], v250 offset:46208
    ds_read_b64_tr_b16 v[140:141], v251 offset:25600
    ds_read_b64_tr_b16 v[142:143], v251 offset:38400
    ds_read_b64_tr_b16 v[144:145], v251 offset:25632
    ds_read_b64_tr_b16 v[146:147], v251 offset:38432
L_out:
    ds_read_b64_tr_b16 v[76:77], v251 offset:25664
    ds_read_b64_tr_b16 v[78:79], v251 offset:38464
    ds_read_b64_tr_b16 v[80:81], v251 offset:25696
    ds_read_b64_tr_b16 v[82:83], v251 offset:38496
    ds_read_b64_tr_b16 v[84:85], v251 offset:25728
    ds_read_b64_tr_b16 v[86:87], v251 offset:38528
    ds_read_b64_tr_b16 v[124:125], v250 offset:0
    ds_read_b64_tr_b16 v[126:127], v250 offset:1280
    s_waitcnt vmcnt(2)
    v_max3_u32 v10, v150, v151, v152
    v_max3_u32 v11, v153, v154, v155
    v_max3_u32 v10, v10, v156, v157
    v_max3_u32 v11, v11, v158, v159
    v_max3_u32 v10, v10, v160, v161
    v_max3_u32 v11, v11, v162, v163
    v_max3_u32 v10, v10, v164, v165
    v_max3_u32 v11, v11, v166, v167
    v_max3_u32 v10, v10, v168, v169
    v_max3_u32 v11, v11, v170, v171
    v_max3_u32 v10, v10, v172, v173
    v_max3_u32 v11, v11, v174, v175
    v_max3_u32 v10, v10, v176, v177
    v_max3_u32 v11, v11, v178, v179
    v_max3_u32 v10, v10, v180, v181
    v_max3_u32 v11, v11, v182, v183
    v_max3_u32 v10, v10, v184, v185
    v_max3_u32 v11, v11, v186, v187
    v_max3_u32 v10, v10, v188, v189
    v_max_u32 v10, v10, v11
    v_cmp_eq_u32 vcc, -1, v10
    s_cmp_lg_u64 vcc, 0
    s_cbranch_scc1 L_ow0
L_ob0:
    s_cmp_eq_u32 s4, 0
    s_cselect_b32 s40, 1, -1
    s_mul_i32 s7, s40, 81920
    s_add_u32 s42, s42, s7
    s_mul_i32 s40, s40, 163840
    s_mul_i32 s40, s40, s44
    s_add_u32 s43, s43, s40
    s_waitcnt lgkmcnt(15)
    v_mfma_f32_16x16x32_bf16 v[104:107], v[192:195], v[170:173], 0
    s_waitcnt lgkmcnt(15)
    v_mfma_f32_16x16x32_bf16 v[108:111], v[196:199], v[170:173], 0
    s_waitcnt lgkmcnt(15)
    v_mfma_f32_16x16x32_bf16 v[112:115], v[200:203], v[170:173], 0
    s_waitcnt lgkmcnt(15)
    v_mfma_f32_16x16x32_bf16 v[116:119], v[204:207], v[170:173], 0
    s_waitcnt lgkmcnt(15)
    v_mfma_f32_16x16x32_bf16 v[120:123], v[208:211], v[170:173], 0
    s_waitcnt lgkmcnt(15)
    v_mfma_f32_16x16x32_bf16 v[104:107], v[212:215], v[174:177], v[104:107]
    ds_read_b64_tr_b16 v[170:171], v250 offset:32
    ds_read_b64_tr_b16 v[172:173], v250 offset:1312
    s_waitcnt lgkmcnt(15)
    v_mfma_f32_16x16x32_bf16 v[108:111], v[216:219], v[174:177], v[108:111]
    s_waitcnt lgkmcnt(15)
    v_mfma_f32_16x16x32_bf16 v[112:115], v[220:223], v[174:177], v[112:115]
    s_waitcnt lgkmcnt(15)
    v_mfma_f32_16x16x32_bf16 v[116:119], v[224:227], v[174:177], v[116:119]
    s_waitcnt lgkmcnt(15)
    v_mfma_f32_16x16x32_bf16 v[120:123], v[228:231], v[174:177], v[120:123]
    s_waitcnt lgkmcnt(15)
    v_mfma_f32_16x16x32_bf16 v[104:107], v[232:235], v[178:181], v[104:107]
    ds_read_b64_tr_b16 v[174:175], v250 offset:64
    ds_read_b64_tr_b16 v[176:177], v250 offset:1344
    s_waitcnt lgkmcnt(15)
    v_mfma_f32_16x16x32_bf16 v[108:111], v[236:239], v[178:181], v[108:111]
    s_waitcnt lgkmcnt(15)
    v_mfma_f32_16x16x32_bf16 v[112:115], v[240:243], v[178:181], v[112:115]
    s_waitcnt lgkmcnt(15)
    v_mfma_f32_16x16x32_bf16 v[116:119], v[244:247], v[178:181], v[116:119]
    s_waitcnt lgkmcnt(15)
    v_mfma_f32_16x16x32_bf16 v[120:123], v[88:91], v[178:181], v[120:123]
    s_waitcnt lgkmcnt(15)
    v_mfma_f32_16x16x32_bf16 v[104:107], v[92:95], v[182:185], v[104:107]
    ds_read_b64_tr_b16 v[178:179], v250 offset:96
    ds_read_b64_tr_b16 v[180:181], v250 offset:1376
    s_waitcnt lgkmcnt(15)
    v_mfma_f32_16x16x32_bf16 v[108:111], v[96:99], v[182:185], v[108:111]
    s_waitcnt lgkmcnt(15)
    v_mfma_f32_16x16x32_bf16 v[112:115], v[100:103], v[182:185], v[112:115]
    s_waitcnt lgkmcnt(15)
    v_mfma_f32_16x16x32_bf16 v[116:119], v[128:131], v[182:185], v[116:119]
    s_waitcnt lgkmcnt(15)
    v_mfma_f32_16x16x32_bf16 v[120:123], v[136:139], v[182:185], v[120:123]
    s_waitcnt lgkmcnt(15)
    v_mfma_f32_16x16x32_bf16 v[104:107], v[140:143], v[186:189], v[104:107]
    ds_read_b64_tr_b16 v[182:183], v250 offset:128
    ds_read_b64_tr_b16 v[184:185], v250 offset:1408
    s_waitcnt lgkmcnt(15)
    v_mfma_f32_16x16x32_bf16 v[108:111], v[144:147], v[186:189], v[108:111]
    s_waitcnt lgkmcnt(14)
    v_mfma_f32_16x16x32_bf16 v[112:115], v[76:79], v[186:189], v[112:115]
    s_waitcnt lgkmcnt(12)
    v_mfma_f32_16x16x32_bf16 v[116:119], v[80:83], v[186:189], v[116:119]
    ds_read_b64_tr_b16 v[76:77], v250 offset:6400
    ds_read_b64_tr_b16 v[78:79], v250 offset:7680
    s_waitcnt lgkmcnt(12)
    v_mfma_f32_16x16x32_bf16 v[120:123], v[84:87], v[186:189], v[120:123]
    ds_read_b64_tr_b16 v[80:81], v250 offset:6432
    ds_read_b64_tr_b16 v[82:83], v250 offset:7712
    s_waitcnt lgkmcnt(12)
    v_mfma_f32_16x16x32_bf16 v[104:107], v[124:127], v[150:153], v[104:107]
    ds_read_b64_tr_b16 v[84:85], v250 offset:6464
    ds_read_b64_tr_b16 v[86:87], v250 offset:7744
    ds_read_b64_tr_b16 v[186:187], v250 offset:6496
    ds_read_b64_tr_b16 v[188:189], v250 offset:7776
    s_waitcnt lgkmcnt(14)
    v_mfma_f32_16x16x32_bf16 v[108:111], v[170:173], v[150:153], v[108:111]
    ds_read_b64_tr_b16 v[124:125], v250 offset:6528
    ds_read_b64_tr_b16 v[126:127], v250 offset:7808
    s_waitcnt lgkmcnt(14)
    v_mfma_f32_16x16x32_bf16 v[112:115], v[174:177], v[150:153], v[112:115]
    ds_read_b64_tr_b16 v[170:171], v250 offset:12800
    ds_read_b64_tr_b16 v[172:173], v250 offset:14080
    s_waitcnt lgkmcnt(14)
    v_mfma_f32_16x16x32_bf16 v[116:119], v[178:181], v[150:153], v[116:119]
    ds_read_b64_tr_b16 v[174:175], v250 offset:12832
    ds_read_b64_tr_b16 v[176:177], v250 offset:14112
    s_waitcnt lgkmcnt(14)
    v_mfma_f32_16x16x32_bf16 v[120:123], v[182:185], v[150:153], v[120:123]
    ds_read_b64_tr_b16 v[178:179], v250 offset:12864
    ds_read_b64_tr_b16 v[180:181], v250 offset:14144
    s_setprio 3
    s_add_u32 s7, s42, 10240
    buffer_load_dwordx4 v[36:39], v248, s[32:35], s7 offen offset:0 sc1
    buffer_load_dwordx4 v[40:43], v248, s[32:35], s7 offen offset:2560 sc1
    s_waitcnt lgkmcnt(14)
    v_mfma_f32_16x16x32_bf16 v[104:107], v[76:79], v[154:157], v[104:107]
    ds_read_b64_tr_b16 v[182:183], v250 offset:12896
    ds_read_b64_tr_b16 v[184:185], v250 offset:14176
    ds_read_b64_tr_b16 v[150:151], v250 offset:12928
    ds_read_b64_tr_b16 v[152:153], v250 offset:14208
    s_waitcnt lgkmcnt(15)
    v_mfma_f32_16x16x32_bf16 v[108:111], v[80:83], v[154:157], v[108:111]
    ds_read_b64_tr_b16 v[76:77], v250 offset:19200
    ds_read_b64_tr_b16 v[78:79], v250 offset:20480
    s_waitcnt lgkmcnt(15)
    v_mfma_f32_16x16x32_bf16 v[112:115], v[84:87], v[154:157], v[112:115]
    ds_read_b64_tr_b16 v[80:81], v250 offset:19232
    ds_read_b64_tr_b16 v[82:83], v250 offset:20512
    s_waitcnt lgkmcnt(15)
    v_mfma_f32_16x16x32_bf16 v[116:119], v[186:189], v[154:157], v[116:119]
    ds_read_b64_tr_b16 v[84:85], v250 offset:19264
    ds_read_b64_tr_b16 v[86:87], v250 offset:20544
    s_waitcnt lgkmcnt(15)
    v_mfma_f32_16x16x32_bf16 v[120:123], v[124:127], v[154:157], v[120:123]
    ds_read_b64_tr_b16 v[186:187], v250 offset:19296
    ds_read_b64_tr_b16 v[188:189], v250 offset:20576
    s_waitcnt lgkmcnt(15)
    v_mfma_f32_16x16x32_bf16 v[104:107], v[170:173], v[158:161], v[104:107]
    ds_read_b64_tr_b16 v[124:125], v250 offset:19328
    ds_read_b64_tr_b16 v[126:127], v250 offset:20608
    ds_read_b64_tr_b16 v[154:155], v251 offset:0
    ds_read_b64_tr_b16 v[156:157], v251 offset:12800
    s_waitcnt lgkmcnt(15)
    v_mfma_f32_16x16x32_bf16 v[108:111], v[174:177], v[158:161], v[108:111]
    ds_read_b64_tr_b16 v[170:171], v251 offset:32
    ds_read_b64_tr_b16 v[172:173], v251 offset:12832
    s_waitcnt lgkmcnt(15)
    v_mfma_f32_16x16x32_bf16 v[112:115], v[178:181], v[158:161], v[112:115]
    ds_read_b64_tr_b16 v[174:175], v251 offset:64
    ds_read_b64_tr_b16 v[176:177], v251 offset:12864
    s_waitcnt lgkmcnt(15)
    v_mfma_f32_16x16x32_bf16 v[116:119], v[182:185], v[158:161], v[116:119]
    ds_read_b64_tr_b16 v[178:179], v251 offset:96
    ds_read_b64_tr_b16 v[180:181], v251 offset:12896
    s_waitcnt lgkmcnt(15)
    v_mfma_f32_16x16x32_bf16 v[120:123], v[150:153], v[158:161], v[120:123]
    s_setprio 2
    s_add_u32 s7, s42, 15360
    buffer_load_dwordx4 v[44:47], v248, s[32:35], s7 offen offset:0 sc1
    buffer_load_dwordx4 v[48:51], v248, s[32:35], s7 offen offset:2560 sc1
    s_add_u32 s7, s42, 10240
    buffer_load_dwordx2 v[52:53], v249, s[32:35], s7 offen offset:1024 sc1
    s_add_u32 s7, s42, 15360
    buffer_load_dwordx2 v[54:55], v249, s[32:35], s7 offen offset:1024 sc1
    s_waitcnt lgkmcnt(15)
    v_mfma_f32_16x16x32_bf16 v[104:107], v[76:79], v[162:165], v[104:107]
    ds_read_b64_tr_b16 v[158:159], v251 offset:128
    ds_read_b64_tr_b16 v[160:161], v251 offset:12928
    s_waitcnt lgkmcnt(15)
    v_mfma_f32_16x16x32_bf16 v[108:111], v[80:83], v[162:165], v[108:111]
    s_waitcnt lgkmcnt(14)
    v_mfma_f32_16x16x32_bf16 v[112:115], v[84:87], v[162:165], v[112:115]
    s_waitcnt lgkmcnt(12)
    v_mfma_f32_16x16x32_bf16 v[116:119], v[186:189], v[162:165], v[116:119]
    s_waitcnt lgkmcnt(10)
    v_mfma_f32_16x16x32_bf16 v[120:123], v[124:127], v[162:165], v[120:123]
    s_waitcnt lgkmcnt(8)
    v_mfma_f32_16x16x32_bf16 v[104:107], v[154:157], v[166:169], v[104:107]
    ds_read_b64_tr_b16 v[162:163], v251 offset:25664
    ds_read_b64_tr_b16 v[164:165], v251 offset:38464
    s_waitcnt lgkmcnt(8)
    v_mfma_f32_16x16x32_bf16 v[108:111], v[170:173], v[166:169], v[108:111]
    s_waitcnt lgkmcnt(6)
    v_mfma_f32_16x16x32_bf16 v[112:115], v[174:177], v[166:169], v[112:115]
    s_waitcnt lgkmcnt(4)
    v_mfma_f32_16x16x32_bf16 v[116:119], v[178:181], v[166:169], v[116:119]
    s_waitcnt lgkmcnt(2)
    v_mfma_f32_16x16x32_bf16 v[120:123], v[158:161], v[166:169], v[120:123]
    s_cmp_lt_u32 s3, 4
    s_cbranch_scc1 L_rw0
    ds_write_b128 v14, v[104:107] offset:0
    ds_write_b128 v14, v[108:111] offset:1024
    ds_write_b128 v14, v[112:115] offset:2048
    s_nop 0
    ds_write_b128 v134, v[116:119] offset:24576
    s_nop 0
    ds_write_b128 v134, v[120:123] offset:25600
L_rw0:
    s_waitcnt vmcnt(4)
    v_max3_u32 v10, v36, v37, v38
    v_max3_u32 v11, v39, v40, v41
    v_max3_u32 v10, v10, v42, v43
    v_max_u32 v10, v10, v11
    v_cmp_eq_u32 vcc, -1, v10
    s_cmp_lg_u64 vcc, 0
    s_cbranch_scc1 L_og0
L_oh0:
    s_setprio 1
    s_add_u32 s7, s42, 0
    buffer_load_dwordx4 v[16:19], v248, s[32:35], s7 offen offset:0 sc1
    buffer_load_dwordx4 v[20:23], v248, s[32:35], s7 offen offset:2560 sc1
    v_mfma_f32_16x16x32_bf16 v[56:59], v[192:195], v[36:39], 0
    ds_read_b64_tr_b16 v[166:167], v251 offset:25696
    ds_read_b64_tr_b16 v[168:169], v251 offset:38496
    v_mfma_f32_16x16x32_bf16 v[60:63], v[196:199], v[36:39], 0
    ds_read_b64_tr_b16 v[192:193], v251 offset:25728
    ds_read_b64_tr_b16 v[194:195], v251 offset:38528
    v_mfma_f32_16x16x32_bf16 v[64:67], v[200:203], v[36:39], 0
    ds_read_b64_tr_b16 v[196:197], v250 offset:0
    ds_read_b64_tr_b16 v[198:199], v250 offset:1280
    v_mfma_f32_16x16x32_bf16 v[68:71], v[204:207], v[36:39], 0
    ds_read_b64_tr_b16 v[200:201], v250 offset:32
    ds_read_b64_tr_b16 v[202:203], v250 offset:1312
    v_mfma_f32_16x16x32_bf16 v[72:75], v[208:211], v[36:39], 0
    ds_read_b64_tr_b16 v[204:205], v250 offset:64
    ds_read_b64_tr_b16 v[206:207], v250 offset:1344
    v_mfma_f32_16x16x32_bf16 v[56:59], v[212:215], v[40:43], v[56:59]
    ds_read_b64_tr_b16 v[208:209], v250 offset:96
    ds_read_b64_tr_b16 v[210:211], v250 offset:1376
    v_mfma_f32_16x16x32_bf16 v[60:63], v[216:219], v[40:43], v[60:63]
    ds_read_b64_tr_b16 v[212:213], v250 offset:128
    ds_read_b64_tr_b16 v[214:215], v250 offset:1408
    v_mfma_f32_16x16x32_bf16 v[64:67], v[220:223], v[40:43], v[64:67]
    ds_read_b64_tr_b16 v[216:217], v250 offset:6400
    ds_read_b64_tr_b16 v[218:219], v250 offset:7680
    v_mfma_f32_16x16x32_bf16 v[68:71], v[224:227], v[40:43], v[68:71]
    ds_read_b64_tr_b16 v[220:221], v250 offset:6432
    ds_read_b64_tr_b16 v[222:223], v250 offset:7712
    v_mfma_f32_16x16x32_bf16 v[72:75], v[228:231], v[40:43], v[72:75]
    ds_read_b64_tr_b16 v[224:225], v250 offset:6464
    ds_read_b64_tr_b16 v[226:227], v250 offset:7744
    s_waitcnt vmcnt(2)
    v_max3_u32 v10, v44, v45, v46
    v_max3_u32 v11, v47, v48, v49
    v_max3_u32 v10, v10, v52, v53
    v_max3_u32 v11, v11, v54, v55
    v_max3_u32 v10, v10, v50, v51
    v_max_u32 v10, v10, v11
    v_cmp_eq_u32 vcc, -1, v10
    s_cmp_lg_u64 vcc, 0
    s_cbranch_scc1 L_og1
L_oh1:
    s_setprio 0
    s_add_u32 s7, s42, 5120
    buffer_load_dwordx4 v[24:27], v248, s[32:35], s7 offen offset:0 sc1
    buffer_load_dwordx4 v[28:31], v248, s[32:35], s7 offen offset:2560 sc1
    s_add_u32 s7, s42, 0
    buffer_load_dwordx2 v[32:33], v249, s[32:35], s7 offen offset:1024 sc1
    s_add_u32 s7, s42, 5120
    buffer_load_dwordx2 v[34:35], v249, s[32:35], s7 offen offset:1024 sc1
    v_mfma_f32_16x16x32_bf16 v[56:59], v[232:235], v[44:47], v[56:59]
    ds_read_b64_tr_b16 v[228:229], v250 offset:6496
    ds_read_b64_tr_b16 v[230:231], v250 offset:7776
    v_mfma_f32_16x16x32_bf16 v[60:63], v[236:239], v[44:47], v[60:63]
    ds_read_b64_tr_b16 v[232:233], v250 offset:6528
    ds_read_b64_tr_b16 v[234:235], v250 offset:7808
    v_mfma_f32_16x16x32_bf16 v[64:67], v[240:243], v[44:47], v[64:67]
    ds_read_b64_tr_b16 v[236:237], v250 offset:12800
    ds_read_b64_tr_b16 v[238:239], v250 offset:14080
    v_mfma_f32_16x16x32_bf16 v[68:71], v[244:247], v[44:47], v[68:71]
    ds_read_b64_tr_b16 v[240:241], v250 offset:12832
    ds_read_b64_tr_b16 v[242:243], v250 offset:14112
    v_mfma_f32_16x16x32_bf16 v[72:75], v[88:91], v[44:47], v[72:75]
    ds_read_b64_tr_b16 v[244:245], v250 offset:12864
    ds_read_b64_tr_b16 v[246:247], v250 offset:14144
    v_mfma_f32_16x16x32_bf16 v[56:59], v[92:95], v[48:51], v[56:59]
    v_mfma_f32_16x16x32_bf16 v[60:63], v[96:99], v[48:51], v[60:63]
    v_mfma_f32_16x16x32_bf16 v[64:67], v[100:103], v[48:51], v[64:67]
    v_mfma_f32_16x16x32_bf16 v[68:71], v[128:131], v[48:51], v[68:71]
    v_mfma_f32_16x16x32_bf16 v[72:75], v[136:139], v[48:51], v[72:75]
    v_mfma_f32_16x16x32_bf16 v[56:59], v[140:143], v[52:55], v[56:59]
    v_mfma_f32_16x16x32_bf16 v[60:63], v[144:147], v[52:55], v[60:63]
    s_waitcnt lgkmcnt(15)
    v_mfma_f32_16x16x32_bf16 v[64:67], v[162:165], v[52:55], v[64:67]
    s_waitcnt lgkmcnt(15)
    v_mfma_f32_16x16x32_bf16 v[68:71], v[166:169], v[52:55], v[68:71]
    s_waitcnt lgkmcnt(15)
    v_mfma_f32_16x16x32_bf16 v[72:75], v[192:195], v[52:55], v[72:75]
    s_waitcnt vmcnt(4)
    v_max3_u32 v10, v16, v17, v18
    v_max3_u32 v11, v19, v20, v21
    v_max3_u32 v10, v10, v22, v23
    v_max_u32 v10, v10, v11
    v_cmp_eq_u32 vcc, -1, v10
    s_cmp_lg_u64 vcc, 0
    s_cbranch_scc1 L_og2
L_oh2:
    s_waitcnt lgkmcnt(15)
    v_mfma_f32_16x16x32_bf16 v[56:59], v[196:199], v[16:19], v[56:59]
    s_waitcnt lgkmcnt(15)
    v_mfma_f32_16x16x32_bf16 v[60:63], v[200:203], v[16:19], v[60:63]
    s_waitcnt lgkmcnt(15)
    v_mfma_f32_16x16x32_bf16 v[64:67], v[204:207], v[16:19], v[64:67]
    s_waitcnt lgkmcnt(15)
    v_mfma_f32_16x16x32_bf16 v[68:71], v[208:211], v[16:19], v[68:71]
    s_waitcnt lgkmcnt(15)
    v_mfma_f32_16x16x32_bf16 v[72:75], v[212:215], v[16:19], v[72:75]
    s_waitcnt lgkmcnt(14)
    v_mfma_f32_16x16x32_bf16 v[56:59], v[216:219], v[20:23], v[56:59]
    s_waitcnt lgkmcnt(12)
    v_mfma_f32_16x16x32_bf16 v[60:63], v[220:223], v[20:23], v[60:63]
    s_waitcnt lgkmcnt(10)
    v_mfma_f32_16x16x32_bf16 v[64:67], v[224:227], v[20:23], v[64:67]
    s_waitcnt lgkmcnt(8)
    v_mfma_f32_16x16x32_bf16 v[68:71], v[228:231], v[20:23], v[68:71]
    s_waitcnt lgkmcnt(6)
    v_mfma_f32_16x16x32_bf16 v[72:75], v[232:235], v[20:23], v[72:75]
    s_waitcnt vmcnt(0)
    v_max3_u32 v10, v24, v25, v26
    v_max3_u32 v11, v27, v28, v29
    v_max3_u32 v10, v10, v32, v33
    v_max3_u32 v11, v11, v34, v35
    v_max3_u32 v10, v10, v30, v31
    v_max_u32 v10, v10, v11
    v_cmp_eq_u32 vcc, -1, v10
    s_cmp_lg_u64 vcc, 0
    s_cbranch_scc1 L_og3
L_oh3:
    s_cmp_lt_u32 s3, 4
    s_waitcnt lgkmcnt(4)
    v_mfma_f32_16x16x32_bf16 v[56:59], v[236:239], v[24:27], v[56:59]
    s_waitcnt lgkmcnt(2)
    v_mfma_f32_16x16x32_bf16 v[60:63], v[240:243], v[24:27], v[60:63]
    s_waitcnt lgkmcnt(0)
    v_mfma_f32_16x16x32_bf16 v[64:67], v[244:247], v[24:27], v[64:67]
    v_mfma_f32_16x16x32_bf16 v[68:71], v[182:185], v[24:27], v[68:71]
    v_mfma_f32_16x16x32_bf16 v[72:75], v[150:153], v[24:27], v[72:75]
    v_mfma_f32_16x16x32_bf16 v[56:59], v[76:79], v[28:31], v[56:59]
    v_mfma_f32_16x16x32_bf16 v[60:63], v[80:83], v[28:31], v[60:63]
    v_mfma_f32_16x16x32_bf16 v[64:67], v[84:87], v[28:31], v[64:67]
    v_mfma_f32_16x16x32_bf16 v[68:71], v[186:189], v[28:31], v[68:71]
    v_mfma_f32_16x16x32_bf16 v[72:75], v[124:127], v[28:31], v[72:75]
    v_mfma_f32_16x16x32_bf16 v[56:59], v[154:157], v[32:35], v[56:59]
    v_mfma_f32_16x16x32_bf16 v[60:63], v[170:173], v[32:35], v[60:63]
    v_mfma_f32_16x16x32_bf16 v[64:67], v[174:177], v[32:35], v[64:67]
    v_mfma_f32_16x16x32_bf16 v[68:71], v[178:181], v[32:35], v[68:71]
    v_mfma_f32_16x16x32_bf16 v[72:75], v[158:161], v[32:35], v[72:75]
    s_cbranch_scc0 L_rs1
    s_nop 2
    ds_write_b128 v14, v[56:59] offset:0
    ds_write_b128 v14, v[60:63] offset:1024
    ds_write_b128 v14, v[64:67] offset:2048
    ds_write_b128 v134, v[68:71] offset:24576
    ds_write_b128 v134, v[72:75] offset:25600
    s_waitcnt lgkmcnt(0)
    s_barrier
    ds_read_b128 v[192:195], v134 offset:0
    ds_read_b128 v[196:199], v134 offset:1024
    ds_read_b128 v[200:203], v134 offset:2048
    ds_read_b128 v[204:207], v14 offset:24576
    ds_read_b128 v[208:211], v14 offset:25600
    s_waitcnt lgkmcnt(4)
    v_pk_add_f32 v[104:105], v[104:105], v[192:193]
    v_pk_add_f32 v[106:107], v[106:107], v[194:195]
    v_cvt_pk_bf16_f32 v212, v104, v105
    v_cvt_pk_bf16_f32 v213, v106, v107
    s_waitcnt lgkmcnt(3)
    v_pk_add_f32 v[108:109], v[108:109], v[196:197]
    v_pk_add_f32 v[110:111], v[110:111], v[198:199]
    v_cvt_pk_bf16_f32 v214, v108, v109
    v_cvt_pk_bf16_f32 v215, v110, v111
    s_nop 0
    v_permlane16_swap_b32 v212, v214
    v_permlane16_swap_b32 v213, v215
    buffer_store_dwordx4 v[212:215], v252, s[12:15], s43 offen offset:0
    s_waitcnt lgkmcnt(2)
    v_pk_add_f32 v[112:113], v[112:113], v[200:201]
    v_pk_add_f32 v[114:115], v[114:115], v[202:203]
    v_cvt_pk_bf16_f32 v216, v112, v113
    v_cvt_pk_bf16_f32 v217, v114, v115
    s_waitcnt lgkmcnt(1)
    v_pk_add_f32 v[116:117], v[116:117], v[204:205]
    v_pk_add_f32 v[118:119], v[118:119], v[206:207]
    v_cvt_pk_bf16_f32 v218, v116, v117
    v_cvt_pk_bf16_f32 v219, v118, v119
    s_nop 0
    v_permlane16_swap_b32 v216, v218
    v_permlane16_swap_b32 v217, v219
    buffer_store_dwordx4 v[216:219], v252, s[12:15], s43 offen offset:64
    s_waitcnt lgkmcnt(0)
    v_pk_add_f32 v[120:121], v[120:121], v[208:209]
    v_pk_add_f32 v[122:123], v[122:123], v[210:211]
    v_cvt_pk_bf16_f32 v220, v120, v121
    v_cvt_pk_bf16_f32 v221, v122, v123
    buffer_store_dwordx2 v[220:221], v253, s[12:15], s43 offen offset:128
    s_branch L_fin
L_rs1:
    s_waitcnt lgkmcnt(0)
    s_barrier
    ds_read_b128 v[192:195], v134 offset:0
    ds_read_b128 v[196:199], v134 offset:1024
    ds_read_b128 v[200:203], v134 offset:2048
    ds_read_b128 v[204:207], v14 offset:24576
    ds_read_b128 v[208:211], v14 offset:25600
    s_waitcnt lgkmcnt(4)
    v_pk_add_f32 v[56:57], v[56:57], v[192:193]
    v_pk_add_f32 v[58:59], v[58:59], v[194:195]
    v_cvt_pk_bf16_f32 v212, v56, v57
    v_cvt_pk_bf16_f32 v213, v58, v59
    s_waitcnt lgkmcnt(3)
    v_pk_add_f32 v[60:61], v[60:61], v[196:197]
    v_pk_add_f32 v[62:63], v[62:63], v[198:199]
    v_cvt_pk_bf16_f32 v214, v60, v61
    v_cvt_pk_bf16_f32 v215, v62, v63
    s_nop 0
    v_permlane16_swap_b32 v212, v214
    v_permlane16_swap_b32 v213, v215
    buffer_store_dwordx4 v[212:215], v252, s[12:15], s43 offen offset:0
    s_waitcnt lgkmcnt(2)
    v_pk_add_f32 v[64:65], v[64:65], v[200:201]
    v_pk_add_f32 v[66:67], v[66:67], v[202:203]
    v_cvt_pk_bf16_f32 v216, v64, v65
    v_cvt_pk_bf16_f32 v217, v66, v67
    s_waitcnt lgkmcnt(1)
    v_pk_add_f32 v[68:69], v[68:69], v[204:205]
    v_pk_add_f32 v[70:71], v[70:71], v[206:207]
    v_cvt_pk_bf16_f32 v218, v68, v69
    v_cvt_pk_bf16_f32 v219, v70, v71
    s_nop 0
    v_permlane16_swap_b32 v216, v218
    v_permlane16_swap_b32 v217, v219
    buffer_store_dwordx4 v[216:219], v252, s[12:15], s43 offen offset:64
    s_waitcnt lgkmcnt(0)
    v_pk_add_f32 v[72:73], v[72:73], v[208:209]
    v_pk_add_f32 v[74:75], v[74:75], v[210:211]
    v_cvt_pk_bf16_f32 v220, v72, v73
    v_cvt_pk_bf16_f32 v221, v74, v75
    buffer_store_dwordx2 v[220:221], v253, s[12:15], s43 offen offset:128
L_fin:
L_end:
    s_endpgm
L_lost:
    s_waitcnt vmcnt(0) lgkmcnt(0)
    s_barrier
    s_cmp_lg_u32 s3, 0
    s_cbranch_scc1 L_lost2
    s_mov_b64 exec, 1
    s_mov_b32 s42, 0
L_lost1:
    s_add_u32 s41, s41, 1
    s_and_b32 s41, s41, 255
    v_mov_b32 v22, s36
    v_mov_b32 v23, s37
    s_lshl_b32 s7, s41, 3
    s_add_u32 s7, s7, 18354176
    buffer_atomic_swap_x2 v[22:23], off, s[32:35], s7 sc0 sc1
    s_add_u32 s42, s42, 1
    s_waitcnt vmcnt(0)
    v_subrev_co_u32 v22, vcc, s38, v22
    v_mov_b32 v22, s39
    s_nop 0
    v_subb_co_u32 v23, vcc, v23, v22, vcc
    s_nop 0
    v_readfirstlane_b32 s7, v23
    s_cmp_lg_u32 s7, 0
    s_cselect_b32 s42, 256, s42
    s_cmp_lt_u32 s42, 256
    s_cbranch_scc1 L_lost1
    v_mov_b32 v22, s41
    ds_write_b32 v21, v22
    s_mov_b64 exec, -1
    s_waitcnt lgkmcnt(0)
L_lost2:
    s_barrier
    ds_read_b32 v22, v21
    s_mov_b32 s42, 1
    s_mov_b32 s40, 0
    s_waitcnt lgkmcnt(0)
    v_readfirstlane_b32 s41, v22
    s_barrier
    s_branch L_restart
L_og0:
    s_mov_b32 s55, 0
L_ogl0:
    s_add_u32 s7, s42, 10240
    buffer_load_dwordx4 v[36:39], v248, s[32:35], s7 offen offset:0 sc1
    buffer_load_dwordx4 v[40:43], v248, s[32:35], s7 offen offset:2560 sc1
    s_add_u32 s7, s42, 15360
    buffer_load_dwordx4 v[44:47], v248, s[32:35], s7 offen offset:0 sc1
    buffer_load_dwordx4 v[48:51], v248, s[32:35], s7 offen offset:2560 sc1
    s_add_u32 s7, s42, 10240
    buffer_load_dwordx2 v[52:53], v249, s[32:35], s7 offen offset:1024 sc1
    s_add_u32 s7, s42, 15360
    buffer_load_dwordx2 v[54:55], v249, s[32:35], s7 offen offset:1024 sc1
    s_add_u32 s55, s55, 1
    s_waitcnt vmcnt(4)
    v_max3_u32 v10, v36, v37, v38
    v_max3_u32 v11, v39, v40, v41
    v_max3_u32 v10, v10, v42, v43
    v_max_u32 v10, v10, v11
    v_cmp_eq_u32 vcc, -1, v10
    s_cmp_lg_u64 vcc, 0
    s_cselect_b32 s55, s55, -1
    s_cmp_lt_u32 s55, 16384
    s_cbranch_scc1 L_ogl0
    s_branch L_oh0
L_og1:
    s_mov_b32 s55, 0
L_ogl1:
    s_add_u32 s7, s42, 15360
    buffer_load_dwordx4 v[44:47], v248, s[32:35], s7 offen offset:0 sc1
    buffer_load_dwordx4 v[48:51], v248, s[32:35], s7 offen offset:2560 sc1
    s_add_u32 s7, s42, 10240
    buffer_load_dwordx2 v[52:53], v249, s[32:35], s7 offen offset:1024 sc1
    s_add_u32 s7, s42, 15360
    buffer_load_dwordx2 v[54:55], v249, s[32:35], s7 offen offset:1024 sc1
    s_add_u32 s7, s42, 0
    buffer_load_dwordx4 v[16:19], v248, s[32:35], s7 offen offset:0 sc1
    buffer_load_dwordx4 v[20:23], v248, s[32:35], s7 offen offset:2560 sc1
    s_add_u32 s55, s55, 1
    s_waitcnt vmcnt(2)
    v_max3_u32 v10, v44, v45, v46
    v_max3_u32 v11, v47, v48, v49
    v_max3_u32 v10, v10, v52, v53
    v_max3_u32 v11, v11, v54, v55
    v_max3_u32 v10, v10, v50, v51
    v_max_u32 v10, v10, v11
    v_cmp_eq_u32 vcc, -1, v10
    s_cmp_lg_u64 vcc, 0
    s_cselect_b32 s55, s55, -1
    s_cmp_lt_u32 s55, 16384
    s_cbranch_scc1 L_ogl1
    s_branch L_oh1
L_og2:
    s_mov_b32 s55, 0
L_ogl2:
    s_add_u32 s7, s42, 0
    buffer_load_dwordx4 v[16:19], v248, s[32:35], s7 offen offset:0 sc1
    buffer_load_dwordx4 v[20:23], v248, s[32:35], s7 offen offset:2560 sc1
    s_add_u32 s7, s42, 5120
    buffer_load_dwordx4 v[24:27], v248, s[32:35], s7 offen offset:0 sc1
    buffer_load_dwordx4 v[28:31], v248, s[32:35], s7 offen offset:2560 sc1
    s_add_u32 s7, s42, 0
    buffer_load_dwordx2 v[32:33], v249, s[32:35], s7 offen offset:1024 sc1
    s_add_u32 s7, s42, 5120
    buffer_load_dwordx2 v[34:35], v249, s[32:35], s7 offen offset:1024 sc1
    s_add_u32 s55, s55, 1
    s_waitcnt vmcnt(4)
    v_max3_u32 v10, v16, v17, v18
    v_max3_u32 v11, v19, v20, v21
    v_max3_u32 v10, v10, v22, v23
    v_max_u32 v10, v10, v11
    v_cmp_eq_u32 vcc, -1, v10
    s_cmp_lg_u64 vcc, 0
    s_cselect_b32 s55, s55, -1
    s_cmp_lt_u32 s55, 16384
    s_cbranch_scc1 L_ogl2
    s_branch L_oh2
L_og3:
    s_mov_b32 s55, 0
L_ogl3:
    s_add_u32 s7, s42, 5120
    buffer_load_dwordx4 v[24:27], v248, s[32:35], s7 offen offset:0 sc1
    buffer_load_dwordx4 v[28:31], v248, s[32:35], s7 offen offset:2560 sc1
    s_add_u32 s7, s42, 0
    buffer_load_dwordx2 v[32:33], v249, s[32:35], s7 offen offset:1024 sc1
    s_add_u32 s7, s42, 5120
    buffer_load_dwordx2 v[34:35], v249, s[32:35], s7 offen offset:1024 sc1
    s_add_u32 s55, s55, 1
    s_waitcnt vmcnt(0)
    v_max3_u32 v10, v24, v25, v26
    v_max3_u32 v11, v27, v28, v29
    v_max3_u32 v10, v10, v32, v33
    v_max3_u32 v11, v11, v34, v35
    v_max3_u32 v10, v10, v30, v31
    v_max_u32 v10, v10, v11
    v_cmp_eq_u32 vcc, -1, v10
    s_cmp_lg_u64 vcc, 0
    s_cselect_b32 s55, s55, -1
    s_cmp_lt_u32 s55, 16384
    s_cbranch_scc1 L_ogl3
    s_branch L_oh3
L_pw0:
    s_mov_b32 s55, 0
    s_mov_b64 exec, s[68:69]
L_pl0:
    buffer_load_dwordx2 v[8:9], v0, s[32:35], 0 offen sc1
    s_add_u32 s55, s55, 1
    s_waitcnt vmcnt(0)
    v_subrev_co_u32 v8, vcc, s38, v8
    s_nop 1
    v_subb_co_u32 v9, vcc, v9, v7, vcc
    v_cmp_eq_u32 vcc, 0, v9
    s_or_b64 s[66:67], s[66:67], vcc
    s_andn2_b64 s[70:71], s[68:69], s[66:67]
    s_cselect_b32 s55, s55, -1
    s_cmp_lt_u32 s55, 16384
    s_cbranch_scc1 L_pl0
    s_mov_b64 exec, -1
    s_branch L_pb0
L_pw1:
    s_mov_b32 s55, 0
    s_mov_b64 exec, s[68:69]
L_pl1:
    buffer_load_dwordx2 v[8:9], v6, s[32:35], 0 offen sc1
    s_add_u32 s55, s55, 1
    s_waitcnt vmcnt(0)
    v_subrev_co_u32 v8, vcc, s38, v8
    s_nop 1
    v_subb_co_u32 v9, vcc, v9, v7, vcc
    v_cmp_eq_u32 vcc, 0, v9
    s_or_b64 s[66:67], s[66:67], vcc
    s_andn2_b64 s[70:71], s[68:69], s[66:67]
    s_cselect_b32 s55, s55, -1
    s_cmp_lt_u32 s55, 16384
    s_cbranch_scc1 L_pl1
    s_mov_b64 exec, -1
    s_branch L_pb1
L_pw2:
    s_mov_b32 s55, 0
    s_mov_b64 exec, s[68:69]
L_pl2:
    buffer_load_dwordx2 v[8:9], v6, s[32:35], 0 offen sc1
    s_add_u32 s55, s55, 1
    s_waitcnt vmcnt(0)
    v_subrev_co_u32 v8, vcc, s38, v8
    s_nop 1
    v_subb_co_u32 v9, vcc, v9, v7, vcc
    v_cmp_eq_u32 vcc, 0, v9
    s_or_b64 s[66:67], s[66:67], vcc
    s_andn2_b64 s[70:71], s[68:69], s[66:67]
    s_cselect_b32 s55, s55, -1
    s_cmp_lt_u32 s55, 16384
    s_cbranch_scc1 L_pl2
    s_mov_b64 exec, -1
    s_branch L_pb2
L_pw3:
    s_mov_b32 s55, 0
    s_mov_b64 exec, s[68:69]
L_pl3:
    buffer_load_dwordx2 v[8:9], v6, s[32:35], 0 offen sc1
    s_add_u32 s55, s55, 1
    s_waitcnt vmcnt(0)
    v_subrev_co_u32 v8, vcc, s38, v8
    s_nop 1
    v_subb_co_u32 v9, vcc, v9, v7, vcc
    v_cmp_eq_u32 vcc, 0, v9
    s_or_b64 s[66:67], s[66:67], vcc
    s_andn2_b64 s[70:71], s[68:69], s[66:67]
    s_cselect_b32 s55, s55, -1
    s_cmp_lt_u32 s55, 16384
    s_cbranch_scc1 L_pl3
    s_mov_b64 exec, -1
    s_branch L_pb3
L_pw4:
    s_mov_b32 s55, 0
    s_mov_b64 exec, s[68:69]
L_pl4:
    buffer_load_dwordx2 v[8:9], v6, s[32:35], 0 offen sc1
    s_add_u32 s55, s55, 1
    s_waitcnt vmcnt(0)
    v_subrev_co_u32 v8, vcc, s38, v8
    s_nop 1
    v_subb_co_u32 v9, vcc, v9, v7, vcc
    v_cmp_eq_u32 vcc, 0, v9
    s_or_b64 s[66:67], s[66:67], vcc
    s_andn2_b64 s[70:71], s[68:69], s[66:67]
    s_cselect_b32 s55, s55, -1
    s_cmp_lt_u32 s55, 16384
    s_cbranch_scc1 L_pl4
    s_mov_b64 exec, -1
    s_branch L_pb4
L_pw5:
    s_mov_b32 s55, 0
    s_mov_b64 exec, s[68:69]
L_pl5:
    buffer_load_dwordx2 v[8:9], v6, s[32:35], 0 offen sc1
    s_add_u32 s55, s55, 1
    s_waitcnt vmcnt(0)
    v_subrev_co_u32 v8, vcc, s38, v8
    s_nop 1
    v_subb_co_u32 v9, vcc, v9, v7, vcc
    v_cmp_eq_u32 vcc, 0, v9
    s_or_b64 s[66:67], s[66:67], vcc
    s_andn2_b64 s[70:71], s[68:69], s[66:67]
    s_cselect_b32 s55, s55, -1
    s_cmp_lt_u32 s55, 16384
    s_cbranch_scc1 L_pl5
    s_mov_b64 exec, -1
    s_branch L_pb5
L_pw6:
    s_mov_b32 s55, 0
    s_mov_b64 exec, s[68:69]
L_pl6:
    buffer_load_dwordx2 v[8:9], v6, s[32:35], 0 offen sc1
    s_add_u32 s55, s55, 1
    s_waitcnt vmcnt(0)
    v_subrev_co_u32 v8, vcc, s38, v8
    s_nop 1
    v_subb_co_u32 v9, vcc, v9, v7, vcc
    v_cmp_eq_u32 vcc, 0, v9
    s_or_b64 s[66:67], s[66:67], vcc
    s_andn2_b64 s[70:71], s[68:69], s[66:67]
    s_cselect_b32 s55, s55, -1
    s_cmp_lt_u32 s55, 16384
    s_cbranch_scc1 L_pl6
    s_mov_b64 exec, -1
    s_branch L_pb6
L_pw7:
    s_mov_b32 s55, 0
    s_mov_b64 exec, s[68:69]
L_pl7:
    buffer_load_dwordx2 v[8:9], v6, s[32:35], 0 offen sc1
    s_add_u32 s55, s55, 1
    s_waitcnt vmcnt(0)
    v_subrev_co_u32 v8, vcc, s38, v8
    s_nop 1
    v_subb_co_u32 v9, vcc, v9, v7, vcc
    v_cmp_eq_u32 vcc, 0, v9
    s_or_b64 s[66:67], s[66:67], vcc
    s_andn2_b64 s[70:71], s[68:69], s[66:67]
    s_cselect_b32 s55, s55, -1
    s_cmp_lt_u32 s55, 16384
    s_cbranch_scc1 L_pl7
    s_mov_b64 exec, -1
    s_branch L_pb7
L_pw8:
    s_mov_b32 s55, 0
    s_mov_b64 exec, s[68:69]
L_pl8:
    buffer_load_dwordx2 v[8:9], v6, s[32:35], 0 offen sc1
    s_add_u32 s55, s55, 1
    s_waitcnt vmcnt(0)
    v_subrev_co_u32 v8, vcc, s38, v8
    s_nop 1
    v_subb_co_u32 v9, vcc, v9, v7, vcc
    v_cmp_eq_u32 vcc, 0, v9
    s_or_b64 s[66:67], s[66:67], vcc
    s_andn2_b64 s[70:71], s[68:69], s[66:67]
    s_cselect_b32 s55, s55, -1
    s_cmp_lt_u32 s55, 16384
    s_cbranch_scc1 L_pl8
    s_mov_b64 exec, -1
    s_branch L_pb8
L_ow0:
    s_mov_b32 s55, 0
L_ol0:
    s_add_u32 s7, s42, 0
    buffer_load_dwordx4 v[150:153], v248, s[32:35], s7 offen offset:0 sc1
    buffer_load_dwordx4 v[154:157], v248, s[32:35], s7 offen offset:2560 sc1
    s_add_u32 s7, s42, 5120
    buffer_load_dwordx4 v[158:161], v248, s[32:35], s7 offen offset:0 sc1
    buffer_load_dwordx4 v[162:165], v248, s[32:35], s7 offen offset:2560 sc1
    s_add_u32 s7, s42, 0
    buffer_load_dwordx2 v[166:167], v249, s[32:35], s7 offen offset:1024 sc1
    s_add_u32 s7, s42, 5120
    buffer_load_dwordx2 v[168:169], v249, s[32:35], s7 offen offset:1024 sc1
    s_add_u32 s7, s42, 10240
    buffer_load_dwordx4 v[170:173], v248, s[32:35], s7 offen offset:0 sc1
    buffer_load_dwordx4 v[174:177], v248, s[32:35], s7 offen offset:2560 sc1
    s_add_u32 s7, s42, 15360
    buffer_load_dwordx4 v[178:181], v248, s[32:35], s7 offen offset:0 sc1
    buffer_load_dwordx4 v[182:185], v248, s[32:35], s7 offen offset:2560 sc1
    s_add_u32 s7, s42, 10240
    buffer_load_dwordx2 v[186:187], v249, s[32:35], s7 offen offset:1024 sc1
    s_add_u32 s7, s42, 15360
    buffer_load_dwordx2 v[188:189], v249, s[32:35], s7 offen offset:1024 sc1
    s_add_u32 s55, s55, 1
    s_waitcnt vmcnt(0)
    v_max3_u32 v10, v150, v151, v152
    v_max3_u32 v11, v153, v154, v155
    v_max3_u32 v10, v10, v156, v157
    v_max3_u32 v11, v11, v158, v159
    v_max3_u32 v10, v10, v160, v161
    v_max3_u32 v11, v11, v162, v163
    v_max3_u32 v10, v10, v164, v165
    v_max3_u32 v11, v11, v166, v167
    v_max3_u32 v10, v10, v168, v169
    v_max3_u32 v11, v11, v170, v171
    v_max3_u32 v10, v10, v172, v173
    v_max3_u32 v11, v11, v174, v175
    v_max3_u32 v10, v10, v176, v177
    v_max3_u32 v11, v11, v178, v179
    v_max3_u32 v10, v10, v180, v181
    v_max3_u32 v11, v11, v182, v183
    v_max3_u32 v10, v10, v184, v185
    v_max3_u32 v11, v11, v186, v187
    v_max3_u32 v10, v10, v188, v189
    v_max_u32 v10, v10, v11
    v_cmp_eq_u32 vcc, -1, v10
    s_cmp_lg_u64 vcc, 0
    s_cselect_b32 s55, s55, -1
    s_cmp_lt_u32 s55, 16384
    s_cbranch_scc1 L_ol0
    s_branch L_ob0
L_qw0:
    s_mov_b32 s55, 0
L_ql0:
    s_xor_b32 s7, s44, 1
    s_mul_i32 s7, s7, 5120
    s_add_u32 s7, s7, s47
    buffer_load_dwordx4 v[104:107], v2, s[32:35], s7 offen sc1
    s_mov_b64 exec, s[62:63]
    buffer_load_dwordx2 v[108:109], v3, s[32:35], s7 offen offset:1024 sc1
    s_mov_b64 exec, -1
    s_or_b32 s7, s44, 0
    s_mul_i32 s7, s7, 5120
    s_add_u32 s7, s7, s47
    buffer_load_dwordx4 v[110:113], v2, s[32:35], s7 offen sc1
    s_mov_b64 exec, s[62:63]
    buffer_load_dwordx2 v[114:115], v3, s[32:35], s7 offen offset:1024 sc1
    s_mov_b64 exec, -1
    s_add_u32 s55, s55, 1
    s_waitcnt vmcnt(0)
    v_max3_u32 v10, v104, v105, v106
    v_max3_u32 v11, v107, v108, v109
    v_max3_u32 v10, v10, v110, v111
    v_max3_u32 v11, v11, v112, v113
    v_max3_u32 v10, v10, v114, v115
    v_max_u32 v10, v10, v11
    v_cmp_eq_u32 vcc, -1, v10
    s_cmp_lg_u64 vcc, 0
    s_cselect_b32 s55, s55, -1
    s_cmp_lt_u32 s55, 16384
    s_cbranch_scc1 L_ql0
    s_branch L_qb0
L_qw1:
    s_mov_b32 s55, 0
L_ql1:
    s_xor_b32 s7, s44, 1
    s_mul_i32 s7, s7, 5120
    s_add_u32 s7, s7, s47
    buffer_load_dwordx4 v[116:119], v2, s[32:35], s7 offen sc1
    s_mov_b64 exec, s[62:63]
    buffer_load_dwordx2 v[120:121], v3, s[32:35], s7 offen offset:1024 sc1
    s_mov_b64 exec, -1
    s_or_b32 s7, s44, 0
    s_mul_i32 s7, s7, 5120
    s_add_u32 s7, s7, s47
    buffer_load_dwordx4 v[122:125], v2, s[32:35], s7 offen sc1
    s_mov_b64 exec, s[62:63]
    buffer_load_dwordx2 v[126:127], v3, s[32:35], s7 offen offset:1024 sc1
    s_mov_b64 exec, -1
    s_add_u32 s55, s55, 1
    s_waitcnt vmcnt(0)
    v_max3_u32 v10, v116, v117, v118
    v_max3_u32 v11, v119, v120, v121
    v_max3_u32 v10, v10, v122, v123
    v_max3_u32 v11, v11, v124, v125
    v_max3_u32 v10, v10, v126, v127
    v_max_u32 v10, v10, v11
    v_cmp_eq_u32 vcc, -1, v10
    s_cmp_lg_u64 vcc, 0
    s_cselect_b32 s55, s55, -1
    s_cmp_lt_u32 s55, 16384
    s_cbranch_scc1 L_ql1
    s_branch L_qb1
L_t0_0:
    s_nop 7
    s_nop 7
    s_cmp_eq_u32 s44, 0
    s_cbranch_scc1 L_t0k_0
    v_add_f32 v16, v16, v88
    v_add_f32 v17, v17, v89
    v_add_f32 v18, v18, v90
    v_add_f32 v19, v19, v91
    v_add_f32 v20, v20, v92
    v_add_f32 v21, v21, v93
    v_add_f32 v22, v22, v94
    v_add_f32 v23, v23, v95
    v_add_f32 v24, v24, v96
    v_add_f32 v25, v25, v97
    v_add_f32 v26, v26, v98
    v_add_f32 v27, v27, v99
    v_add_f32 v28, v28, v100
    v_add_f32 v29, v29, v101
    v_add_f32 v30, v30, v102
    v_add_f32 v31, v31, v103
    s_nop 1
    s_branch L_t0b_0
L_t0k_0:
    v_sub_f32 v10, v15, v88
    v_add_f32 v32, v32, v10
    v_sub_f32 v10, v15, v89
    v_add_f32 v33, v33, v10
    v_sub_f32 v10, v15, v90
    v_add_f32 v34, v34, v10
    v_sub_f32 v10, v15, v91
    v_add_f32 v35, v35, v10
    v_sub_f32 v10, v15, v92
    v_add_f32 v36, v36, v10
    v_sub_f32 v10, v15, v93
    v_add_f32 v37, v37, v10
    v_sub_f32 v10, v15, v94
    v_add_f32 v38, v38, v10
    v_sub_f32 v10, v15, v95
    v_add_f32 v39, v39, v10
    v_sub_f32 v10, v15, v96
    v_add_f32 v40, v40, v10
    v_sub_f32 v10, v15, v97
    v_add_f32 v41, v41, v10
    v_sub_f32 v10, v15, v98
    v_add_f32 v42, v42, v10
    v_sub_f32 v10, v15, v99
    v_add_f32 v43, v43, v10
    v_sub_f32 v10, v15, v100
    v_add_f32 v44, v44, v10
    v_sub_f32 v10, v15, v101
    v_add_f32 v45, v45, v10
    v_sub_f32 v10, v15, v102
    v_add_f32 v46, v46, v10
    v_sub_f32 v10, v15, v103
    v_add_f32 v47, v47, v10
    s_nop 1
    s_branch L_t0b_0
L_t0_1:
    s_nop 7
    s_nop 7
    s_cmp_eq_u32 s44, 0
    s_cbranch_scc1 L_t0k_1
    v_add_f32 v16, v16, v88
    v_add_f32 v17, v17, v89
    v_add_f32 v18, v18, v90
    v_add_f32 v19, v19, v91
    v_add_f32 v20, v20, v92
    v_add_f32 v21, v21, v93
    v_add_f32 v22, v22, v94
    v_add_f32 v23, v23, v95
    v_add_f32 v24, v24, v96
    v_add_f32 v25, v25, v97
    v_add_f32 v26, v26, v98
    v_add_f32 v27, v27, v99
    v_add_f32 v28, v28, v100
    v_add_f32 v29, v29, v101
    v_add_f32 v30, v30, v102
    v_add_f32 v31, v31, v103
    s_nop 1
    s_branch L_t0b_1
L_t0k_1:
    v_sub_f32 v10, v15, v88
    v_add_f32 v32, v32, v10
    v_sub_f32 v10, v15, v89
    v_add_f32 v33, v33, v10
    v_sub_f32 v10, v15, v90
    v_add_f32 v34, v34, v10
    v_sub_f32 v10, v15, v91
    v_add_f32 v35, v35, v10
    v_sub_f32 v10, v15, v92
    v_add_f32 v36, v36, v10
    v_sub_f32 v10, v15, v93
    v_add_f32 v37, v37, v10
    v_sub_f32 v10, v15, v94
    v_add_f32 v38, v38, v10
    v_sub_f32 v10, v15, v95
    v_add_f32 v39, v39, v10
    v_sub_f32 v10, v15, v96
    v_add_f32 v40, v40, v10
    v_sub_f32 v10, v15, v97
    v_add_f32 v41, v41, v10
    v_sub_f32 v10, v15, v98
    v_add_f32 v42, v42, v10
    v_sub_f32 v10, v15, v99
    v_add_f32 v43, v43, v10
    v_sub_f32 v10, v15, v100
    v_add_f32 v44, v44, v10
    v_sub_f32 v10, v15, v101
    v_add_f32 v45, v45, v10
    v_sub_f32 v10, v15, v102
    v_add_f32 v46, v46, v10
    v_sub_f32 v10, v15, v103
    v_add_f32 v47, v47, v10
    s_nop 1
    s_branch L_t0b_1
L_fb:
    s_waitcnt vmcnt(0) lgkmcnt(0)
    v_and_b32 v86, 31, v1
    v_lshrrev_b32 v10, 5, v1
    v_lshlrev_b32 v10, 2, v10
    v_sub_u32 v86, v86, v10
    v_mov_b32 v78, v135
    v_mov_b32 v79, v135
    v_mov_b32 v80, v135
    v_mov_b32 v81, v135
    v_mov_b32 v82, v135
    v_mov_b32 v83, v135
    v_mov_b32 v84, v135
    v_mov_b32 v85, v135
    v_mov_b64 v[76:77], 0
    v_mov_b32 v32, 0
    v_mov_b32 v33, 0
    v_mov_b32 v34, 0
    v_mov_b32 v35, 0
    v_mov_b32 v36, 0
    v_mov_b32 v37, 0
    v_mov_b32 v38, 0
    v_mov_b32 v39, 0
    v_mov_b32 v40, 0
    v_mov_b32 v41, 0
    v_mov_b32 v42, 0
    v_mov_b32 v43, 0
    v_mov_b32 v44, 0
    v_mov_b32 v45, 0
    v_mov_b32 v46, 0
    v_mov_b32 v47, 0
    v_mov_b32 v56, 0
    v_mov_b32 v57, 0
    v_mov_b32 v58, 0
    v_mov_b32 v59, 0
    v_mov_b32 v60, 0
    v_mov_b32 v61, 0
    v_mov_b32 v62, 0
    v_mov_b32 v63, 0
    v_mov_b32 v64, 0
    v_mov_b32 v65, 0
    v_mov_b32 v66, 0
    v_mov_b32 v67, 0
    v_mov_b32 v68, 0
    v_mov_b32 v69, 0
    v_mov_b32 v70, 0
    v_mov_b32 v71, 0
    v_mov_b32 v87, v15
    s_mov_b32 s68, s46
    s_mov_b32 s69, 64
    s_mov_b32 s70, 0x7fffffff
    s_mov_b32 s7, 0x10000
    s_add_u32 s40, s100, 1
    s_bitcmp1_b32 s40, 1
    s_cbranch_scc0 L_fbgo
    s_add_u32 s7, s53, s44
    s_min_u32 s69, s7, 8
    s_sub_u32 s7, s7, s69
    s_mul_i32 s7, s7, 2560
    s_add_u32 s68, s68, s7
    s_add_u32 s68, s68, 5242880
    s_lshl_b32 s7, s69, 5
    s_add_u32 s69, s69, 1
    s_mov_b32 s70, 256
L_fbgo:
    v_add_u32 v86, s7, v86
    s_mov_b32 s71, 0
L_fbpass:
    s_mov_b32 s55, 0
    s_mov_b32 s7, s68
    v_mov_b32 v11, v86
L_fbloop:
    buffer_load_dwordx4 v[72:75], v2, s[32:35], s7 offen sc1
    s_mov_b64 exec, s[62:63]
    buffer_load_dwordx2 v[76:77], v3, s[32:35], s7 offen offset:2304 sc1
    s_mov_b64 exec, s[64:65]
    buffer_load_dwordx4 v[78:81], v4, s[32:35], s7 offen offset:1024 sc1
    buffer_load_dwordx4 v[82:85], v5, s[32:35], s7 offen offset:1024 sc1
    s_mov_b64 exec, -1
    s_waitcnt vmcnt(0)
    s_bitcmp1_b32 s40, 1
    s_cbranch_scc1 L_fbqb
    v_mfma_f32_32x32x8bf16_1k v[16:31], v[76:77], v[114:115], v[32:47]
    v_mfma_f32_32x32x16_bf16 v[16:31], v[72:75], v[110:113], v[16:31]
    s_branch L_fbq
L_fbqb:
    s_nop 8
    v_mfma_f32_32x32x8bf16_1k v[16:31], v[76:77], v[126:127], v[32:47]
    v_mfma_f32_32x32x16_bf16 v[16:31], v[72:75], v[122:125], v[16:31]
L_fbq:
    s_nop 7
    s_nop 7
    v_subrev_u32 v10, 0, v11
    v_cmp_gt_u32 vcc, s70, v10
    s_nop 1
    v_cndmask_b32 v16, v15, v16, vcc
    v_subrev_u32 v10, 1, v11
    v_cmp_gt_u32 vcc, s70, v10
    s_nop 1
    v_cndmask_b32 v17, v15, v17, vcc
    v_subrev_u32 v10, 2, v11
    v_cmp_gt_u32 vcc, s70, v10
    s_nop 1
    v_cndmask_b32 v18, v15, v18, vcc
    v_subrev_u32 v10, 3, v11
    v_cmp_gt_u32 vcc, s70, v10
    s_nop 1
    v_cndmask_b32 v19, v15, v19, vcc
    v_subrev_u32 v10, 8, v11
    v_cmp_gt_u32 vcc, s70, v10
    s_nop 1
    v_cndmask_b32 v20, v15, v20, vcc
    v_subrev_u32 v10, 9, v11
    v_cmp_gt_u32 vcc, s70, v10
    s_nop 1
    v_cndmask_b32 v21, v15, v21, vcc
    v_subrev_u32 v10, 10, v11
    v_cmp_gt_u32 vcc, s70, v10
    s_nop 1
    v_cndmask_b32 v22, v15, v22, vcc
    v_subrev_u32 v10, 11, v11
    v_cmp_gt_u32 vcc, s70, v10
    s_nop 1
    v_cndmask_b32 v23, v15, v23, vcc
    v_subrev_u32 v10, 16, v11
    v_cmp_gt_u32 vcc, s70, v10
    s_nop 1
    v_cndmask_b32 v24, v15, v24, vcc
    v_subrev_u32 v10, 17, v11
    v_cmp_gt_u32 vcc, s70, v10
    s_nop 1
    v_cndmask_b32 v25, v15, v25, vcc
    v_subrev_u32 v10, 18, v11
    v_cmp_gt_u32 vcc, s70, v10
    s_nop 1
    v_cndmask_b32 v26, v15, v26, vcc
    v_subrev_u32 v10, 19, v11
    v_cmp_gt_u32 vcc, s70, v10
    s_nop 1
    v_cndmask_b32 v27, v15, v27, vcc
    v_subrev_u32 v10, 24, v11
    v_cmp_gt_u32 vcc, s70, v10
    s_nop 1
    v_cndmask_b32 v28, v15, v28, vcc
    v_subrev_u32 v10, 25, v11
    v_cmp_gt_u32 vcc, s70, v10
    s_nop 1
    v_cndmask_b32 v29, v15, v29, vcc
    v_subrev_u32 v10, 26, v11
    v_cmp_gt_u32 vcc, s70, v10
    s_nop 1
    v_cndmask_b32 v30, v15, v30, vcc
    v_subrev_u32 v10, 27, v11
    v_cmp_gt_u32 vcc, s70, v10
    s_nop 1
    v_cndmask_b32 v31, v15, v31, vcc
    s_cmp_eq_u32 s71, 1
    s_cbranch_scc1 L_fb2
    v_max3_f32 v87, v87, v16, v17
    v_max3_f32 v87, v87, v18, v19
    v_max3_f32 v87, v87, v20, v21
    v_max3_f32 v87, v87, v22, v23
    v_max3_f32 v87, v87, v24, v25
    v_max3_f32 v87, v87, v26, v27
    v_max3_f32 v87, v87, v28, v29
    v_max3_f32 v87, v87, v30, v31
    s_branch L_fbnext
L_fb2:
    v_exp_f32 v16, v16
    v_exp_f32 v17, v17
    v_exp_f32 v18, v18
    v_exp_f32 v19, v19
    v_exp_f32 v20, v20
    v_exp_f32 v21, v21
    v_exp_f32 v22, v22
    v_exp_f32 v23, v23
    v_exp_f32 v24, v24
    v_exp_f32 v25, v25
    v_exp_f32 v26, v26
    v_exp_f32 v27, v27
    v_exp_f32 v28, v28
    v_exp_f32 v29, v29
    v_exp_f32 v30, v30
    v_exp_f32 v31, v31
    v_cvt_pk_bf16_f32 v48, v16, v17
    v_cvt_pk_bf16_f32 v49, v18, v19
    v_cvt_pk_bf16_f32 v50, v20, v21
    v_cvt_pk_bf16_f32 v51, v22, v23
    v_cvt_pk_bf16_f32 v52, v24, v25
    v_cvt_pk_bf16_f32 v53, v26, v27
    v_cvt_pk_bf16_f32 v54, v28, v29
    v_cvt_pk_bf16_f32 v55, v30, v31
    v_mfma_f32_32x32x16_bf16 v[56:71], v[78:81], v[48:51], v[56:71]
    s_nop 0
    v_mfma_f32_32x32x16_bf16 v[56:71], v[82:85], v[52:55], v[56:71]
    s_nop 7
    s_nop 7
L_fbnext:
    v_subrev_u32 v11, 32, v11
    s_add_u32 s7, s7, 2560
    s_add_u32 s55, s55, 1
    s_cmp_lt_u32 s55, s69
    s_cbranch_scc1 L_fbloop
    s_cmp_eq_u32 s71, 1
    s_cbranch_scc1 L_fbdone
    v_mov_b32 v10, v87
    s_nop 1
    v_permlane32_swap_b32 v10, v87
    v_max_f32 v87, v87, v10
    v_sub_f32 v32, 0, v87
    v_sub_f32 v33, 0, v87
    v_sub_f32 v34, 0, v87
    v_sub_f32 v35, 0, v87
    v_sub_f32 v36, 0, v87
    v_sub_f32 v37, 0, v87
    v_sub_f32 v38, 0, v87
    v_sub_f32 v39, 0, v87
    v_sub_f32 v40, 0, v87
    v_sub_f32 v41, 0, v87
    v_sub_f32 v42, 0, v87
    v_sub_f32 v43, 0, v87
    v_sub_f32 v44, 0, v87
    v_sub_f32 v45, 0, v87
    v_sub_f32 v46, 0, v87
    v_sub_f32 v47, 0, v87
    s_mov_b32 s71, 1
    s_branch L_fbpass
L_fbdone:
    s_cmp_eq_u32 s100, 0
    s_cbranch_scc1 L_ret0
    s_cmp_eq_u32 s100, 1
    s_cbranch_scc1 L_ret1
    s_cmp_eq_u32 s100, 2
    s_cbranch_scc1 L_ret2
    s_branch L_ret3
.section .rodata,"a"
.p2align 6
.amdhsa_kernel fk_kernel
  .amdhsa_next_free_vgpr 256
  .amdhsa_next_free_sgpr 102
  .amdhsa_accum_offset 256
  .amdhsa_group_segment_fixed_size 0
  .amdhsa_kernarg_size 72
  .amdhsa_user_sgpr_count 2
  .amdhsa_user_sgpr_kernarg_segment_ptr 1
  .amdhsa_system_sgpr_workgroup_id_x 1
.end_amdhsa_kernel
```
